```python
import torch

def _softmax(x, axis=-1):
    return torch.softmax(x, dim=axis)
def _gelu(x):
    return torch.nn.functional.gelu(x, approximate="tanh")
def _silu(x):
    return torch.nn.functional.silu(x)
def _sigmoid(x):
    return torch.sigmoid(x)
def _layernorm(x, axis=-1, eps=1e-5):
    m = x.mean(dim=axis, keepdim=True)
    v = x.var(dim=axis, keepdim=True, unbiased=False)
    return (x - m) / torch.sqrt(v + eps)
def _scatter_add(tgt, idx, src, axis=0):
    return tgt.clone().index_add_(axis, idx, src)
def _segment_sum(src, seg, n):
    out = torch.zeros((n,) + src.shape[1:], dtype=src.dtype)
    return out.index_add_(0, seg, src)
def _pad(x, pw):
    flat = tuple(v for pair in reversed(pw) for v in pair)
    return torch.nn.functional.pad(x, flat)

kernel_name = 'concat_heads__gqa_block_cached__gqa_block_cached__near_ridge'

def setup_inputs():

    _w = (lambda a: (lambda t: t.to(torch.bfloat16) if t.is_floating_point() else t)(torch.as_tensor(a)))
    def _A_setup():
        B, Sq, D = 8, 192, 512
        Hq, Hkv, Sk, Dh = 32, 32, 1024, 128
        assert Hq % Hkv == 0, (Hq, Hkv)
        return {
            "x": _w((lambda *s: torch.randn(*s, dtype=torch.bfloat16) * 0.8)(B, Sq, D)),
            "k_cache": _w((lambda *s: torch.randn(*s, dtype=torch.bfloat16) * 0.8)(B, Hkv, Sk, Dh)),
            "v_cache": _w((lambda *s: torch.randn(*s, dtype=torch.bfloat16) * 0.05)(B, Hkv, Sk, Dh)),
            "wq": _w((lambda *s: torch.randn(*s, dtype=torch.bfloat16) * 0.8)(D, Hq * Dh) * (D ** -0.5)),
            "wo": _w((lambda *s: torch.randn(*s, dtype=torch.bfloat16) * 0.05)(Hq * Dh, D) * ((Hq * Dh) ** -0.5)),
        }
    _A_in = _A_setup()

    def _B_setup():
        B, Sq, D = 8, 192, 512
        Hq, Hkv, Sk, Dh = 32, 32, 1024, 128
        assert Hq % Hkv == 0, (Hq, Hkv)
        return {
            "x": _w((lambda *s: torch.randn(*s, dtype=torch.bfloat16) * 0.8)(B, Sq, D)),
            "k_cache": _w((lambda *s: torch.randn(*s, dtype=torch.bfloat16) * 0.8)(B, Hkv, Sk, Dh)),
            "v_cache": _w((lambda *s: torch.randn(*s, dtype=torch.bfloat16) * 0.05)(B, Hkv, Sk, Dh)),
            "wq": _w((lambda *s: torch.randn(*s, dtype=torch.bfloat16) * 0.8)(D, Hq * Dh) * (D ** -0.5)),
            "wo": _w((lambda *s: torch.randn(*s, dtype=torch.bfloat16) * 0.05)(Hq * Dh, D) * ((Hq * Dh) ** -0.5)),
        }
    _B_in = _B_setup()

    return {
        "A_x": _A_in["x"],
        "A_k_cache": _A_in["k_cache"],
        "A_v_cache": _A_in["v_cache"],
        "A_wq": _A_in["wq"],
        "A_wo": _A_in["wo"],
        "B_x": _B_in["x"],
        "B_k_cache": _B_in["k_cache"],
        "B_v_cache": _B_in["v_cache"],
        "B_wq": _B_in["wq"],
        "B_wo": _B_in["wo"],
    }

def reference(A_x, A_k_cache, A_v_cache, A_wq, A_wo, B_x, B_k_cache, B_v_cache, B_wq, B_wo):
    def _A_ref(x, k_cache, v_cache, wq, wo):
        B, Sq, D = x.shape
        Hq, Dh = 32, 128
        Hkv = k_cache.shape[1]
        rep = Hq // Hkv
        q = (lambda x, *d: x.permute(*d))((x @ wq).reshape(B, Sq, Hq, Dh), 0, 2, 1, 3)
        k = (lambda x, n, axis: torch.repeat_interleave(x, n, dim=axis))(k_cache, rep, axis=1)
        v = (lambda x, n, axis: torch.repeat_interleave(x, n, dim=axis))(v_cache, rep, axis=1)
        scores = torch.einsum("bhqd,bhkd->bhqk", q, k) * (Dh ** -0.5)
        p = _softmax(scores, axis=-1)
        o = torch.einsum("bhqk,bhkd->bhqd", p, v)
        return (lambda x, *d: x.permute(*d))(o, 0, 2, 1, 3).reshape(B, Sq, Hq * Dh) @ wo

    def _B_ref(x, k_cache, v_cache, wq, wo):
        B, Sq, D = x.shape
        Hq, Dh = 32, 128
        Hkv = k_cache.shape[1]
        rep = Hq // Hkv
        q = (lambda x, *d: x.permute(*d))((x @ wq).reshape(B, Sq, Hq, Dh), 0, 2, 1, 3)
        k = (lambda x, n, axis: torch.repeat_interleave(x, n, dim=axis))(k_cache, rep, axis=1)
        v = (lambda x, n, axis: torch.repeat_interleave(x, n, dim=axis))(v_cache, rep, axis=1)
        scores = torch.einsum("bhqd,bhkd->bhqk", q, k) * (Dh ** -0.5)
        p = _softmax(scores, axis=-1)
        o = torch.einsum("bhqk,bhkd->bhqd", p, v)
        return (lambda x, *d: x.permute(*d))(o, 0, 2, 1, 3).reshape(B, Sq, Hq * Dh) @ wo

    a = _A_ref(A_x, A_k_cache, A_v_cache, A_wq, A_wo)
    b = _B_ref(B_x, B_k_cache, B_v_cache, B_wq, B_wo)
    return torch.concatenate([a, b], axis=-1)
```

```asm
; @launch kernel=attn_kernel grid=(256,1,1) block=(256,1,1) lds=163840
; @launch kernel=reduce_kernel grid=(256,1,1) block=(256,1,1) lds=0
.amdgcn_target "amdgcn-amd-amdhsa--gfx950"
.text
.globl attn_kernel
.p2align 8
.type attn_kernel,@function
attn_kernel:
    s_cmp_ge_u32 s2, 256
    s_cbranch_scc1 Lk1_end
    s_load_dwordx8 s[48:55], s[0:1], 0
    s_load_dwordx8 s[56:63], s[0:1], 40
    s_load_dwordx2 s[64:65], s[0:1], 96
    v_lshrrev_b32 v100, 6, v0
    v_and_b32 v119, 63, v0
    v_readfirstlane_b32 s20, v100
    s_and_b32 s23, s2, 7
    s_lshr_b32 s31, s2, 3
    s_lshr_b32 s80, s23, 2
    s_and_b32 s23, s23, 3
    s_lshl_b32 s23, s23, 2
    s_lshr_b32 s82, s31, 3
    s_add_u32 s82, s82, s23
    s_and_b32 s81, s31, 7
    s_lshr_b32 s21, s20, 1
    s_and_b32 s22, s20, 1
    v_lshrrev_b32 v100, 4, v119
    v_and_b32 v101, 15, v119
    v_and_b32 v102, 3, v119
    v_lshrrev_b32 v104, 2, v119
    v_and_b32 v103, 3, v104
    v_lshrrev_b32 v105, 5, v119
    v_and_b32 v106, 31, v119
    v_sub_u32 v107, 0, v100
    v_and_b32 v107, 3, v107
    v_xor_b32 v107, v107, v102
    v_lshlrev_b32 v107, 4, v107
    v_lshl_add_u32 v192, v104, 10, v107
    v_add_u32 v193, 15360, v192
    v_add_u32 v194, 30720, v192
    v_lshrrev_b32 v107, 2, v106
    v_add_u32 v108, 0, v105
    v_xor_b32 v108, v108, v107
    v_lshl_add_u32 v108, v108, 2, v102
    v_lshlrev_b32 v108, 4, v108
    v_lshl_add_u32 v108, v105, 13, v108
    v_add_u32 v195, 0, v108
    v_add_u32 v108, 2, v105
    v_xor_b32 v108, v108, v107
    v_lshl_add_u32 v108, v108, 2, v102
    v_lshlrev_b32 v108, 4, v108
    v_lshl_add_u32 v108, v105, 13, v108
    v_add_u32 v196, 15360, v108
    v_add_u32 v108, 0, v105
    v_xor_b32 v108, v108, v107
    v_lshl_add_u32 v108, v108, 2, v102
    v_lshlrev_b32 v108, 4, v108
    v_lshl_add_u32 v108, v105, 13, v108
    v_add_u32 v197, 30720, v108
    v_add_u32 v108, 2, v105
    v_xor_b32 v108, v108, v107
    v_lshl_add_u32 v108, v108, 2, v102
    v_lshlrev_b32 v108, 4, v108
    v_lshl_add_u32 v108, v105, 13, v108
    v_add_u32 v198, 46080, v108
    s_waitcnt lgkmcnt(0)
    s_cmp_eq_u32 s80, 0
    s_cselect_b32 s48, s48, s56
    s_cselect_b32 s49, s49, s57
    s_cselect_b32 s50, s50, s58
    s_cselect_b32 s51, s51, s59
    s_cselect_b32 s52, s52, s60
    s_cselect_b32 s53, s53, s61
    s_cselect_b32 s54, s54, s62
    s_cselect_b32 s55, s55, s63
    s_mul_i32 s23, s81, 196608
    s_mul_i32 s31, s20, 49152
    s_add_u32 s23, s23, s31
    s_add_u32 s8, s48, s23
    s_addc_u32 s9, s49, 0
    s_mov_b32 s10, 49152
    s_mov_b32 s11, 0x00020000
    s_lshl_b32 s23, s82, 9
    s_lshl_b32 s31, s20, 16
    s_add_u32 s23, s23, s31
    s_add_u32 s12, s54, s23
    s_addc_u32 s13, s55, 0
    s_mov_b32 s14, 0
    s_mov_b32 s15, 0x00020000
    s_sub_u32 s14, 4194304, s23
    s_mov_b32 s36, 0
    s_mov_b32 s37, 0
    s_mul_i32 s38, s20, 3072
    s_add_u32 s38, s38, 98304
    s_lshl_b32 s39, s20, 12
    s_add_u32 s39, s39, 32768
    s_add_u32 m0, s39, 0
    s_nop 0
    buffer_load_dwordx4 v195, s[12:15], s37 offen offset:0 lds
    buffer_load_dwordx4 v196, s[12:15], s37 offen offset:1024 lds
    buffer_load_dwordx4 v197, s[12:15], s37 offen offset:2048 lds
    buffer_load_dwordx4 v198, s[12:15], s37 offen offset:3072 lds
    s_add_u32 m0, s38, 0
    s_add_u32 s37, s37, 262144
    buffer_load_dwordx4 v192, s[8:11], s36 offen offset:0 lds
    buffer_load_dwordx4 v193, s[8:11], s36 offen offset:1024 lds
    buffer_load_dwordx4 v194, s[8:11], s36 offen offset:2048 lds
    s_add_u32 s36, s36, 64
    s_add_u32 m0, s39, 16384
    s_nop 0
    buffer_load_dwordx4 v195, s[12:15], s37 offen offset:0 lds
    buffer_load_dwordx4 v196, s[12:15], s37 offen offset:1024 lds
    buffer_load_dwordx4 v197, s[12:15], s37 offen offset:2048 lds
    buffer_load_dwordx4 v198, s[12:15], s37 offen offset:3072 lds
    s_add_u32 m0, s38, 12288
    s_add_u32 s37, s37, 262144
    buffer_load_dwordx4 v192, s[8:11], s36 offen offset:0 lds
    buffer_load_dwordx4 v193, s[8:11], s36 offen offset:1024 lds
    buffer_load_dwordx4 v194, s[8:11], s36 offen offset:2048 lds
    s_add_u32 s36, s36, 64
    s_add_u32 m0, s39, 32768
    s_nop 0
    buffer_load_dwordx4 v195, s[12:15], s37 offen offset:0 lds
    buffer_load_dwordx4 v196, s[12:15], s37 offen offset:1024 lds
    buffer_load_dwordx4 v197, s[12:15], s37 offen offset:2048 lds
    buffer_load_dwordx4 v198, s[12:15], s37 offen offset:3072 lds
    s_add_u32 m0, s38, 24576
    s_add_u32 s37, s37, 262144
    buffer_load_dwordx4 v192, s[8:11], s36 offen offset:0 lds
    buffer_load_dwordx4 v193, s[8:11], s36 offen offset:1024 lds
    buffer_load_dwordx4 v194, s[8:11], s36 offen offset:2048 lds
    s_add_u32 s36, s36, 64
    s_add_u32 m0, s39, 49152
    s_nop 0
    buffer_load_dwordx4 v195, s[12:15], s37 offen offset:0 lds
    buffer_load_dwordx4 v196, s[12:15], s37 offen offset:1024 lds
    buffer_load_dwordx4 v197, s[12:15], s37 offen offset:2048 lds
    buffer_load_dwordx4 v198, s[12:15], s37 offen offset:3072 lds
    s_add_u32 m0, s38, 36864
    s_add_u32 s37, s37, 262144
    buffer_load_dwordx4 v192, s[8:11], s36 offen offset:0 lds
    buffer_load_dwordx4 v193, s[8:11], s36 offen offset:1024 lds
    buffer_load_dwordx4 v194, s[8:11], s36 offen offset:2048 lds
    s_add_u32 s36, s36, 64
    s_mov_b32 s68, s48
    s_mov_b32 s69, s49
    s_mov_b32 s70, 1572864
    s_mov_b32 s71, 0x00020000
    s_mov_b32 s72, s54
    s_mov_b32 s73, s55
    s_mov_b32 s74, 4194304
    s_mov_b32 s75, 0x00020000
    s_lshr_b32 s23, s2, 3
    s_lshl_b32 s23, s23, 2
    s_add_u32 s23, s23, s20
    s_mul_i32 s31, s23, 12288
    v_lshlrev_b32 v107, 7, v119
    v_add_u32 v107, s31, v107
    s_lshl_b32 s31, s23, 15
    s_and_b32 s23, s2, 3
    s_lshl_b32 s23, s23, 11
    s_add_u32 s31, s31, s23
    v_lshlrev_b32 v108, 7, v101
    v_lshl_add_u32 v108, v100, 13, v108
    v_add_u32 v108, s31, v108
    s_movk_i32 s23, 0x2000
    buffer_load_dword v253, v108, s[72:75], 0 offen
    buffer_load_dword v254, v107, s[68:71], 0 offen
    buffer_load_dword v255, v107, s[68:71], s23 offen
    s_getpc_b64 s[66:67]
Lpc0:
    s_lshl_b32 s23, s20, 14
    v_lshlrev_b32 v107, 7, v119
    v_add_u32 v107, s23, v107
    s_mov_b32 s23, Ltext_end-Lpc0-4
    v_min_u32 v108, s23, v107
    global_load_dword v252, v108, s[66:67]
    v_add_u32 v107, 8192, v107
    v_min_u32 v108, s23, v107
    global_load_dword v252, v108, s[66:67]
    s_lshl_b32 s23, s81, 5
    s_lshl_b32 s31, s82, 1
    s_add_u32 s31, s31, s21
    s_add_u32 s23, s23, s31
    s_lshl_b32 s23, s23, 18
    s_add_u32 s4, s50, s23
    s_addc_u32 s5, s51, 0
    s_mov_b32 s6, 262144
    s_mov_b32 s7, 0x00020000
    s_add_u32 s76, s52, s23
    s_addc_u32 s77, s53, 0
    s_mov_b32 s78, 262144
    s_mov_b32 s79, 0x00020000
    s_lshl_b32 s23, s80, 3
    s_add_u32 s23, s23, s81
    s_lshl_b32 s23, s23, 4
    s_add_u32 s23, s23, s82
    s_lshl_b32 s23, s23, 2
    s_lshl_b32 s35, s22, 1
    s_add_u32 s23, s23, s35
    s_add_u32 s23, s23, s21
    s_mul_i32 s23, s23, 49152
    s_add_u32 s16, s64, s23
    s_addc_u32 s17, s65, 0
    s_mov_b32 s18, 49152
    s_mov_b32 s19, 0x00020000
    v_sub_u32 v107, 0, v103
    v_and_b32 v107, 3, v107
    v_xor_b32 v107, v107, v100
    v_lshlrev_b32 v107, 4, v107
    v_lshl_add_u32 v107, v101, 6, v107
    s_mul_i32 s23, s22, 6144
    s_add_u32 s23, s23, 98304
    v_add_u32 v199, s23, v107
    v_lshl_add_u32 v110, v100, 3, v103
    s_lshl_b32 s23, s21, 8
    s_add_u32 s23, s23, 32768
    v_lshlrev_b32 v107, 4, v102
    v_lshl_add_u32 v107, v110, 9, v107
    v_xor_b32 v108, 0, v103
    v_lshl_add_u32 v108, v108, 6, v107
    v_add_u32 v200, s23, v108
    v_xor_b32 v108, 1, v103
    v_lshl_add_u32 v108, v108, 6, v107
    v_add_u32 v201, s23, v108
    v_xor_b32 v108, 2, v103
    v_lshl_add_u32 v108, v108, 6, v107
    v_add_u32 v202, s23, v108
    v_xor_b32 v108, 3, v103
    v_lshl_add_u32 v108, v108, 6, v107
    v_add_u32 v203, s23, v108
    s_lshl_b32 s31, s21, 13
    s_add_u32 s23, s31, 98304
    v_and_b32 v109, 1, v100
    v_lshl_add_u32 v109, v109, 2, v103
    v_lshlrev_b32 v107, 3, v102
    v_lshl_add_u32 v107, v110, 8, v107
    v_xor_b32 v108, 0, v109
    v_lshl_add_u32 v108, v108, 5, v107
    v_add_u32 v224, s23, v108
    v_xor_b32 v108, 1, v109
    v_lshl_add_u32 v108, v108, 5, v107
    v_add_u32 v225, s23, v108
    v_xor_b32 v108, 2, v109
    v_lshl_add_u32 v108, v108, 5, v107
    v_add_u32 v226, s23, v108
    v_xor_b32 v108, 3, v109
    v_lshl_add_u32 v108, v108, 5, v107
    v_add_u32 v227, s23, v108
    v_xor_b32 v108, 4, v109
    v_lshl_add_u32 v108, v108, 5, v107
    v_add_u32 v228, s23, v108
    v_xor_b32 v108, 5, v109
    v_lshl_add_u32 v108, v108, 5, v107
    v_add_u32 v229, s23, v108
    v_xor_b32 v108, 6, v109
    v_lshl_add_u32 v108, v108, 5, v107
    v_add_u32 v230, s23, v108
    v_xor_b32 v108, 7, v109
    v_lshl_add_u32 v108, v108, 5, v107
    v_add_u32 v231, s23, v108
    v_lshl_add_u32 v107, v103, 3, v102
    v_lshlrev_b32 v107, 8, v107
    v_add_u32 v108, 0, v100
    v_xor_b32 v108, v108, v101
    v_lshl_add_u32 v108, v108, 4, v107
    v_add_u32 v220, s31, v108
    v_add_u32 v108, 4, v100
    v_xor_b32 v108, v108, v101
    v_lshl_add_u32 v108, v108, 4, v107
    v_add_u32 v221, s31, v108
    v_add_u32 v108, 8, v100
    v_xor_b32 v108, v108, v101
    v_lshl_add_u32 v108, v108, 4, v107
    v_add_u32 v222, s31, v108
    v_add_u32 v108, 12, v100
    v_xor_b32 v108, v108, v101
    v_lshl_add_u32 v108, v108, 4, v107
    v_add_u32 v223, s31, v108
    s_lshl_b32 s23, s22, 3
    v_add_u32 v107, 0, v100
    v_add_u32 v107, s23, v107
    v_xor_b32 v107, v107, v101
    v_lshlrev_b32 v107, 4, v107
    v_lshl_add_u32 v232, v100, 8, v107
    v_or_b32 v108, 0, v100
    v_lshlrev_b32 v108, 1, v108
    v_xor_b32 v108, v108, v101
    v_lshlrev_b32 v108, 4, v108
    v_lshl_add_u32 v234, v100, 8, v108
    v_add_u32 v107, 4, v100
    v_add_u32 v107, s23, v107
    v_xor_b32 v107, v107, v101
    v_lshlrev_b32 v107, 4, v107
    v_lshl_add_u32 v233, v100, 8, v107
    v_or_b32 v108, 4, v100
    v_lshlrev_b32 v108, 1, v108
    v_xor_b32 v108, v108, v101
    v_lshlrev_b32 v108, 4, v108
    v_lshl_add_u32 v235, v100, 8, v108
    v_lshlrev_b32 v236, 4, v119
    v_lshrrev_b32 v107, 3, v119
    v_and_b32 v108, 7, v119
    v_and_b32 v109, 6, v107
    v_xor_b32 v108, v108, v109
    v_lshlrev_b32 v108, 4, v108
    v_lshl_add_u32 v237, v107, 10, v108
    v_lshl_add_u32 v107, v100, 2, v103
    v_lshlrev_b32 v107, 7, v107
    v_lshl_add_u32 v107, v102, 3, v107
    s_lshl_b32 s23, s21, 14
    v_add_u32 v250, s23, v107
    v_lshrrev_b32 v107, 1, v103
    v_lshl_add_u32 v107, v100, 1, v107
    v_and_b32 v251, 3, v107
    s_lshl_b32 s28, s22, 12
    s_mov_b32 s29, s28
    s_add_u32 s24, s31, s28
    s_add_u32 s25, s24, 98304
    s_mov_b32 s32, 0x3e0293ee
    s_mov_b32 s33, 0x3e0293ee
    s_mov_b32 s34, 0x41800000
    v_mov_b32 v216, 0x3f803f80
    v_mov_b32 v217, 0x3f803f80
    v_mov_b32 v218, 0x3f803f80
    v_mov_b32 v219, 0x3f803f80
    s_waitcnt vmcnt(26)
    s_barrier
    ds_read_b128 a[32:35], v199 offset:0
    ds_read_b128 a[36:39], v199 offset:1024
    ds_read_b128 a[40:43], v199 offset:2048
    ds_read_b128 a[44:47], v199 offset:3072
    ds_read_b128 a[48:51], v199 offset:4096
    ds_read_b128 a[52:55], v199 offset:5120
    ds_read_b64_tr_b16 a[0:1], v200 offset:0
    ds_read_b64_tr_b16 a[2:3], v200 offset:2048
    ds_read_b64_tr_b16 a[4:5], v200 offset:8
    ds_read_b64_tr_b16 a[6:7], v200 offset:2056
    ds_read_b64_tr_b16 a[8:9], v201 offset:0
    ds_read_b64_tr_b16 a[10:11], v201 offset:2048
    ds_read_b64_tr_b16 a[12:13], v201 offset:8
    ds_read_b64_tr_b16 a[14:15], v201 offset:2056
    ds_read_b64_tr_b16 a[16:17], v202 offset:0
    ds_read_b64_tr_b16 a[18:19], v202 offset:2048
    ds_read_b64_tr_b16 a[20:21], v202 offset:8
    ds_read_b64_tr_b16 a[22:23], v202 offset:2056
    ds_read_b64_tr_b16 a[24:25], v203 offset:0
    ds_read_b64_tr_b16 a[26:27], v203 offset:2048
    ds_read_b64_tr_b16 a[28:29], v203 offset:8
    ds_read_b64_tr_b16 a[30:31], v203 offset:2056
    s_waitcnt vmcnt(19)
    s_waitcnt lgkmcnt(0)
    s_barrier
    v_mfma_f32_16x16x32_bf16 v[0:3], a[0:3], a[32:35], 0
    ds_read_b128 a[88:91], v199 offset:12288
    v_mfma_f32_16x16x32_bf16 v[32:35], a[0:3], a[36:39], 0
    s_add_u32 m0, s39, 0
    s_nop 0
    buffer_load_dwordx4 v195, s[12:15], s37 offen offset:0 lds
    v_mfma_f32_16x16x32_bf16 v[64:67], a[0:3], a[40:43], 0
    ds_read_b128 a[92:95], v199 offset:13312
    v_mfma_f32_16x16x32_bf16 v[96:99], a[0:3], a[44:47], 0
    v_mfma_f32_16x16x32_bf16 v[128:131], a[0:3], a[48:51], 0
    ds_read_b128 a[96:99], v199 offset:14336
    v_mfma_f32_16x16x32_bf16 v[160:163], a[0:3], a[52:55], 0
    v_mfma_f32_16x16x32_bf16 v[4:7], a[4:7], a[32:35], 0
    ds_read_b128 a[100:103], v199 offset:15360
    v_mfma_f32_16x16x32_bf16 v[36:39], a[4:7], a[36:39], 0
    buffer_load_dwordx4 v196, s[12:15], s37 offen offset:1024 lds
    v_mfma_f32_16x16x32_bf16 v[68:71], a[4:7], a[40:43], 0
    ds_read_b128 a[104:107], v199 offset:16384
    v_mfma_f32_16x16x32_bf16 v[100:103], a[4:7], a[44:47], 0
    v_mfma_f32_16x16x32_bf16 v[132:135], a[4:7], a[48:51], 0
    ds_read_b128 a[108:111], v199 offset:17408
    v_mfma_f32_16x16x32_bf16 v[164:167], a[4:7], a[52:55], 0
    v_mfma_f32_16x16x32_bf16 v[8:11], a[8:11], a[32:35], 0
    ds_read_b64_tr_b16 a[56:57], v200 offset:16384
    v_mfma_f32_16x16x32_bf16 v[40:43], a[8:11], a[36:39], 0
    buffer_load_dwordx4 v197, s[12:15], s37 offen offset:2048 lds
    v_mfma_f32_16x16x32_bf16 v[72:75], a[8:11], a[40:43], 0
    ds_read_b64_tr_b16 a[58:59], v200 offset:18432
    v_mfma_f32_16x16x32_bf16 v[104:107], a[8:11], a[44:47], 0
    v_mfma_f32_16x16x32_bf16 v[136:139], a[8:11], a[48:51], 0
    ds_read_b64_tr_b16 a[60:61], v200 offset:16392
    v_mfma_f32_16x16x32_bf16 v[168:171], a[8:11], a[52:55], 0
    v_mfma_f32_16x16x32_bf16 v[12:15], a[12:15], a[32:35], 0
    ds_read_b64_tr_b16 a[62:63], v200 offset:18440
    v_mfma_f32_16x16x32_bf16 v[44:47], a[12:15], a[36:39], 0
    buffer_load_dwordx4 v198, s[12:15], s37 offen offset:3072 lds
    s_add_u32 m0, s38, 0
    s_add_u32 s37, s37, 262144
    v_mfma_f32_16x16x32_bf16 v[76:79], a[12:15], a[40:43], 0
    ds_read_b64_tr_b16 a[64:65], v201 offset:16384
    v_mfma_f32_16x16x32_bf16 v[108:111], a[12:15], a[44:47], 0
    v_mfma_f32_16x16x32_bf16 v[140:143], a[12:15], a[48:51], 0
    ds_read_b64_tr_b16 a[66:67], v201 offset:18432
    v_mfma_f32_16x16x32_bf16 v[172:175], a[12:15], a[52:55], 0
    v_mfma_f32_16x16x32_bf16 v[16:19], a[16:19], a[32:35], 0
    ds_read_b64_tr_b16 a[68:69], v201 offset:16392
    v_mfma_f32_16x16x32_bf16 v[48:51], a[16:19], a[36:39], 0
    v_mfma_f32_16x16x32_bf16 v[80:83], a[16:19], a[40:43], 0
    ds_read_b64_tr_b16 a[70:71], v201 offset:18440
    v_mfma_f32_16x16x32_bf16 v[112:115], a[16:19], a[44:47], 0
    buffer_load_dwordx4 v192, s[8:11], s36 offen offset:0 lds
    v_mfma_f32_16x16x32_bf16 v[144:147], a[16:19], a[48:51], 0
    ds_read_b64_tr_b16 a[72:73], v202 offset:16384
    v_mfma_f32_16x16x32_bf16 v[176:179], a[16:19], a[52:55], 0
    v_mfma_f32_16x16x32_bf16 v[20:23], a[20:23], a[32:35], 0
    ds_read_b64_tr_b16 a[74:75], v202 offset:18432
    v_mfma_f32_16x16x32_bf16 v[52:55], a[20:23], a[36:39], 0
    v_mfma_f32_16x16x32_bf16 v[84:87], a[20:23], a[40:43], 0
    ds_read_b64_tr_b16 a[76:77], v202 offset:16392
    v_mfma_f32_16x16x32_bf16 v[116:119], a[20:23], a[44:47], 0
    buffer_load_dwordx4 v193, s[8:11], s36 offen offset:1024 lds
    v_mfma_f32_16x16x32_bf16 v[148:151], a[20:23], a[48:51], 0
    ds_read_b64_tr_b16 a[78:79], v202 offset:18440
    v_mfma_f32_16x16x32_bf16 v[180:183], a[20:23], a[52:55], 0
    v_mfma_f32_16x16x32_bf16 v[24:27], a[24:27], a[32:35], 0
    ds_read_b64_tr_b16 a[80:81], v203 offset:16384
    v_mfma_f32_16x16x32_bf16 v[56:59], a[24:27], a[36:39], 0
    v_mfma_f32_16x16x32_bf16 v[88:91], a[24:27], a[40:43], 0
    ds_read_b64_tr_b16 a[82:83], v203 offset:18432
    v_mfma_f32_16x16x32_bf16 v[120:123], a[24:27], a[44:47], 0
    buffer_load_dwordx4 v194, s[8:11], s36 offen offset:2048 lds
    s_add_u32 s36, s36, 64
    v_mfma_f32_16x16x32_bf16 v[152:155], a[24:27], a[48:51], 0
    ds_read_b64_tr_b16 a[84:85], v203 offset:16392
    v_mfma_f32_16x16x32_bf16 v[184:187], a[24:27], a[52:55], 0
    v_mfma_f32_16x16x32_bf16 v[28:31], a[28:31], a[32:35], 0
    ds_read_b64_tr_b16 a[86:87], v203 offset:18440
    v_mfma_f32_16x16x32_bf16 v[60:63], a[28:31], a[36:39], 0
    v_mfma_f32_16x16x32_bf16 v[92:95], a[28:31], a[40:43], 0
    v_mfma_f32_16x16x32_bf16 v[124:127], a[28:31], a[44:47], 0
    v_mfma_f32_16x16x32_bf16 v[156:159], a[28:31], a[48:51], 0
    v_mfma_f32_16x16x32_bf16 v[188:191], a[28:31], a[52:55], 0
    s_waitcnt vmcnt(19)
    s_waitcnt lgkmcnt(0)
    s_barrier
    v_mfma_f32_16x16x32_bf16 v[0:3], a[56:59], a[88:91], v[0:3]
    ds_read_b128 a[32:35], v199 offset:24576
    v_mfma_f32_16x16x32_bf16 v[32:35], a[56:59], a[92:95], v[32:35]
    s_add_u32 m0, s39, 16384
    s_nop 0
    buffer_load_dwordx4 v195, s[12:15], s37 offen offset:0 lds
    v_mfma_f32_16x16x32_bf16 v[64:67], a[56:59], a[96:99], v[64:67]
    ds_read_b128 a[36:39], v199 offset:25600
    v_mfma_f32_16x16x32_bf16 v[96:99], a[56:59], a[100:103], v[96:99]
    v_mfma_f32_16x16x32_bf16 v[128:131], a[56:59], a[104:107], v[128:131]
    ds_read_b128 a[40:43], v199 offset:26624
    v_mfma_f32_16x16x32_bf16 v[160:163], a[56:59], a[108:111], v[160:163]
    v_mfma_f32_16x16x32_bf16 v[4:7], a[60:63], a[88:91], v[4:7]
    ds_read_b128 a[44:47], v199 offset:27648
    v_mfma_f32_16x16x32_bf16 v[36:39], a[60:63], a[92:95], v[36:39]
    buffer_load_dwordx4 v196, s[12:15], s37 offen offset:1024 lds
    v_mfma_f32_16x16x32_bf16 v[68:71], a[60:63], a[96:99], v[68:71]
    ds_read_b128 a[48:51], v199 offset:28672
    v_mfma_f32_16x16x32_bf16 v[100:103], a[60:63], a[100:103], v[100:103]
    v_mfma_f32_16x16x32_bf16 v[132:135], a[60:63], a[104:107], v[132:135]
    ds_read_b128 a[52:55], v199 offset:29696
    v_mfma_f32_16x16x32_bf16 v[164:167], a[60:63], a[108:111], v[164:167]
    v_mfma_f32_16x16x32_bf16 v[8:11], a[64:67], a[88:91], v[8:11]
    ds_read_b64_tr_b16 a[0:1], v200 offset:32768
    v_mfma_f32_16x16x32_bf16 v[40:43], a[64:67], a[92:95], v[40:43]
    buffer_load_dwordx4 v197, s[12:15], s37 offen offset:2048 lds
    v_mfma_f32_16x16x32_bf16 v[72:75], a[64:67], a[96:99], v[72:75]
    ds_read_b64_tr_b16 a[2:3], v200 offset:34816
    v_mfma_f32_16x16x32_bf16 v[104:107], a[64:67], a[100:103], v[104:107]
    v_mfma_f32_16x16x32_bf16 v[136:139], a[64:67], a[104:107], v[136:139]
    ds_read_b64_tr_b16 a[4:5], v200 offset:32776
    v_mfma_f32_16x16x32_bf16 v[168:171], a[64:67], a[108:111], v[168:171]
    v_mfma_f32_16x16x32_bf16 v[12:15], a[68:71], a[88:91], v[12:15]
    ds_read_b64_tr_b16 a[6:7], v200 offset:34824
    v_mfma_f32_16x16x32_bf16 v[44:47], a[68:71], a[92:95], v[44:47]
    buffer_load_dwordx4 v198, s[12:15], s37 offen offset:3072 lds
    s_add_u32 m0, s38, 12288
    s_add_u32 s37, s37, 262144
    v_mfma_f32_16x16x32_bf16 v[76:79], a[68:71], a[96:99], v[76:79]
    ds_read_b64_tr_b16 a[8:9], v201 offset:32768
    v_mfma_f32_16x16x32_bf16 v[108:111], a[68:71], a[100:103], v[108:111]
    v_mfma_f32_16x16x32_bf16 v[140:143], a[68:71], a[104:107], v[140:143]
    ds_read_b64_tr_b16 a[10:11], v201 offset:34816
    v_mfma_f32_16x16x32_bf16 v[172:175], a[68:71], a[108:111], v[172:175]
    v_mfma_f32_16x16x32_bf16 v[16:19], a[72:75], a[88:91], v[16:19]
    ds_read_b64_tr_b16 a[12:13], v201 offset:32776
    v_mfma_f32_16x16x32_bf16 v[48:51], a[72:75], a[92:95], v[48:51]
    v_mfma_f32_16x16x32_bf16 v[80:83], a[72:75], a[96:99], v[80:83]
    ds_read_b64_tr_b16 a[14:15], v201 offset:34824
    v_mfma_f32_16x16x32_bf16 v[112:115], a[72:75], a[100:103], v[112:115]
    buffer_load_dwordx4 v192, s[8:11], s36 offen offset:0 lds
    v_mfma_f32_16x16x32_bf16 v[144:147], a[72:75], a[104:107], v[144:147]
    ds_read_b64_tr_b16 a[16:17], v202 offset:32768
    v_mfma_f32_16x16x32_bf16 v[176:179], a[72:75], a[108:111], v[176:179]
    v_mfma_f32_16x16x32_bf16 v[20:23], a[76:79], a[88:91], v[20:23]
    ds_read_b64_tr_b16 a[18:19], v202 offset:34816
    v_mfma_f32_16x16x32_bf16 v[52:55], a[76:79], a[92:95], v[52:55]
    v_mfma_f32_16x16x32_bf16 v[84:87], a[76:79], a[96:99], v[84:87]
    ds_read_b64_tr_b16 a[20:21], v202 offset:32776
    v_mfma_f32_16x16x32_bf16 v[116:119], a[76:79], a[100:103], v[116:119]
    buffer_load_dwordx4 v193, s[8:11], s36 offen offset:1024 lds
    v_mfma_f32_16x16x32_bf16 v[148:151], a[76:79], a[104:107], v[148:151]
    ds_read_b64_tr_b16 a[22:23], v202 offset:34824
    v_mfma_f32_16x16x32_bf16 v[180:183], a[76:79], a[108:111], v[180:183]
    v_mfma_f32_16x16x32_bf16 v[24:27], a[80:83], a[88:91], v[24:27]
    ds_read_b64_tr_b16 a[24:25], v203 offset:32768
    v_mfma_f32_16x16x32_bf16 v[56:59], a[80:83], a[92:95], v[56:59]
    v_mfma_f32_16x16x32_bf16 v[88:91], a[80:83], a[96:99], v[88:91]
    ds_read_b64_tr_b16 a[26:27], v203 offset:34816
    v_mfma_f32_16x16x32_bf16 v[120:123], a[80:83], a[100:103], v[120:123]
    buffer_load_dwordx4 v194, s[8:11], s36 offen offset:2048 lds
    s_add_u32 s36, s36, 64
    v_mfma_f32_16x16x32_bf16 v[152:155], a[80:83], a[104:107], v[152:155]
    ds_read_b64_tr_b16 a[28:29], v203 offset:32776
    v_mfma_f32_16x16x32_bf16 v[184:187], a[80:83], a[108:111], v[184:187]
    v_mfma_f32_16x16x32_bf16 v[28:31], a[84:87], a[88:91], v[28:31]
    ds_read_b64_tr_b16 a[30:31], v203 offset:34824
    v_mfma_f32_16x16x32_bf16 v[60:63], a[84:87], a[92:95], v[60:63]
    v_mfma_f32_16x16x32_bf16 v[92:95], a[84:87], a[96:99], v[92:95]
    v_mfma_f32_16x16x32_bf16 v[124:127], a[84:87], a[100:103], v[124:127]
    v_mfma_f32_16x16x32_bf16 v[156:159], a[84:87], a[104:107], v[156:159]
    v_mfma_f32_16x16x32_bf16 v[188:191], a[84:87], a[108:111], v[188:191]
    s_waitcnt vmcnt(19)
    s_waitcnt lgkmcnt(0)
    s_barrier
    v_mfma_f32_16x16x32_bf16 v[0:3], a[0:3], a[32:35], v[0:3]
    ds_read_b128 a[88:91], v199 offset:36864
    v_mfma_f32_16x16x32_bf16 v[32:35], a[0:3], a[36:39], v[32:35]
    s_add_u32 m0, s39, 32768
    s_nop 0
    buffer_load_dwordx4 v195, s[12:15], s37 offen offset:0 lds
    v_mfma_f32_16x16x32_bf16 v[64:67], a[0:3], a[40:43], v[64:67]
    ds_read_b128 a[92:95], v199 offset:37888
    v_mfma_f32_16x16x32_bf16 v[96:99], a[0:3], a[44:47], v[96:99]
    v_mfma_f32_16x16x32_bf16 v[128:131], a[0:3], a[48:51], v[128:131]
    ds_read_b128 a[96:99], v199 offset:38912
    v_mfma_f32_16x16x32_bf16 v[160:163], a[0:3], a[52:55], v[160:163]
    v_mfma_f32_16x16x32_bf16 v[4:7], a[4:7], a[32:35], v[4:7]
    ds_read_b128 a[100:103], v199 offset:39936
    v_mfma_f32_16x16x32_bf16 v[36:39], a[4:7], a[36:39], v[36:39]
    buffer_load_dwordx4 v196, s[12:15], s37 offen offset:1024 lds
    v_mfma_f32_16x16x32_bf16 v[68:71], a[4:7], a[40:43], v[68:71]
    ds_read_b128 a[104:107], v199 offset:40960
    v_mfma_f32_16x16x32_bf16 v[100:103], a[4:7], a[44:47], v[100:103]
    v_mfma_f32_16x16x32_bf16 v[132:135], a[4:7], a[48:51], v[132:135]
    ds_read_b128 a[108:111], v199 offset:41984
    v_mfma_f32_16x16x32_bf16 v[164:167], a[4:7], a[52:55], v[164:167]
    v_mfma_f32_16x16x32_bf16 v[8:11], a[8:11], a[32:35], v[8:11]
    ds_read_b64_tr_b16 a[56:57], v200 offset:49152
    v_mfma_f32_16x16x32_bf16 v[40:43], a[8:11], a[36:39], v[40:43]
    buffer_load_dwordx4 v197, s[12:15], s37 offen offset:2048 lds
    v_mfma_f32_16x16x32_bf16 v[72:75], a[8:11], a[40:43], v[72:75]
    ds_read_b64_tr_b16 a[58:59], v200 offset:51200
    v_mfma_f32_16x16x32_bf16 v[104:107], a[8:11], a[44:47], v[104:107]
    v_mfma_f32_16x16x32_bf16 v[136:139], a[8:11], a[48:51], v[136:139]
    ds_read_b64_tr_b16 a[60:61], v200 offset:49160
    v_mfma_f32_16x16x32_bf16 v[168:171], a[8:11], a[52:55], v[168:171]
    v_mfma_f32_16x16x32_bf16 v[12:15], a[12:15], a[32:35], v[12:15]
    ds_read_b64_tr_b16 a[62:63], v200 offset:51208
    v_mfma_f32_16x16x32_bf16 v[44:47], a[12:15], a[36:39], v[44:47]
    buffer_load_dwordx4 v198, s[12:15], s37 offen offset:3072 lds
    s_add_u32 m0, s38, 24576
    s_add_u32 s37, s37, 262144
    v_mfma_f32_16x16x32_bf16 v[76:79], a[12:15], a[40:43], v[76:79]
    ds_read_b64_tr_b16 a[64:65], v201 offset:49152
    v_mfma_f32_16x16x32_bf16 v[108:111], a[12:15], a[44:47], v[108:111]
    v_mfma_f32_16x16x32_bf16 v[140:143], a[12:15], a[48:51], v[140:143]
    ds_read_b64_tr_b16 a[66:67], v201 offset:51200
    v_mfma_f32_16x16x32_bf16 v[172:175], a[12:15], a[52:55], v[172:175]
    v_mfma_f32_16x16x32_bf16 v[16:19], a[16:19], a[32:35], v[16:19]
    ds_read_b64_tr_b16 a[68:69], v201 offset:49160
    v_mfma_f32_16x16x32_bf16 v[48:51], a[16:19], a[36:39], v[48:51]
    v_mfma_f32_16x16x32_bf16 v[80:83], a[16:19], a[40:43], v[80:83]
    ds_read_b64_tr_b16 a[70:71], v201 offset:51208
    v_mfma_f32_16x16x32_bf16 v[112:115], a[16:19], a[44:47], v[112:115]
    buffer_load_dwordx4 v192, s[8:11], s36 offen offset:0 lds
    v_mfma_f32_16x16x32_bf16 v[144:147], a[16:19], a[48:51], v[144:147]
    ds_read_b64_tr_b16 a[72:73], v202 offset:49152
    v_mfma_f32_16x16x32_bf16 v[176:179], a[16:19], a[52:55], v[176:179]
    v_mfma_f32_16x16x32_bf16 v[20:23], a[20:23], a[32:35], v[20:23]
    ds_read_b64_tr_b16 a[74:75], v202 offset:51200
    v_mfma_f32_16x16x32_bf16 v[52:55], a[20:23], a[36:39], v[52:55]
    v_mfma_f32_16x16x32_bf16 v[84:87], a[20:23], a[40:43], v[84:87]
    ds_read_b64_tr_b16 a[76:77], v202 offset:49160
    v_mfma_f32_16x16x32_bf16 v[116:119], a[20:23], a[44:47], v[116:119]
    buffer_load_dwordx4 v193, s[8:11], s36 offen offset:1024 lds
    v_mfma_f32_16x16x32_bf16 v[148:151], a[20:23], a[48:51], v[148:151]
    ds_read_b64_tr_b16 a[78:79], v202 offset:51208
    v_mfma_f32_16x16x32_bf16 v[180:183], a[20:23], a[52:55], v[180:183]
    v_mfma_f32_16x16x32_bf16 v[24:27], a[24:27], a[32:35], v[24:27]
    ds_read_b64_tr_b16 a[80:81], v203 offset:49152
    v_mfma_f32_16x16x32_bf16 v[56:59], a[24:27], a[36:39], v[56:59]
    v_mfma_f32_16x16x32_bf16 v[88:91], a[24:27], a[40:43], v[88:91]
    ds_read_b64_tr_b16 a[82:83], v203 offset:51200
    v_mfma_f32_16x16x32_bf16 v[120:123], a[24:27], a[44:47], v[120:123]
    buffer_load_dwordx4 v194, s[8:11], s36 offen offset:2048 lds
    s_add_u32 s36, s36, 64
    v_mfma_f32_16x16x32_bf16 v[152:155], a[24:27], a[48:51], v[152:155]
    ds_read_b64_tr_b16 a[84:85], v203 offset:49160
    v_mfma_f32_16x16x32_bf16 v[184:187], a[24:27], a[52:55], v[184:187]
    v_mfma_f32_16x16x32_bf16 v[28:31], a[28:31], a[32:35], v[28:31]
    ds_read_b64_tr_b16 a[86:87], v203 offset:51208
    v_mfma_f32_16x16x32_bf16 v[60:63], a[28:31], a[36:39], v[60:63]
    v_mfma_f32_16x16x32_bf16 v[92:95], a[28:31], a[40:43], v[92:95]
    v_mfma_f32_16x16x32_bf16 v[124:127], a[28:31], a[44:47], v[124:127]
    v_mfma_f32_16x16x32_bf16 v[156:159], a[28:31], a[48:51], v[156:159]
    v_mfma_f32_16x16x32_bf16 v[188:191], a[28:31], a[52:55], v[188:191]
    s_waitcnt vmcnt(14)
    s_waitcnt lgkmcnt(0)
    s_barrier
    v_mfma_f32_16x16x32_bf16 v[0:3], a[56:59], a[88:91], v[0:3]
    ds_read_b128 a[32:35], v199 offset:0
    v_mfma_f32_16x16x32_bf16 v[32:35], a[56:59], a[92:95], v[32:35]
    s_add_u32 m0, s39, 49152
    s_nop 0
    buffer_load_dwordx4 v195, s[12:15], s37 offen offset:0 lds
    v_mfma_f32_16x16x32_bf16 v[64:67], a[56:59], a[96:99], v[64:67]
    ds_read_b128 a[36:39], v199 offset:1024
    v_mfma_f32_16x16x32_bf16 v[96:99], a[56:59], a[100:103], v[96:99]
    v_mfma_f32_16x16x32_bf16 v[128:131], a[56:59], a[104:107], v[128:131]
    ds_read_b128 a[40:43], v199 offset:2048
    v_mfma_f32_16x16x32_bf16 v[160:163], a[56:59], a[108:111], v[160:163]
    v_mfma_f32_16x16x32_bf16 v[4:7], a[60:63], a[88:91], v[4:7]
    ds_read_b128 a[44:47], v199 offset:3072
    v_mfma_f32_16x16x32_bf16 v[36:39], a[60:63], a[92:95], v[36:39]
    buffer_load_dwordx4 v196, s[12:15], s37 offen offset:1024 lds
    v_mfma_f32_16x16x32_bf16 v[68:71], a[60:63], a[96:99], v[68:71]
    ds_read_b128 a[48:51], v199 offset:4096
    v_mfma_f32_16x16x32_bf16 v[100:103], a[60:63], a[100:103], v[100:103]
    v_mfma_f32_16x16x32_bf16 v[132:135], a[60:63], a[104:107], v[132:135]
    ds_read_b128 a[52:55], v199 offset:5120
    v_mfma_f32_16x16x32_bf16 v[164:167], a[60:63], a[108:111], v[164:167]
    v_mfma_f32_16x16x32_bf16 v[8:11], a[64:67], a[88:91], v[8:11]
    ds_read_b64_tr_b16 a[0:1], v200 offset:0
    v_mfma_f32_16x16x32_bf16 v[40:43], a[64:67], a[92:95], v[40:43]
    buffer_load_dwordx4 v197, s[12:15], s37 offen offset:2048 lds
    v_mfma_f32_16x16x32_bf16 v[72:75], a[64:67], a[96:99], v[72:75]
    ds_read_b64_tr_b16 a[2:3], v200 offset:2048
    v_mfma_f32_16x16x32_bf16 v[104:107], a[64:67], a[100:103], v[104:107]
    v_mfma_f32_16x16x32_bf16 v[136:139], a[64:67], a[104:107], v[136:139]
    ds_read_b64_tr_b16 a[4:5], v200 offset:8
    v_mfma_f32_16x16x32_bf16 v[168:171], a[64:67], a[108:111], v[168:171]
    v_mfma_f32_16x16x32_bf16 v[12:15], a[68:71], a[88:91], v[12:15]
    ds_read_b64_tr_b16 a[6:7], v200 offset:2056
    v_mfma_f32_16x16x32_bf16 v[44:47], a[68:71], a[92:95], v[44:47]
    buffer_load_dwordx4 v198, s[12:15], s37 offen offset:3072 lds
    s_add_u32 m0, s38, 36864
    s_add_u32 s37, s37, 262144
    v_mfma_f32_16x16x32_bf16 v[76:79], a[68:71], a[96:99], v[76:79]
    ds_read_b64_tr_b16 a[8:9], v201 offset:0
    v_mfma_f32_16x16x32_bf16 v[108:111], a[68:71], a[100:103], v[108:111]
    v_mfma_f32_16x16x32_bf16 v[140:143], a[68:71], a[104:107], v[140:143]
    ds_read_b64_tr_b16 a[10:11], v201 offset:2048
    v_mfma_f32_16x16x32_bf16 v[172:175], a[68:71], a[108:111], v[172:175]
    v_mfma_f32_16x16x32_bf16 v[16:19], a[72:75], a[88:91], v[16:19]
    ds_read_b64_tr_b16 a[12:13], v201 offset:8
    v_mfma_f32_16x16x32_bf16 v[48:51], a[72:75], a[92:95], v[48:51]
    v_mfma_f32_16x16x32_bf16 v[80:83], a[72:75], a[96:99], v[80:83]
    ds_read_b64_tr_b16 a[14:15], v201 offset:2056
    v_mfma_f32_16x16x32_bf16 v[112:115], a[72:75], a[100:103], v[112:115]
    buffer_load_dwordx4 v192, s[8:11], s36 offen offset:0 lds
    v_mfma_f32_16x16x32_bf16 v[144:147], a[72:75], a[104:107], v[144:147]
    ds_read_b64_tr_b16 a[16:17], v202 offset:0
    v_mfma_f32_16x16x32_bf16 v[176:179], a[72:75], a[108:111], v[176:179]
    v_mfma_f32_16x16x32_bf16 v[20:23], a[76:79], a[88:91], v[20:23]
    ds_read_b64_tr_b16 a[18:19], v202 offset:2048
    v_mfma_f32_16x16x32_bf16 v[52:55], a[76:79], a[92:95], v[52:55]
    v_mfma_f32_16x16x32_bf16 v[84:87], a[76:79], a[96:99], v[84:87]
    ds_read_b64_tr_b16 a[20:21], v202 offset:8
    v_mfma_f32_16x16x32_bf16 v[116:119], a[76:79], a[100:103], v[116:119]
    buffer_load_dwordx4 v193, s[8:11], s36 offen offset:1024 lds
    v_mfma_f32_16x16x32_bf16 v[148:151], a[76:79], a[104:107], v[148:151]
    ds_read_b64_tr_b16 a[22:23], v202 offset:2056
    v_mfma_f32_16x16x32_bf16 v[180:183], a[76:79], a[108:111], v[180:183]
    v_mfma_f32_16x16x32_bf16 v[24:27], a[80:83], a[88:91], v[24:27]
    ds_read_b64_tr_b16 a[24:25], v203 offset:0
    v_mfma_f32_16x16x32_bf16 v[56:59], a[80:83], a[92:95], v[56:59]
    v_mfma_f32_16x16x32_bf16 v[88:91], a[80:83], a[96:99], v[88:91]
    ds_read_b64_tr_b16 a[26:27], v203 offset:2048
    v_mfma_f32_16x16x32_bf16 v[120:123], a[80:83], a[100:103], v[120:123]
    buffer_load_dwordx4 v194, s[8:11], s36 offen offset:2048 lds
    s_add_u32 s36, s36, 64
    v_mfma_f32_16x16x32_bf16 v[152:155], a[80:83], a[104:107], v[152:155]
    ds_read_b64_tr_b16 a[28:29], v203 offset:8
    v_mfma_f32_16x16x32_bf16 v[184:187], a[80:83], a[108:111], v[184:187]
    v_mfma_f32_16x16x32_bf16 v[28:31], a[84:87], a[88:91], v[28:31]
    ds_read_b64_tr_b16 a[30:31], v203 offset:2056
    v_mfma_f32_16x16x32_bf16 v[60:63], a[84:87], a[92:95], v[60:63]
    v_mfma_f32_16x16x32_bf16 v[92:95], a[84:87], a[96:99], v[92:95]
    v_mfma_f32_16x16x32_bf16 v[124:127], a[84:87], a[100:103], v[124:127]
    v_mfma_f32_16x16x32_bf16 v[156:159], a[84:87], a[104:107], v[156:159]
    v_mfma_f32_16x16x32_bf16 v[188:191], a[84:87], a[108:111], v[188:191]
    s_waitcnt vmcnt(14)
    s_waitcnt lgkmcnt(0)
    s_barrier
    v_mfma_f32_16x16x32_bf16 v[0:3], a[0:3], a[32:35], v[0:3]
    ds_read_b128 a[88:91], v199 offset:12288
    v_mfma_f32_16x16x32_bf16 v[32:35], a[0:3], a[36:39], v[32:35]
    s_add_u32 m0, s39, 0
    s_nop 0
    buffer_load_dwordx4 v195, s[12:15], s37 offen offset:0 lds
    v_mfma_f32_16x16x32_bf16 v[64:67], a[0:3], a[40:43], v[64:67]
    ds_read_b128 a[92:95], v199 offset:13312
    v_mfma_f32_16x16x32_bf16 v[96:99], a[0:3], a[44:47], v[96:99]
    v_mfma_f32_16x16x32_bf16 v[128:131], a[0:3], a[48:51], v[128:131]
    ds_read_b128 a[96:99], v199 offset:14336
    v_mfma_f32_16x16x32_bf16 v[160:163], a[0:3], a[52:55], v[160:163]
    buffer_load_dwordx4 v196, s[12:15], s37 offen offset:1024 lds
    v_mfma_f32_16x16x32_bf16 v[4:7], a[4:7], a[32:35], v[4:7]
    ds_read_b128 a[100:103], v199 offset:15360
    v_mfma_f32_16x16x32_bf16 v[36:39], a[4:7], a[36:39], v[36:39]
    v_mfma_f32_16x16x32_bf16 v[68:71], a[4:7], a[40:43], v[68:71]
    ds_read_b128 a[104:107], v199 offset:16384
    v_mfma_f32_16x16x32_bf16 v[100:103], a[4:7], a[44:47], v[100:103]
    buffer_load_dwordx4 v197, s[12:15], s37 offen offset:2048 lds
    v_mfma_f32_16x16x32_bf16 v[132:135], a[4:7], a[48:51], v[132:135]
    ds_read_b128 a[108:111], v199 offset:17408
    v_mfma_f32_16x16x32_bf16 v[164:167], a[4:7], a[52:55], v[164:167]
    v_mfma_f32_16x16x32_bf16 v[8:11], a[8:11], a[32:35], v[8:11]
    ds_read_b64_tr_b16 a[56:57], v200 offset:16384
    v_mfma_f32_16x16x32_bf16 v[40:43], a[8:11], a[36:39], v[40:43]
    buffer_load_dwordx4 v198, s[12:15], s37 offen offset:3072 lds
    s_add_u32 m0, s38, 0
    s_add_u32 s37, s37, 262144
    v_mfma_f32_16x16x32_bf16 v[72:75], a[8:11], a[40:43], v[72:75]
    ds_read_b64_tr_b16 a[58:59], v200 offset:18432
    v_mfma_f32_16x16x32_bf16 v[104:107], a[8:11], a[44:47], v[104:107]
    v_mfma_f32_16x16x32_bf16 v[136:139], a[8:11], a[48:51], v[136:139]
    ds_read_b64_tr_b16 a[60:61], v200 offset:16392
    v_mfma_f32_16x16x32_bf16 v[168:171], a[8:11], a[52:55], v[168:171]
    buffer_load_dwordx4 v192, s[8:11], s36 offen offset:0 lds
    v_mfma_f32_16x16x32_bf16 v[12:15], a[12:15], a[32:35], v[12:15]
    ds_read_b64_tr_b16 a[62:63], v200 offset:18440
    v_mfma_f32_16x16x32_bf16 v[44:47], a[12:15], a[36:39], v[44:47]
    v_mfma_f32_16x16x32_bf16 v[76:79], a[12:15], a[40:43], v[76:79]
    ds_read_b64_tr_b16 a[64:65], v201 offset:16384
    v_mfma_f32_16x16x32_bf16 v[108:111], a[12:15], a[44:47], v[108:111]
    buffer_load_dwordx4 v193, s[8:11], s36 offen offset:1024 lds
    v_mfma_f32_16x16x32_bf16 v[140:143], a[12:15], a[48:51], v[140:143]
    ds_read_b64_tr_b16 a[66:67], v201 offset:18432
    v_mfma_f32_16x16x32_bf16 v[172:175], a[12:15], a[52:55], v[172:175]
    v_mfma_f32_16x16x32_bf16 v[16:19], a[16:19], a[32:35], v[16:19]
    ds_read_b64_tr_b16 a[68:69], v201 offset:16392
    v_mfma_f32_16x16x32_bf16 v[48:51], a[16:19], a[36:39], v[48:51]
    buffer_load_dwordx4 v194, s[8:11], s36 offen offset:2048 lds
    s_add_u32 s36, s36, 64
    s_add_u32 m0, s24, 0
    v_mfma_f32_16x16x32_bf16 v[80:83], a[16:19], a[40:43], v[80:83]
    ds_read_b64_tr_b16 a[70:71], v201 offset:18440
    v_mfma_f32_16x16x32_bf16 v[112:115], a[16:19], a[44:47], v[112:115]
    v_mfma_f32_16x16x32_bf16 v[144:147], a[16:19], a[48:51], v[144:147]
    ds_read_b64_tr_b16 a[72:73], v202 offset:16384
    v_mfma_f32_16x16x32_bf16 v[176:179], a[16:19], a[52:55], v[176:179]
    buffer_load_dwordx4 v232, s[4:7], s28 offen offset:0 sc0 sc1 nt lds
    v_mfma_f32_16x16x32_bf16 v[20:23], a[20:23], a[32:35], v[20:23]
    ds_read_b64_tr_b16 a[74:75], v202 offset:18432
    v_mfma_f32_16x16x32_bf16 v[52:55], a[20:23], a[36:39], v[52:55]
    v_mfma_f32_16x16x32_bf16 v[84:87], a[20:23], a[40:43], v[84:87]
    ds_read_b64_tr_b16 a[76:77], v202 offset:16392
    v_mfma_f32_16x16x32_bf16 v[116:119], a[20:23], a[44:47], v[116:119]
    buffer_load_dwordx4 v232, s[4:7], s28 offen offset:1024 sc0 sc1 nt lds
    v_mfma_f32_16x16x32_bf16 v[148:151], a[20:23], a[48:51], v[148:151]
    ds_read_b64_tr_b16 a[78:79], v202 offset:18440
    v_mfma_f32_16x16x32_bf16 v[180:183], a[20:23], a[52:55], v[180:183]
    v_mfma_f32_16x16x32_bf16 v[24:27], a[24:27], a[32:35], v[24:27]
    ds_read_b64_tr_b16 a[80:81], v203 offset:16384
    v_mfma_f32_16x16x32_bf16 v[56:59], a[24:27], a[36:39], v[56:59]
    buffer_load_dwordx4 v233, s[4:7], s28 offen offset:2048 sc0 sc1 nt lds
    v_mfma_f32_16x16x32_bf16 v[88:91], a[24:27], a[40:43], v[88:91]
    ds_read_b64_tr_b16 a[82:83], v203 offset:18432
    v_mfma_f32_16x16x32_bf16 v[120:123], a[24:27], a[44:47], v[120:123]
    v_mfma_f32_16x16x32_bf16 v[152:155], a[24:27], a[48:51], v[152:155]
    ds_read_b64_tr_b16 a[84:85], v203 offset:16392
    v_mfma_f32_16x16x32_bf16 v[184:187], a[24:27], a[52:55], v[184:187]
    buffer_load_dwordx4 v233, s[4:7], s28 offen offset:3072 sc0 sc1 nt lds
    s_add_u32 s28, s28, 8192
    v_mfma_f32_16x16x32_bf16 v[28:31], a[28:31], a[32:35], v[28:31]
    ds_read_b64_tr_b16 a[86:87], v203 offset:18440
    v_mfma_f32_16x16x32_bf16 v[60:63], a[28:31], a[36:39], v[60:63]
    v_mfma_f32_16x16x32_bf16 v[92:95], a[28:31], a[40:43], v[92:95]
    v_mfma_f32_16x16x32_bf16 v[124:127], a[28:31], a[44:47], v[124:127]
    v_mfma_f32_16x16x32_bf16 v[156:159], a[28:31], a[48:51], v[156:159]
    v_mfma_f32_16x16x32_bf16 v[188:191], a[28:31], a[52:55], v[188:191]
    s_waitcnt vmcnt(18)
    s_waitcnt lgkmcnt(0)
    s_barrier
    v_mfma_f32_16x16x32_bf16 v[0:3], a[56:59], a[88:91], v[0:3]
    ds_read_b128 a[32:35], v199 offset:24576
    v_mfma_f32_16x16x32_bf16 v[32:35], a[56:59], a[92:95], v[32:35]
    s_add_u32 m0, s39, 16384
    s_nop 0
    buffer_load_dwordx4 v195, s[12:15], s37 offen offset:0 lds
    v_mfma_f32_16x16x32_bf16 v[64:67], a[56:59], a[96:99], v[64:67]
    ds_read_b128 a[36:39], v199 offset:25600
    v_mfma_f32_16x16x32_bf16 v[96:99], a[56:59], a[100:103], v[96:99]
    v_mfma_f32_16x16x32_bf16 v[128:131], a[56:59], a[104:107], v[128:131]
    ds_read_b128 a[40:43], v199 offset:26624
    v_mfma_f32_16x16x32_bf16 v[160:163], a[56:59], a[108:111], v[160:163]
    v_mfma_f32_16x16x32_bf16 v[4:7], a[60:63], a[88:91], v[4:7]
    ds_read_b128 a[44:47], v199 offset:27648
    v_mfma_f32_16x16x32_bf16 v[36:39], a[60:63], a[92:95], v[36:39]
    buffer_load_dwordx4 v196, s[12:15], s37 offen offset:1024 lds
    v_mfma_f32_16x16x32_bf16 v[68:71], a[60:63], a[96:99], v[68:71]
    ds_read_b128 a[48:51], v199 offset:28672
    v_mfma_f32_16x16x32_bf16 v[100:103], a[60:63], a[100:103], v[100:103]
    v_mfma_f32_16x16x32_bf16 v[132:135], a[60:63], a[104:107], v[132:135]
    ds_read_b128 a[52:55], v199 offset:29696
    v_mfma_f32_16x16x32_bf16 v[164:167], a[60:63], a[108:111], v[164:167]
    v_mfma_f32_16x16x32_bf16 v[8:11], a[64:67], a[88:91], v[8:11]
    ds_read_b64_tr_b16 a[0:1], v200 offset:32768
    v_mfma_f32_16x16x32_bf16 v[40:43], a[64:67], a[92:95], v[40:43]
    buffer_load_dwordx4 v197, s[12:15], s37 offen offset:2048 lds
    v_mfma_f32_16x16x32_bf16 v[72:75], a[64:67], a[96:99], v[72:75]
    ds_read_b64_tr_b16 a[2:3], v200 offset:34816
    v_mfma_f32_16x16x32_bf16 v[104:107], a[64:67], a[100:103], v[104:107]
    v_mfma_f32_16x16x32_bf16 v[136:139], a[64:67], a[104:107], v[136:139]
    ds_read_b64_tr_b16 a[4:5], v200 offset:32776
    v_mfma_f32_16x16x32_bf16 v[168:171], a[64:67], a[108:111], v[168:171]
    v_mfma_f32_16x16x32_bf16 v[12:15], a[68:71], a[88:91], v[12:15]
    ds_read_b64_tr_b16 a[6:7], v200 offset:34824
    v_mfma_f32_16x16x32_bf16 v[44:47], a[68:71], a[92:95], v[44:47]
    buffer_load_dwordx4 v198, s[12:15], s37 offen offset:3072 lds
    s_add_u32 m0, s38, 12288
    s_add_u32 s37, s37, 262144
    v_mfma_f32_16x16x32_bf16 v[76:79], a[68:71], a[96:99], v[76:79]
    ds_read_b64_tr_b16 a[8:9], v201 offset:32768
    v_mfma_f32_16x16x32_bf16 v[108:111], a[68:71], a[100:103], v[108:111]
    v_mfma_f32_16x16x32_bf16 v[140:143], a[68:71], a[104:107], v[140:143]
    ds_read_b64_tr_b16 a[10:11], v201 offset:34816
    v_mfma_f32_16x16x32_bf16 v[172:175], a[68:71], a[108:111], v[172:175]
    v_mfma_f32_16x16x32_bf16 v[16:19], a[72:75], a[88:91], v[16:19]
    ds_read_b64_tr_b16 a[12:13], v201 offset:32776
    v_mfma_f32_16x16x32_bf16 v[48:51], a[72:75], a[92:95], v[48:51]
    v_mfma_f32_16x16x32_bf16 v[80:83], a[72:75], a[96:99], v[80:83]
    ds_read_b64_tr_b16 a[14:15], v201 offset:34824
    v_mfma_f32_16x16x32_bf16 v[112:115], a[72:75], a[100:103], v[112:115]
    buffer_load_dwordx4 v192, s[8:11], s36 offen offset:0 lds
    v_mfma_f32_16x16x32_bf16 v[144:147], a[72:75], a[104:107], v[144:147]
    ds_read_b64_tr_b16 a[16:17], v202 offset:32768
    v_mfma_f32_16x16x32_bf16 v[176:179], a[72:75], a[108:111], v[176:179]
    v_mfma_f32_16x16x32_bf16 v[20:23], a[76:79], a[88:91], v[20:23]
    ds_read_b64_tr_b16 a[18:19], v202 offset:34816
    v_mfma_f32_16x16x32_bf16 v[52:55], a[76:79], a[92:95], v[52:55]
    v_mfma_f32_16x16x32_bf16 v[84:87], a[76:79], a[96:99], v[84:87]
    ds_read_b64_tr_b16 a[20:21], v202 offset:32776
    v_mfma_f32_16x16x32_bf16 v[116:119], a[76:79], a[100:103], v[116:119]
    buffer_load_dwordx4 v193, s[8:11], s36 offen offset:1024 lds
    v_mfma_f32_16x16x32_bf16 v[148:151], a[76:79], a[104:107], v[148:151]
    ds_read_b64_tr_b16 a[22:23], v202 offset:34824
    v_mfma_f32_16x16x32_bf16 v[180:183], a[76:79], a[108:111], v[180:183]
    v_mfma_f32_16x16x32_bf16 v[24:27], a[80:83], a[88:91], v[24:27]
    ds_read_b64_tr_b16 a[24:25], v203 offset:32768
    v_mfma_f32_16x16x32_bf16 v[56:59], a[80:83], a[92:95], v[56:59]
    v_mfma_f32_16x16x32_bf16 v[88:91], a[80:83], a[96:99], v[88:91]
    ds_read_b64_tr_b16 a[26:27], v203 offset:34816
    v_mfma_f32_16x16x32_bf16 v[120:123], a[80:83], a[100:103], v[120:123]
    buffer_load_dwordx4 v194, s[8:11], s36 offen offset:2048 lds
    s_add_u32 s36, s36, 64
    v_mfma_f32_16x16x32_bf16 v[152:155], a[80:83], a[104:107], v[152:155]
    ds_read_b64_tr_b16 a[28:29], v203 offset:32776
    v_mfma_f32_16x16x32_bf16 v[184:187], a[80:83], a[108:111], v[184:187]
    v_mfma_f32_16x16x32_bf16 v[28:31], a[84:87], a[88:91], v[28:31]
    ds_read_b64_tr_b16 a[30:31], v203 offset:34824
    v_mfma_f32_16x16x32_bf16 v[60:63], a[84:87], a[92:95], v[60:63]
    v_mfma_f32_16x16x32_bf16 v[92:95], a[84:87], a[96:99], v[92:95]
    v_mfma_f32_16x16x32_bf16 v[124:127], a[84:87], a[100:103], v[124:127]
    v_mfma_f32_16x16x32_bf16 v[156:159], a[84:87], a[104:107], v[156:159]
    v_mfma_f32_16x16x32_bf16 v[188:191], a[84:87], a[108:111], v[188:191]
    s_waitcnt vmcnt(18)
    s_waitcnt lgkmcnt(0)
    s_barrier
    v_mfma_f32_16x16x32_bf16 v[0:3], a[0:3], a[32:35], v[0:3]
    ds_read_b128 a[88:91], v199 offset:36864
    v_mfma_f32_16x16x32_bf16 v[32:35], a[0:3], a[36:39], v[32:35]
    s_add_u32 m0, s39, 32768
    s_nop 0
    buffer_load_dwordx4 v195, s[12:15], s37 offen offset:0 lds
    v_mfma_f32_16x16x32_bf16 v[64:67], a[0:3], a[40:43], v[64:67]
    ds_read_b128 a[92:95], v199 offset:37888
    v_mfma_f32_16x16x32_bf16 v[96:99], a[0:3], a[44:47], v[96:99]
    v_mfma_f32_16x16x32_bf16 v[128:131], a[0:3], a[48:51], v[128:131]
    ds_read_b128 a[96:99], v199 offset:38912
    v_mfma_f32_16x16x32_bf16 v[160:163], a[0:3], a[52:55], v[160:163]
    buffer_load_dwordx4 v196, s[12:15], s37 offen offset:1024 lds
    v_mfma_f32_16x16x32_bf16 v[4:7], a[4:7], a[32:35], v[4:7]
    ds_read_b128 a[100:103], v199 offset:39936
    v_mfma_f32_16x16x32_bf16 v[36:39], a[4:7], a[36:39], v[36:39]
    v_mfma_f32_16x16x32_bf16 v[68:71], a[4:7], a[40:43], v[68:71]
    ds_read_b128 a[104:107], v199 offset:40960
    v_mfma_f32_16x16x32_bf16 v[100:103], a[4:7], a[44:47], v[100:103]
    buffer_load_dwordx4 v197, s[12:15], s37 offen offset:2048 lds
    v_mfma_f32_16x16x32_bf16 v[132:135], a[4:7], a[48:51], v[132:135]
    ds_read_b128 a[108:111], v199 offset:41984
    v_mfma_f32_16x16x32_bf16 v[164:167], a[4:7], a[52:55], v[164:167]
    v_mfma_f32_16x16x32_bf16 v[8:11], a[8:11], a[32:35], v[8:11]
    ds_read_b64_tr_b16 a[56:57], v200 offset:49152
    v_mfma_f32_16x16x32_bf16 v[40:43], a[8:11], a[36:39], v[40:43]
    buffer_load_dwordx4 v198, s[12:15], s37 offen offset:3072 lds
    s_add_u32 m0, s38, 24576
    s_add_u32 s37, s37, 262144
    v_mfma_f32_16x16x32_bf16 v[72:75], a[8:11], a[40:43], v[72:75]
    ds_read_b64_tr_b16 a[58:59], v200 offset:51200
    v_mfma_f32_16x16x32_bf16 v[104:107], a[8:11], a[44:47], v[104:107]
    v_mfma_f32_16x16x32_bf16 v[136:139], a[8:11], a[48:51], v[136:139]
    ds_read_b64_tr_b16 a[60:61], v200 offset:49160
    v_mfma_f32_16x16x32_bf16 v[168:171], a[8:11], a[52:55], v[168:171]
    buffer_load_dwordx4 v192, s[8:11], s36 offen offset:0 lds
    v_mfma_f32_16x16x32_bf16 v[12:15], a[12:15], a[32:35], v[12:15]
    ds_read_b64_tr_b16 a[62:63], v200 offset:51208
    v_mfma_f32_16x16x32_bf16 v[44:47], a[12:15], a[36:39], v[44:47]
    v_mfma_f32_16x16x32_bf16 v[76:79], a[12:15], a[40:43], v[76:79]
    ds_read_b64_tr_b16 a[64:65], v201 offset:49152
    v_mfma_f32_16x16x32_bf16 v[108:111], a[12:15], a[44:47], v[108:111]
    buffer_load_dwordx4 v193, s[8:11], s36 offen offset:1024 lds
    v_mfma_f32_16x16x32_bf16 v[140:143], a[12:15], a[48:51], v[140:143]
    ds_read_b64_tr_b16 a[66:67], v201 offset:51200
    v_mfma_f32_16x16x32_bf16 v[172:175], a[12:15], a[52:55], v[172:175]
    v_mfma_f32_16x16x32_bf16 v[16:19], a[16:19], a[32:35], v[16:19]
    ds_read_b64_tr_b16 a[68:69], v201 offset:49160
    v_mfma_f32_16x16x32_bf16 v[48:51], a[16:19], a[36:39], v[48:51]
    buffer_load_dwordx4 v194, s[8:11], s36 offen offset:2048 lds
    s_add_u32 s36, s36, 64
    s_add_u32 m0, s25, 49152
    v_mfma_f32_16x16x32_bf16 v[80:83], a[16:19], a[40:43], v[80:83]
    ds_read_b64_tr_b16 a[70:71], v201 offset:51208
    v_mfma_f32_16x16x32_bf16 v[112:115], a[16:19], a[44:47], v[112:115]
    v_mfma_f32_16x16x32_bf16 v[144:147], a[16:19], a[48:51], v[144:147]
    ds_read_b64_tr_b16 a[72:73], v202 offset:49152
    v_mfma_f32_16x16x32_bf16 v[176:179], a[16:19], a[52:55], v[176:179]
    buffer_load_dwordx4 v234, s[76:79], s29 offen offset:0 sc0 sc1 nt lds
    v_mfma_f32_16x16x32_bf16 v[20:23], a[20:23], a[32:35], v[20:23]
    ds_read_b64_tr_b16 a[74:75], v202 offset:51200
    v_mfma_f32_16x16x32_bf16 v[52:55], a[20:23], a[36:39], v[52:55]
    v_mfma_f32_16x16x32_bf16 v[84:87], a[20:23], a[40:43], v[84:87]
    ds_read_b64_tr_b16 a[76:77], v202 offset:49160
    v_mfma_f32_16x16x32_bf16 v[116:119], a[20:23], a[44:47], v[116:119]
    buffer_load_dwordx4 v234, s[76:79], s29 offen offset:1024 sc0 sc1 nt lds
    v_mfma_f32_16x16x32_bf16 v[148:151], a[20:23], a[48:51], v[148:151]
    ds_read_b64_tr_b16 a[78:79], v202 offset:51208
    v_mfma_f32_16x16x32_bf16 v[180:183], a[20:23], a[52:55], v[180:183]
    v_mfma_f32_16x16x32_bf16 v[24:27], a[24:27], a[32:35], v[24:27]
    ds_read_b64_tr_b16 a[80:81], v203 offset:49152
    v_mfma_f32_16x16x32_bf16 v[56:59], a[24:27], a[36:39], v[56:59]
    buffer_load_dwordx4 v235, s[76:79], s29 offen offset:2048 sc0 sc1 nt lds
    v_mfma_f32_16x16x32_bf16 v[88:91], a[24:27], a[40:43], v[88:91]
    ds_read_b64_tr_b16 a[82:83], v203 offset:51200
    v_mfma_f32_16x16x32_bf16 v[120:123], a[24:27], a[44:47], v[120:123]
    v_mfma_f32_16x16x32_bf16 v[152:155], a[24:27], a[48:51], v[152:155]
    ds_read_b64_tr_b16 a[84:85], v203 offset:49160
    v_mfma_f32_16x16x32_bf16 v[184:187], a[24:27], a[52:55], v[184:187]
    buffer_load_dwordx4 v235, s[76:79], s29 offen offset:3072 sc0 sc1 nt lds
    s_add_u32 s29, s29, 8192
    v_mfma_f32_16x16x32_bf16 v[28:31], a[28:31], a[32:35], v[28:31]
    ds_read_b64_tr_b16 a[86:87], v203 offset:51208
    v_mfma_f32_16x16x32_bf16 v[60:63], a[28:31], a[36:39], v[60:63]
    v_mfma_f32_16x16x32_bf16 v[92:95], a[28:31], a[40:43], v[92:95]
    v_mfma_f32_16x16x32_bf16 v[124:127], a[28:31], a[44:47], v[124:127]
    v_mfma_f32_16x16x32_bf16 v[156:159], a[28:31], a[48:51], v[156:159]
    v_mfma_f32_16x16x32_bf16 v[188:191], a[28:31], a[52:55], v[188:191]
    s_waitcnt vmcnt(22)
    s_waitcnt lgkmcnt(0)
    s_barrier
    v_mfma_f32_16x16x32_bf16 v[0:3], a[56:59], a[88:91], v[0:3]
    ds_read_b128 a[32:35], v199 offset:0
    v_mfma_f32_16x16x32_bf16 v[32:35], a[56:59], a[92:95], v[32:35]
    s_add_u32 m0, s39, 49152
    s_nop 0
    buffer_load_dwordx4 v195, s[12:15], s37 offen offset:0 lds
    v_mfma_f32_16x16x32_bf16 v[64:67], a[56:59], a[96:99], v[64:67]
    ds_read_b128 a[36:39], v199 offset:1024
    v_mfma_f32_16x16x32_bf16 v[96:99], a[56:59], a[100:103], v[96:99]
    v_mfma_f32_16x16x32_bf16 v[128:131], a[56:59], a[104:107], v[128:131]
    ds_read_b128 a[40:43], v199 offset:2048
    v_mfma_f32_16x16x32_bf16 v[160:163], a[56:59], a[108:111], v[160:163]
    v_mfma_f32_16x16x32_bf16 v[4:7], a[60:63], a[88:91], v[4:7]
    ds_read_b128 a[44:47], v199 offset:3072
    v_mfma_f32_16x16x32_bf16 v[36:39], a[60:63], a[92:95], v[36:39]
    buffer_load_dwordx4 v196, s[12:15], s37 offen offset:1024 lds
    v_mfma_f32_16x16x32_bf16 v[68:71], a[60:63], a[96:99], v[68:71]
    ds_read_b128 a[48:51], v199 offset:4096
    v_mfma_f32_16x16x32_bf16 v[100:103], a[60:63], a[100:103], v[100:103]
    v_mfma_f32_16x16x32_bf16 v[132:135], a[60:63], a[104:107], v[132:135]
    ds_read_b128 a[52:55], v199 offset:5120
    v_mfma_f32_16x16x32_bf16 v[164:167], a[60:63], a[108:111], v[164:167]
    v_mfma_f32_16x16x32_bf16 v[8:11], a[64:67], a[88:91], v[8:11]
    ds_read_b64_tr_b16 a[0:1], v200 offset:0
    v_mfma_f32_16x16x32_bf16 v[40:43], a[64:67], a[92:95], v[40:43]
    buffer_load_dwordx4 v197, s[12:15], s37 offen offset:2048 lds
    v_mfma_f32_16x16x32_bf16 v[72:75], a[64:67], a[96:99], v[72:75]
    ds_read_b64_tr_b16 a[2:3], v200 offset:2048
    v_mfma_f32_16x16x32_bf16 v[104:107], a[64:67], a[100:103], v[104:107]
    v_mfma_f32_16x16x32_bf16 v[136:139], a[64:67], a[104:107], v[136:139]
    ds_read_b64_tr_b16 a[4:5], v200 offset:8
    v_mfma_f32_16x16x32_bf16 v[168:171], a[64:67], a[108:111], v[168:171]
    v_mfma_f32_16x16x32_bf16 v[12:15], a[68:71], a[88:91], v[12:15]
    ds_read_b64_tr_b16 a[6:7], v200 offset:2056
    v_mfma_f32_16x16x32_bf16 v[44:47], a[68:71], a[92:95], v[44:47]
    buffer_load_dwordx4 v198, s[12:15], s37 offen offset:3072 lds
    s_add_u32 m0, s38, 36864
    s_add_u32 s37, s37, 262144
    v_mfma_f32_16x16x32_bf16 v[76:79], a[68:71], a[96:99], v[76:79]
    ds_read_b64_tr_b16 a[8:9], v201 offset:0
    v_mfma_f32_16x16x32_bf16 v[108:111], a[68:71], a[100:103], v[108:111]
    v_mfma_f32_16x16x32_bf16 v[140:143], a[68:71], a[104:107], v[140:143]
    ds_read_b64_tr_b16 a[10:11], v201 offset:2048
    v_mfma_f32_16x16x32_bf16 v[172:175], a[68:71], a[108:111], v[172:175]
    v_mfma_f32_16x16x32_bf16 v[16:19], a[72:75], a[88:91], v[16:19]
    ds_read_b64_tr_b16 a[12:13], v201 offset:8
    v_mfma_f32_16x16x32_bf16 v[48:51], a[72:75], a[92:95], v[48:51]
    v_mfma_f32_16x16x32_bf16 v[80:83], a[72:75], a[96:99], v[80:83]
    ds_read_b64_tr_b16 a[14:15], v201 offset:2056
    v_mfma_f32_16x16x32_bf16 v[112:115], a[72:75], a[100:103], v[112:115]
    buffer_load_dwordx4 v192, s[8:11], s36 offen offset:0 lds
    v_mfma_f32_16x16x32_bf16 v[144:147], a[72:75], a[104:107], v[144:147]
    ds_read_b64_tr_b16 a[16:17], v202 offset:0
    v_mfma_f32_16x16x32_bf16 v[176:179], a[72:75], a[108:111], v[176:179]
    v_mfma_f32_16x16x32_bf16 v[20:23], a[76:79], a[88:91], v[20:23]
    ds_read_b64_tr_b16 a[18:19], v202 offset:2048
    v_mfma_f32_16x16x32_bf16 v[52:55], a[76:79], a[92:95], v[52:55]
    v_mfma_f32_16x16x32_bf16 v[84:87], a[76:79], a[96:99], v[84:87]
    ds_read_b64_tr_b16 a[20:21], v202 offset:8
    v_mfma_f32_16x16x32_bf16 v[116:119], a[76:79], a[100:103], v[116:119]
    buffer_load_dwordx4 v193, s[8:11], s36 offen offset:1024 lds
    v_mfma_f32_16x16x32_bf16 v[148:151], a[76:79], a[104:107], v[148:151]
    ds_read_b64_tr_b16 a[22:23], v202 offset:2056
    v_mfma_f32_16x16x32_bf16 v[180:183], a[76:79], a[108:111], v[180:183]
    v_mfma_f32_16x16x32_bf16 v[24:27], a[80:83], a[88:91], v[24:27]
    ds_read_b64_tr_b16 a[24:25], v203 offset:0
    v_mfma_f32_16x16x32_bf16 v[56:59], a[80:83], a[92:95], v[56:59]
    v_mfma_f32_16x16x32_bf16 v[88:91], a[80:83], a[96:99], v[88:91]
    ds_read_b64_tr_b16 a[26:27], v203 offset:2048
    v_mfma_f32_16x16x32_bf16 v[120:123], a[80:83], a[100:103], v[120:123]
    buffer_load_dwordx4 v194, s[8:11], s36 offen offset:2048 lds
    s_add_u32 s36, s36, 64
    v_mfma_f32_16x16x32_bf16 v[152:155], a[80:83], a[104:107], v[152:155]
    ds_read_b64_tr_b16 a[28:29], v203 offset:8
    v_mfma_f32_16x16x32_bf16 v[184:187], a[80:83], a[108:111], v[184:187]
    v_mfma_f32_16x16x32_bf16 v[28:31], a[84:87], a[88:91], v[28:31]
    ds_read_b64_tr_b16 a[30:31], v203 offset:2056
    v_mfma_f32_16x16x32_bf16 v[60:63], a[84:87], a[92:95], v[60:63]
    v_mfma_f32_16x16x32_bf16 v[92:95], a[84:87], a[96:99], v[92:95]
    v_mfma_f32_16x16x32_bf16 v[124:127], a[84:87], a[100:103], v[124:127]
    v_mfma_f32_16x16x32_bf16 v[156:159], a[84:87], a[104:107], v[156:159]
    v_mfma_f32_16x16x32_bf16 v[188:191], a[84:87], a[108:111], v[188:191]
    s_waitcnt vmcnt(18)
    s_waitcnt lgkmcnt(0)
    s_barrier
    v_mfma_f32_16x16x32_bf16 v[0:3], a[0:3], a[32:35], v[0:3]
    ds_read_b128 a[88:91], v199 offset:12288
    v_mfma_f32_16x16x32_bf16 v[32:35], a[0:3], a[36:39], v[32:35]
    s_add_u32 m0, s39, 0
    s_nop 0
    buffer_load_dwordx4 v195, s[12:15], s37 offen offset:0 lds
    v_mfma_f32_16x16x32_bf16 v[64:67], a[0:3], a[40:43], v[64:67]
    ds_read_b128 a[92:95], v199 offset:13312
    v_mfma_f32_16x16x32_bf16 v[96:99], a[0:3], a[44:47], v[96:99]
    v_mfma_f32_16x16x32_bf16 v[128:131], a[0:3], a[48:51], v[128:131]
    ds_read_b128 a[96:99], v199 offset:14336
    v_mfma_f32_16x16x32_bf16 v[160:163], a[0:3], a[52:55], v[160:163]
    buffer_load_dwordx4 v196, s[12:15], s37 offen offset:1024 lds
    v_mfma_f32_16x16x32_bf16 v[4:7], a[4:7], a[32:35], v[4:7]
    ds_read_b128 a[100:103], v199 offset:15360
    v_mfma_f32_16x16x32_bf16 v[36:39], a[4:7], a[36:39], v[36:39]
    v_mfma_f32_16x16x32_bf16 v[68:71], a[4:7], a[40:43], v[68:71]
    ds_read_b128 a[104:107], v199 offset:16384
    v_mfma_f32_16x16x32_bf16 v[100:103], a[4:7], a[44:47], v[100:103]
    buffer_load_dwordx4 v197, s[12:15], s37 offen offset:2048 lds
    v_mfma_f32_16x16x32_bf16 v[132:135], a[4:7], a[48:51], v[132:135]
    ds_read_b128 a[108:111], v199 offset:17408
    v_mfma_f32_16x16x32_bf16 v[164:167], a[4:7], a[52:55], v[164:167]
    v_mfma_f32_16x16x32_bf16 v[8:11], a[8:11], a[32:35], v[8:11]
    ds_read_b64_tr_b16 a[56:57], v200 offset:16384
    v_mfma_f32_16x16x32_bf16 v[40:43], a[8:11], a[36:39], v[40:43]
    buffer_load_dwordx4 v198, s[12:15], s37 offen offset:3072 lds
    s_add_u32 m0, s38, 0
    s_add_u32 s37, s37, 262144
    v_mfma_f32_16x16x32_bf16 v[72:75], a[8:11], a[40:43], v[72:75]
    ds_read_b64_tr_b16 a[58:59], v200 offset:18432
    v_mfma_f32_16x16x32_bf16 v[104:107], a[8:11], a[44:47], v[104:107]
    v_mfma_f32_16x16x32_bf16 v[136:139], a[8:11], a[48:51], v[136:139]
    ds_read_b64_tr_b16 a[60:61], v200 offset:16392
    v_mfma_f32_16x16x32_bf16 v[168:171], a[8:11], a[52:55], v[168:171]
    buffer_load_dwordx4 v192, s[8:11], s36 offen offset:0 lds
    v_mfma_f32_16x16x32_bf16 v[12:15], a[12:15], a[32:35], v[12:15]
    ds_read_b64_tr_b16 a[62:63], v200 offset:18440
    v_mfma_f32_16x16x32_bf16 v[44:47], a[12:15], a[36:39], v[44:47]
    v_mfma_f32_16x16x32_bf16 v[76:79], a[12:15], a[40:43], v[76:79]
    ds_read_b64_tr_b16 a[64:65], v201 offset:16384
    v_mfma_f32_16x16x32_bf16 v[108:111], a[12:15], a[44:47], v[108:111]
    buffer_load_dwordx4 v193, s[8:11], s36 offen offset:1024 lds
    v_mfma_f32_16x16x32_bf16 v[140:143], a[12:15], a[48:51], v[140:143]
    ds_read_b64_tr_b16 a[66:67], v201 offset:18432
    v_mfma_f32_16x16x32_bf16 v[172:175], a[12:15], a[52:55], v[172:175]
    v_mfma_f32_16x16x32_bf16 v[16:19], a[16:19], a[32:35], v[16:19]
    ds_read_b64_tr_b16 a[68:69], v201 offset:16392
    v_mfma_f32_16x16x32_bf16 v[48:51], a[16:19], a[36:39], v[48:51]
    buffer_load_dwordx4 v194, s[8:11], s36 offen offset:2048 lds
    s_add_u32 s36, s36, 64
    s_add_u32 m0, s24, 16384
    v_mfma_f32_16x16x32_bf16 v[80:83], a[16:19], a[40:43], v[80:83]
    ds_read_b64_tr_b16 a[70:71], v201 offset:18440
    v_mfma_f32_16x16x32_bf16 v[112:115], a[16:19], a[44:47], v[112:115]
    v_mfma_f32_16x16x32_bf16 v[144:147], a[16:19], a[48:51], v[144:147]
    ds_read_b64_tr_b16 a[72:73], v202 offset:16384
    v_mfma_f32_16x16x32_bf16 v[176:179], a[16:19], a[52:55], v[176:179]
    buffer_load_dwordx4 v232, s[4:7], s28 offen offset:0 sc0 sc1 nt lds
    v_mfma_f32_16x16x32_bf16 v[20:23], a[20:23], a[32:35], v[20:23]
    ds_read_b64_tr_b16 a[74:75], v202 offset:18432
    v_mfma_f32_16x16x32_bf16 v[52:55], a[20:23], a[36:39], v[52:55]
    v_mfma_f32_16x16x32_bf16 v[84:87], a[20:23], a[40:43], v[84:87]
    ds_read_b64_tr_b16 a[76:77], v202 offset:16392
    v_mfma_f32_16x16x32_bf16 v[116:119], a[20:23], a[44:47], v[116:119]
    buffer_load_dwordx4 v232, s[4:7], s28 offen offset:1024 sc0 sc1 nt lds
    v_mfma_f32_16x16x32_bf16 v[148:151], a[20:23], a[48:51], v[148:151]
    ds_read_b64_tr_b16 a[78:79], v202 offset:18440
    v_mfma_f32_16x16x32_bf16 v[180:183], a[20:23], a[52:55], v[180:183]
    v_mfma_f32_16x16x32_bf16 v[24:27], a[24:27], a[32:35], v[24:27]
    ds_read_b64_tr_b16 a[80:81], v203 offset:16384
    v_mfma_f32_16x16x32_bf16 v[56:59], a[24:27], a[36:39], v[56:59]
    buffer_load_dwordx4 v233, s[4:7], s28 offen offset:2048 sc0 sc1 nt lds
    v_mfma_f32_16x16x32_bf16 v[88:91], a[24:27], a[40:43], v[88:91]
    ds_read_b64_tr_b16 a[82:83], v203 offset:18432
    v_mfma_f32_16x16x32_bf16 v[120:123], a[24:27], a[44:47], v[120:123]
    v_mfma_f32_16x16x32_bf16 v[152:155], a[24:27], a[48:51], v[152:155]
    ds_read_b64_tr_b16 a[84:85], v203 offset:16392
    v_mfma_f32_16x16x32_bf16 v[184:187], a[24:27], a[52:55], v[184:187]
    buffer_load_dwordx4 v233, s[4:7], s28 offen offset:3072 sc0 sc1 nt lds
    s_add_u32 s28, s28, 8192
    v_mfma_f32_16x16x32_bf16 v[28:31], a[28:31], a[32:35], v[28:31]
    ds_read_b64_tr_b16 a[86:87], v203 offset:18440
    v_mfma_f32_16x16x32_bf16 v[60:63], a[28:31], a[36:39], v[60:63]
    v_mfma_f32_16x16x32_bf16 v[92:95], a[28:31], a[40:43], v[92:95]
    v_mfma_f32_16x16x32_bf16 v[124:127], a[28:31], a[44:47], v[124:127]
    v_mfma_f32_16x16x32_bf16 v[156:159], a[28:31], a[48:51], v[156:159]
    v_mfma_f32_16x16x32_bf16 v[188:191], a[28:31], a[52:55], v[188:191]
    s_waitcnt vmcnt(22)
    s_waitcnt lgkmcnt(0)
    s_barrier
    v_mfma_f32_16x16x32_bf16 v[0:3], a[56:59], a[88:91], v[0:3]
    ds_read_b128 a[32:35], v199 offset:24576
    v_mfma_f32_16x16x32_bf16 v[32:35], a[56:59], a[92:95], v[32:35]
    s_add_u32 m0, s39, 16384
    s_nop 0
    buffer_load_dwordx4 v195, s[12:15], s37 offen offset:0 lds
    v_mfma_f32_16x16x32_bf16 v[64:67], a[56:59], a[96:99], v[64:67]
    ds_read_b128 a[36:39], v199 offset:25600
    v_mfma_f32_16x16x32_bf16 v[96:99], a[56:59], a[100:103], v[96:99]
    v_mfma_f32_16x16x32_bf16 v[128:131], a[56:59], a[104:107], v[128:131]
    ds_read_b128 a[40:43], v199 offset:26624
    v_mfma_f32_16x16x32_bf16 v[160:163], a[56:59], a[108:111], v[160:163]
    v_mfma_f32_16x16x32_bf16 v[4:7], a[60:63], a[88:91], v[4:7]
    ds_read_b128 a[44:47], v199 offset:27648
    v_mfma_f32_16x16x32_bf16 v[36:39], a[60:63], a[92:95], v[36:39]
    buffer_load_dwordx4 v196, s[12:15], s37 offen offset:1024 lds
    v_mfma_f32_16x16x32_bf16 v[68:71], a[60:63], a[96:99], v[68:71]
    ds_read_b128 a[48:51], v199 offset:28672
    v_mfma_f32_16x16x32_bf16 v[100:103], a[60:63], a[100:103], v[100:103]
    v_mfma_f32_16x16x32_bf16 v[132:135], a[60:63], a[104:107], v[132:135]
    ds_read_b128 a[52:55], v199 offset:29696
    v_mfma_f32_16x16x32_bf16 v[164:167], a[60:63], a[108:111], v[164:167]
    v_mfma_f32_16x16x32_bf16 v[8:11], a[64:67], a[88:91], v[8:11]
    ds_read_b64_tr_b16 a[0:1], v200 offset:32768
    v_mfma_f32_16x16x32_bf16 v[40:43], a[64:67], a[92:95], v[40:43]
    buffer_load_dwordx4 v197, s[12:15], s37 offen offset:2048 lds
    v_mfma_f32_16x16x32_bf16 v[72:75], a[64:67], a[96:99], v[72:75]
    ds_read_b64_tr_b16 a[2:3], v200 offset:34816
    v_mfma_f32_16x16x32_bf16 v[104:107], a[64:67], a[100:103], v[104:107]
    v_mfma_f32_16x16x32_bf16 v[136:139], a[64:67], a[104:107], v[136:139]
    ds_read_b64_tr_b16 a[4:5], v200 offset:32776
    v_mfma_f32_16x16x32_bf16 v[168:171], a[64:67], a[108:111], v[168:171]
    v_mfma_f32_16x16x32_bf16 v[12:15], a[68:71], a[88:91], v[12:15]
    ds_read_b64_tr_b16 a[6:7], v200 offset:34824
    v_mfma_f32_16x16x32_bf16 v[44:47], a[68:71], a[92:95], v[44:47]
    buffer_load_dwordx4 v198, s[12:15], s37 offen offset:3072 lds
    s_add_u32 m0, s38, 12288
    s_add_u32 s37, s37, 262144
    v_mfma_f32_16x16x32_bf16 v[76:79], a[68:71], a[96:99], v[76:79]
    ds_read_b64_tr_b16 a[8:9], v201 offset:32768
    v_mfma_f32_16x16x32_bf16 v[108:111], a[68:71], a[100:103], v[108:111]
    v_mfma_f32_16x16x32_bf16 v[140:143], a[68:71], a[104:107], v[140:143]
    ds_read_b64_tr_b16 a[10:11], v201 offset:34816
    v_mfma_f32_16x16x32_bf16 v[172:175], a[68:71], a[108:111], v[172:175]
    v_mfma_f32_16x16x32_bf16 v[16:19], a[72:75], a[88:91], v[16:19]
    ds_read_b64_tr_b16 a[12:13], v201 offset:32776
    v_mfma_f32_16x16x32_bf16 v[48:51], a[72:75], a[92:95], v[48:51]
    v_mfma_f32_16x16x32_bf16 v[80:83], a[72:75], a[96:99], v[80:83]
    ds_read_b64_tr_b16 a[14:15], v201 offset:34824
    v_mfma_f32_16x16x32_bf16 v[112:115], a[72:75], a[100:103], v[112:115]
    buffer_load_dwordx4 v192, s[8:11], s36 offen offset:0 lds
    v_mfma_f32_16x16x32_bf16 v[144:147], a[72:75], a[104:107], v[144:147]
    ds_read_b64_tr_b16 a[16:17], v202 offset:32768
    v_mfma_f32_16x16x32_bf16 v[176:179], a[72:75], a[108:111], v[176:179]
    v_mfma_f32_16x16x32_bf16 v[20:23], a[76:79], a[88:91], v[20:23]
    ds_read_b64_tr_b16 a[18:19], v202 offset:34816
    v_mfma_f32_16x16x32_bf16 v[52:55], a[76:79], a[92:95], v[52:55]
    v_mfma_f32_16x16x32_bf16 v[84:87], a[76:79], a[96:99], v[84:87]
    ds_read_b64_tr_b16 a[20:21], v202 offset:32776
    v_mfma_f32_16x16x32_bf16 v[116:119], a[76:79], a[100:103], v[116:119]
    buffer_load_dwordx4 v193, s[8:11], s36 offen offset:1024 lds
    v_mfma_f32_16x16x32_bf16 v[148:151], a[76:79], a[104:107], v[148:151]
    ds_read_b64_tr_b16 a[22:23], v202 offset:34824
    v_mfma_f32_16x16x32_bf16 v[180:183], a[76:79], a[108:111], v[180:183]
    v_mfma_f32_16x16x32_bf16 v[24:27], a[80:83], a[88:91], v[24:27]
    ds_read_b64_tr_b16 a[24:25], v203 offset:32768
    v_mfma_f32_16x16x32_bf16 v[56:59], a[80:83], a[92:95], v[56:59]
    v_mfma_f32_16x16x32_bf16 v[88:91], a[80:83], a[96:99], v[88:91]
    ds_read_b64_tr_b16 a[26:27], v203 offset:34816
    v_mfma_f32_16x16x32_bf16 v[120:123], a[80:83], a[100:103], v[120:123]
    buffer_load_dwordx4 v194, s[8:11], s36 offen offset:2048 lds
    s_add_u32 s36, s36, 64
    v_mfma_f32_16x16x32_bf16 v[152:155], a[80:83], a[104:107], v[152:155]
    ds_read_b64_tr_b16 a[28:29], v203 offset:32776
    v_mfma_f32_16x16x32_bf16 v[184:187], a[80:83], a[108:111], v[184:187]
    v_mfma_f32_16x16x32_bf16 v[28:31], a[84:87], a[88:91], v[28:31]
    ds_read_b64_tr_b16 a[30:31], v203 offset:34824
    v_mfma_f32_16x16x32_bf16 v[60:63], a[84:87], a[92:95], v[60:63]
    v_mfma_f32_16x16x32_bf16 v[92:95], a[84:87], a[96:99], v[92:95]
    v_mfma_f32_16x16x32_bf16 v[124:127], a[84:87], a[100:103], v[124:127]
    v_mfma_f32_16x16x32_bf16 v[156:159], a[84:87], a[104:107], v[156:159]
    v_mfma_f32_16x16x32_bf16 v[188:191], a[84:87], a[108:111], v[188:191]
    s_waitcnt vmcnt(18)
    s_waitcnt lgkmcnt(0)
    s_barrier
    v_mfma_f32_16x16x32_bf16 v[0:3], a[0:3], a[32:35], v[0:3]
    ds_read_b128 a[88:91], v199 offset:36864
    v_mfma_f32_16x16x32_bf16 v[32:35], a[0:3], a[36:39], v[32:35]
    s_add_u32 m0, s39, 32768
    s_nop 0
    buffer_load_dwordx4 v195, s[12:15], s37 offen offset:0 lds
    v_mfma_f32_16x16x32_bf16 v[64:67], a[0:3], a[40:43], v[64:67]
    ds_read_b128 a[92:95], v199 offset:37888
    v_mfma_f32_16x16x32_bf16 v[96:99], a[0:3], a[44:47], v[96:99]
    v_mfma_f32_16x16x32_bf16 v[128:131], a[0:3], a[48:51], v[128:131]
    ds_read_b128 a[96:99], v199 offset:38912
    v_mfma_f32_16x16x32_bf16 v[160:163], a[0:3], a[52:55], v[160:163]
    v_mfma_f32_16x16x32_bf16 v[4:7], a[4:7], a[32:35], v[4:7]
    ds_read_b128 a[100:103], v199 offset:39936
    v_mfma_f32_16x16x32_bf16 v[36:39], a[4:7], a[36:39], v[36:39]
    buffer_load_dwordx4 v196, s[12:15], s37 offen offset:1024 lds
    v_mfma_f32_16x16x32_bf16 v[68:71], a[4:7], a[40:43], v[68:71]
    ds_read_b128 a[104:107], v199 offset:40960
    v_mfma_f32_16x16x32_bf16 v[100:103], a[4:7], a[44:47], v[100:103]
    v_mfma_f32_16x16x32_bf16 v[132:135], a[4:7], a[48:51], v[132:135]
    ds_read_b128 a[108:111], v199 offset:41984
    v_mfma_f32_16x16x32_bf16 v[164:167], a[4:7], a[52:55], v[164:167]
    v_mfma_f32_16x16x32_bf16 v[8:11], a[8:11], a[32:35], v[8:11]
    ds_read_b64_tr_b16 a[56:57], v200 offset:49152
    v_mfma_f32_16x16x32_bf16 v[40:43], a[8:11], a[36:39], v[40:43]
    buffer_load_dwordx4 v197, s[12:15], s37 offen offset:2048 lds
    v_mfma_f32_16x16x32_bf16 v[72:75], a[8:11], a[40:43], v[72:75]
    ds_read_b64_tr_b16 a[58:59], v200 offset:51200
    v_mfma_f32_16x16x32_bf16 v[104:107], a[8:11], a[44:47], v[104:107]
    v_mfma_f32_16x16x32_bf16 v[136:139], a[8:11], a[48:51], v[136:139]
    ds_read_b64_tr_b16 a[60:61], v200 offset:49160
    v_mfma_f32_16x16x32_bf16 v[168:171], a[8:11], a[52:55], v[168:171]
    v_mfma_f32_16x16x32_bf16 v[12:15], a[12:15], a[32:35], v[12:15]
    ds_read_b64_tr_b16 a[62:63], v200 offset:51208
    v_mfma_f32_16x16x32_bf16 v[44:47], a[12:15], a[36:39], v[44:47]
    buffer_load_dwordx4 v198, s[12:15], s37 offen offset:3072 lds
    s_add_u32 m0, s38, 24576
    s_add_u32 s37, s37, 262144
    v_mfma_f32_16x16x32_bf16 v[76:79], a[12:15], a[40:43], v[76:79]
    ds_read_b64_tr_b16 a[64:65], v201 offset:49152
    v_mfma_f32_16x16x32_bf16 v[108:111], a[12:15], a[44:47], v[108:111]
    v_mfma_f32_16x16x32_bf16 v[140:143], a[12:15], a[48:51], v[140:143]
    ds_read_b64_tr_b16 a[66:67], v201 offset:51200
    v_mfma_f32_16x16x32_bf16 v[172:175], a[12:15], a[52:55], v[172:175]
    v_mfma_f32_16x16x32_bf16 v[16:19], a[16:19], a[32:35], v[16:19]
    ds_read_b64_tr_b16 a[68:69], v201 offset:49160
    v_mfma_f32_16x16x32_bf16 v[48:51], a[16:19], a[36:39], v[48:51]
    v_mfma_f32_16x16x32_bf16 v[80:83], a[16:19], a[40:43], v[80:83]
    ds_read_b64_tr_b16 a[70:71], v201 offset:51208
    v_mfma_f32_16x16x32_bf16 v[112:115], a[16:19], a[44:47], v[112:115]
    buffer_load_dwordx4 v192, s[8:11], s36 offen offset:0 lds
    v_mfma_f32_16x16x32_bf16 v[144:147], a[16:19], a[48:51], v[144:147]
    ds_read_b64_tr_b16 a[72:73], v202 offset:49152
    v_mfma_f32_16x16x32_bf16 v[176:179], a[16:19], a[52:55], v[176:179]
    v_mfma_f32_16x16x32_bf16 v[20:23], a[20:23], a[32:35], v[20:23]
    ds_read_b64_tr_b16 a[74:75], v202 offset:51200
    v_mfma_f32_16x16x32_bf16 v[52:55], a[20:23], a[36:39], v[52:55]
    v_mfma_f32_16x16x32_bf16 v[84:87], a[20:23], a[40:43], v[84:87]
    ds_read_b64_tr_b16 a[76:77], v202 offset:49160
    v_mfma_f32_16x16x32_bf16 v[116:119], a[20:23], a[44:47], v[116:119]
    buffer_load_dwordx4 v193, s[8:11], s36 offen offset:1024 lds
    v_mfma_f32_16x16x32_bf16 v[148:151], a[20:23], a[48:51], v[148:151]
    ds_read_b64_tr_b16 a[78:79], v202 offset:51208
    v_mfma_f32_16x16x32_bf16 v[180:183], a[20:23], a[52:55], v[180:183]
    v_mfma_f32_16x16x32_bf16 v[24:27], a[24:27], a[32:35], v[24:27]
    ds_read_b64_tr_b16 a[80:81], v203 offset:49152
    v_mfma_f32_16x16x32_bf16 v[56:59], a[24:27], a[36:39], v[56:59]
    v_mfma_f32_16x16x32_bf16 v[88:91], a[24:27], a[40:43], v[88:91]
    ds_read_b64_tr_b16 a[82:83], v203 offset:51200
    v_mfma_f32_16x16x32_bf16 v[120:123], a[24:27], a[44:47], v[120:123]
    buffer_load_dwordx4 v194, s[8:11], s36 offen offset:2048 lds
    s_add_u32 s36, s36, 64
    v_mfma_f32_16x16x32_bf16 v[152:155], a[24:27], a[48:51], v[152:155]
    ds_read_b64_tr_b16 a[84:85], v203 offset:49160
    v_mfma_f32_16x16x32_bf16 v[184:187], a[24:27], a[52:55], v[184:187]
    v_mfma_f32_16x16x32_bf16 v[28:31], a[28:31], a[32:35], v[28:31]
    ds_read_b64_tr_b16 a[86:87], v203 offset:51208
    v_mfma_f32_16x16x32_bf16 v[60:63], a[28:31], a[36:39], v[60:63]
    v_mfma_f32_16x16x32_bf16 v[92:95], a[28:31], a[40:43], v[92:95]
    v_mfma_f32_16x16x32_bf16 v[124:127], a[28:31], a[44:47], v[124:127]
    v_mfma_f32_16x16x32_bf16 v[156:159], a[28:31], a[48:51], v[156:159]
    v_mfma_f32_16x16x32_bf16 v[188:191], a[28:31], a[52:55], v[188:191]
    s_waitcnt vmcnt(18)
    s_waitcnt lgkmcnt(0)
    s_barrier
    v_mfma_f32_16x16x32_bf16 v[0:3], a[56:59], a[88:91], v[0:3]
    ds_read_b128 a[32:35], v199 offset:0
    v_mfma_f32_16x16x32_bf16 v[32:35], a[56:59], a[92:95], v[32:35]
    s_add_u32 m0, s39, 49152
    s_nop 0
    buffer_load_dwordx4 v195, s[12:15], s37 offen offset:0 lds
    v_mfma_f32_16x16x32_bf16 v[64:67], a[56:59], a[96:99], v[64:67]
    ds_read_b128 a[36:39], v199 offset:1024
    v_mfma_f32_16x16x32_bf16 v[96:99], a[56:59], a[100:103], v[96:99]
    v_mfma_f32_16x16x32_bf16 v[128:131], a[56:59], a[104:107], v[128:131]
    ds_read_b128 a[40:43], v199 offset:2048
    v_mfma_f32_16x16x32_bf16 v[160:163], a[56:59], a[108:111], v[160:163]
    v_mfma_f32_16x16x32_bf16 v[4:7], a[60:63], a[88:91], v[4:7]
    ds_read_b128 a[44:47], v199 offset:3072
    v_mfma_f32_16x16x32_bf16 v[36:39], a[60:63], a[92:95], v[36:39]
    buffer_load_dwordx4 v196, s[12:15], s37 offen offset:1024 lds
    v_mfma_f32_16x16x32_bf16 v[68:71], a[60:63], a[96:99], v[68:71]
    ds_read_b128 a[48:51], v199 offset:4096
    v_mfma_f32_16x16x32_bf16 v[100:103], a[60:63], a[100:103], v[100:103]
    v_mfma_f32_16x16x32_bf16 v[132:135], a[60:63], a[104:107], v[132:135]
    ds_read_b128 a[52:55], v199 offset:5120
    v_mfma_f32_16x16x32_bf16 v[164:167], a[60:63], a[108:111], v[164:167]
    v_mfma_f32_16x16x32_bf16 v[8:11], a[64:67], a[88:91], v[8:11]
    ds_read_b64_tr_b16 a[0:1], v200 offset:0
    v_mfma_f32_16x16x32_bf16 v[40:43], a[64:67], a[92:95], v[40:43]
    buffer_load_dwordx4 v197, s[12:15], s37 offen offset:2048 lds
    v_mfma_f32_16x16x32_bf16 v[72:75], a[64:67], a[96:99], v[72:75]
    ds_read_b64_tr_b16 a[2:3], v200 offset:2048
    v_mfma_f32_16x16x32_bf16 v[104:107], a[64:67], a[100:103], v[104:107]
    v_mfma_f32_16x16x32_bf16 v[136:139], a[64:67], a[104:107], v[136:139]
    ds_read_b64_tr_b16 a[4:5], v200 offset:8
    v_mfma_f32_16x16x32_bf16 v[168:171], a[64:67], a[108:111], v[168:171]
    v_mfma_f32_16x16x32_bf16 v[12:15], a[68:71], a[88:91], v[12:15]
    ds_read_b64_tr_b16 a[6:7], v200 offset:2056
    v_mfma_f32_16x16x32_bf16 v[44:47], a[68:71], a[92:95], v[44:47]
    buffer_load_dwordx4 v198, s[12:15], s37 offen offset:3072 lds
    s_add_u32 m0, s38, 36864
    s_add_u32 s37, s37, 262144
    v_mfma_f32_16x16x32_bf16 v[76:79], a[68:71], a[96:99], v[76:79]
    ds_read_b64_tr_b16 a[8:9], v201 offset:0
    v_mfma_f32_16x16x32_bf16 v[108:111], a[68:71], a[100:103], v[108:111]
    v_mfma_f32_16x16x32_bf16 v[140:143], a[68:71], a[104:107], v[140:143]
    ds_read_b64_tr_b16 a[10:11], v201 offset:2048
    v_mfma_f32_16x16x32_bf16 v[172:175], a[68:71], a[108:111], v[172:175]
    v_mfma_f32_16x16x32_bf16 v[16:19], a[72:75], a[88:91], v[16:19]
    ds_read_b64_tr_b16 a[12:13], v201 offset:8
    v_mfma_f32_16x16x32_bf16 v[48:51], a[72:75], a[92:95], v[48:51]
    v_mfma_f32_16x16x32_bf16 v[80:83], a[72:75], a[96:99], v[80:83]
    ds_read_b64_tr_b16 a[14:15], v201 offset:2056
    v_mfma_f32_16x16x32_bf16 v[112:115], a[72:75], a[100:103], v[112:115]
    buffer_load_dwordx4 v192, s[8:11], s36 offen offset:0 lds
    v_mfma_f32_16x16x32_bf16 v[144:147], a[72:75], a[104:107], v[144:147]
    ds_read_b64_tr_b16 a[16:17], v202 offset:0
    v_mfma_f32_16x16x32_bf16 v[176:179], a[72:75], a[108:111], v[176:179]
    v_mfma_f32_16x16x32_bf16 v[20:23], a[76:79], a[88:91], v[20:23]
    ds_read_b64_tr_b16 a[18:19], v202 offset:2048
    v_mfma_f32_16x16x32_bf16 v[52:55], a[76:79], a[92:95], v[52:55]
    v_mfma_f32_16x16x32_bf16 v[84:87], a[76:79], a[96:99], v[84:87]
    ds_read_b64_tr_b16 a[20:21], v202 offset:8
    v_mfma_f32_16x16x32_bf16 v[116:119], a[76:79], a[100:103], v[116:119]
    buffer_load_dwordx4 v193, s[8:11], s36 offen offset:1024 lds
    v_mfma_f32_16x16x32_bf16 v[148:151], a[76:79], a[104:107], v[148:151]
    ds_read_b64_tr_b16 a[22:23], v202 offset:2056
    v_mfma_f32_16x16x32_bf16 v[180:183], a[76:79], a[108:111], v[180:183]
    v_mfma_f32_16x16x32_bf16 v[24:27], a[80:83], a[88:91], v[24:27]
    ds_read_b64_tr_b16 a[24:25], v203 offset:0
    v_mfma_f32_16x16x32_bf16 v[56:59], a[80:83], a[92:95], v[56:59]
    v_mfma_f32_16x16x32_bf16 v[88:91], a[80:83], a[96:99], v[88:91]
    ds_read_b64_tr_b16 a[26:27], v203 offset:2048
    v_mfma_f32_16x16x32_bf16 v[120:123], a[80:83], a[100:103], v[120:123]
    buffer_load_dwordx4 v194, s[8:11], s36 offen offset:2048 lds
    s_add_u32 s36, s36, 64
    v_mfma_f32_16x16x32_bf16 v[152:155], a[80:83], a[104:107], v[152:155]
    ds_read_b64_tr_b16 a[28:29], v203 offset:8
    v_mfma_f32_16x16x32_bf16 v[184:187], a[80:83], a[108:111], v[184:187]
    v_mfma_f32_16x16x32_bf16 v[28:31], a[84:87], a[88:91], v[28:31]
    ds_read_b64_tr_b16 a[30:31], v203 offset:2056
    v_mfma_f32_16x16x32_bf16 v[60:63], a[84:87], a[92:95], v[60:63]
    v_mfma_f32_16x16x32_bf16 v[92:95], a[84:87], a[96:99], v[92:95]
    v_mfma_f32_16x16x32_bf16 v[124:127], a[84:87], a[100:103], v[124:127]
    v_mfma_f32_16x16x32_bf16 v[156:159], a[84:87], a[104:107], v[156:159]
    v_mfma_f32_16x16x32_bf16 v[188:191], a[84:87], a[108:111], v[188:191]
    s_waitcnt vmcnt(14)
    s_waitcnt lgkmcnt(0)
    s_barrier
    v_mfma_f32_16x16x32_bf16 v[0:3], a[0:3], a[32:35], v[0:3]
    ds_read_b128 a[88:91], v199 offset:12288
    v_mfma_f32_16x16x32_bf16 v[32:35], a[0:3], a[36:39], v[32:35]
    v_mfma_f32_16x16x32_bf16 v[64:67], a[0:3], a[40:43], v[64:67]
    ds_read_b128 a[92:95], v199 offset:13312
    v_mfma_f32_16x16x32_bf16 v[96:99], a[0:3], a[44:47], v[96:99]
    v_mfma_f32_16x16x32_bf16 v[128:131], a[0:3], a[48:51], v[128:131]
    ds_read_b128 a[96:99], v199 offset:14336
    v_mfma_f32_16x16x32_bf16 v[160:163], a[0:3], a[52:55], v[160:163]
    v_mfma_f32_16x16x32_bf16 v[4:7], a[4:7], a[32:35], v[4:7]
    ds_read_b128 a[100:103], v199 offset:15360
    v_mfma_f32_16x16x32_bf16 v[36:39], a[4:7], a[36:39], v[36:39]
    v_mfma_f32_16x16x32_bf16 v[68:71], a[4:7], a[40:43], v[68:71]
    ds_read_b128 a[104:107], v199 offset:16384
    v_mfma_f32_16x16x32_bf16 v[100:103], a[4:7], a[44:47], v[100:103]
    v_mfma_f32_16x16x32_bf16 v[132:135], a[4:7], a[48:51], v[132:135]
    ds_read_b128 a[108:111], v199 offset:17408
    v_mfma_f32_16x16x32_bf16 v[164:167], a[4:7], a[52:55], v[164:167]
    v_mfma_f32_16x16x32_bf16 v[8:11], a[8:11], a[32:35], v[8:11]
    ds_read_b64_tr_b16 a[56:57], v200 offset:16384
    v_mfma_f32_16x16x32_bf16 v[40:43], a[8:11], a[36:39], v[40:43]
    v_mfma_f32_16x16x32_bf16 v[72:75], a[8:11], a[40:43], v[72:75]
    ds_read_b64_tr_b16 a[58:59], v200 offset:18432
    v_mfma_f32_16x16x32_bf16 v[104:107], a[8:11], a[44:47], v[104:107]
    v_mfma_f32_16x16x32_bf16 v[136:139], a[8:11], a[48:51], v[136:139]
    ds_read_b64_tr_b16 a[60:61], v200 offset:16392
    v_mfma_f32_16x16x32_bf16 v[168:171], a[8:11], a[52:55], v[168:171]
    v_mfma_f32_16x16x32_bf16 v[12:15], a[12:15], a[32:35], v[12:15]
    ds_read_b64_tr_b16 a[62:63], v200 offset:18440
    v_mfma_f32_16x16x32_bf16 v[44:47], a[12:15], a[36:39], v[44:47]
    v_mfma_f32_16x16x32_bf16 v[76:79], a[12:15], a[40:43], v[76:79]
    ds_read_b64_tr_b16 a[64:65], v201 offset:16384
    v_mfma_f32_16x16x32_bf16 v[108:111], a[12:15], a[44:47], v[108:111]
    v_mfma_f32_16x16x32_bf16 v[140:143], a[12:15], a[48:51], v[140:143]
    ds_read_b64_tr_b16 a[66:67], v201 offset:18432
    v_mfma_f32_16x16x32_bf16 v[172:175], a[12:15], a[52:55], v[172:175]
    v_mfma_f32_16x16x32_bf16 v[16:19], a[16:19], a[32:35], v[16:19]
    ds_read_b64_tr_b16 a[68:69], v201 offset:16392
    v_mfma_f32_16x16x32_bf16 v[48:51], a[16:19], a[36:39], v[48:51]
    v_mfma_f32_16x16x32_bf16 v[80:83], a[16:19], a[40:43], v[80:83]
    ds_read_b64_tr_b16 a[70:71], v201 offset:18440
    v_mfma_f32_16x16x32_bf16 v[112:115], a[16:19], a[44:47], v[112:115]
    v_mfma_f32_16x16x32_bf16 v[144:147], a[16:19], a[48:51], v[144:147]
    ds_read_b64_tr_b16 a[72:73], v202 offset:16384
    v_mfma_f32_16x16x32_bf16 v[176:179], a[16:19], a[52:55], v[176:179]
    v_mfma_f32_16x16x32_bf16 v[20:23], a[20:23], a[32:35], v[20:23]
    ds_read_b64_tr_b16 a[74:75], v202 offset:18432
    v_mfma_f32_16x16x32_bf16 v[52:55], a[20:23], a[36:39], v[52:55]
    v_mfma_f32_16x16x32_bf16 v[84:87], a[20:23], a[40:43], v[84:87]
    ds_read_b64_tr_b16 a[76:77], v202 offset:16392
    v_mfma_f32_16x16x32_bf16 v[116:119], a[20:23], a[44:47], v[116:119]
    v_mfma_f32_16x16x32_bf16 v[148:151], a[20:23], a[48:51], v[148:151]
    ds_read_b64_tr_b16 a[78:79], v202 offset:18440
    v_mfma_f32_16x16x32_bf16 v[180:183], a[20:23], a[52:55], v[180:183]
    v_mfma_f32_16x16x32_bf16 v[24:27], a[24:27], a[32:35], v[24:27]
    ds_read_b64_tr_b16 a[80:81], v203 offset:16384
    v_mfma_f32_16x16x32_bf16 v[56:59], a[24:27], a[36:39], v[56:59]
    v_mfma_f32_16x16x32_bf16 v[88:91], a[24:27], a[40:43], v[88:91]
    ds_read_b64_tr_b16 a[82:83], v203 offset:18432
    v_mfma_f32_16x16x32_bf16 v[120:123], a[24:27], a[44:47], v[120:123]
    v_mfma_f32_16x16x32_bf16 v[152:155], a[24:27], a[48:51], v[152:155]
    ds_read_b64_tr_b16 a[84:85], v203 offset:16392
    v_mfma_f32_16x16x32_bf16 v[184:187], a[24:27], a[52:55], v[184:187]
    v_mfma_f32_16x16x32_bf16 v[28:31], a[28:31], a[32:35], v[28:31]
    ds_read_b64_tr_b16 a[86:87], v203 offset:18440
    v_mfma_f32_16x16x32_bf16 v[60:63], a[28:31], a[36:39], v[60:63]
    v_mfma_f32_16x16x32_bf16 v[92:95], a[28:31], a[40:43], v[92:95]
    v_mfma_f32_16x16x32_bf16 v[124:127], a[28:31], a[44:47], v[124:127]
    v_mfma_f32_16x16x32_bf16 v[156:159], a[28:31], a[48:51], v[156:159]
    v_mfma_f32_16x16x32_bf16 v[188:191], a[28:31], a[52:55], v[188:191]
    s_waitcnt vmcnt(7)
    s_waitcnt lgkmcnt(0)
    s_barrier
    v_mfma_f32_16x16x32_bf16 v[0:3], a[56:59], a[88:91], v[0:3]
    ds_read_b128 a[32:35], v199 offset:24576
    v_mfma_f32_16x16x32_bf16 v[32:35], a[56:59], a[92:95], v[32:35]
    s_add_u32 m0, s25, 0
    s_nop 0
    buffer_load_dwordx4 v234, s[76:79], s29 offen offset:0 sc0 sc1 nt lds
    v_mfma_f32_16x16x32_bf16 v[64:67], a[56:59], a[96:99], v[64:67]
    ds_read_b128 a[36:39], v199 offset:25600
    v_mfma_f32_16x16x32_bf16 v[96:99], a[56:59], a[100:103], v[96:99]
    v_mfma_f32_16x16x32_bf16 v[128:131], a[56:59], a[104:107], v[128:131]
    ds_read_b128 a[40:43], v199 offset:26624
    v_mfma_f32_16x16x32_bf16 v[160:163], a[56:59], a[108:111], v[160:163]
    buffer_load_dwordx4 v234, s[76:79], s29 offen offset:1024 sc0 sc1 nt lds
    v_mfma_f32_16x16x32_bf16 v[4:7], a[60:63], a[88:91], v[4:7]
    ds_read_b128 a[44:47], v199 offset:27648
    v_mfma_f32_16x16x32_bf16 v[36:39], a[60:63], a[92:95], v[36:39]
    v_mfma_f32_16x16x32_bf16 v[68:71], a[60:63], a[96:99], v[68:71]
    ds_read_b128 a[48:51], v199 offset:28672
    v_mfma_f32_16x16x32_bf16 v[100:103], a[60:63], a[100:103], v[100:103]
    v_mfma_f32_16x16x32_bf16 v[132:135], a[60:63], a[104:107], v[132:135]
    ds_read_b128 a[52:55], v199 offset:29696
    v_mfma_f32_16x16x32_bf16 v[164:167], a[60:63], a[108:111], v[164:167]
    buffer_load_dwordx4 v235, s[76:79], s29 offen offset:2048 sc0 sc1 nt lds
    v_mfma_f32_16x16x32_bf16 v[8:11], a[64:67], a[88:91], v[8:11]
    ds_read_b64_tr_b16 a[0:1], v200 offset:32768
    v_mfma_f32_16x16x32_bf16 v[40:43], a[64:67], a[92:95], v[40:43]
    v_mfma_f32_16x16x32_bf16 v[72:75], a[64:67], a[96:99], v[72:75]
    ds_read_b64_tr_b16 a[2:3], v200 offset:34816
    v_mfma_f32_16x16x32_bf16 v[104:107], a[64:67], a[100:103], v[104:107]
    v_mfma_f32_16x16x32_bf16 v[136:139], a[64:67], a[104:107], v[136:139]
    ds_read_b64_tr_b16 a[4:5], v200 offset:32776
    v_mfma_f32_16x16x32_bf16 v[168:171], a[64:67], a[108:111], v[168:171]
    buffer_load_dwordx4 v235, s[76:79], s29 offen offset:3072 sc0 sc1 nt lds
    s_add_u32 s29, s29, 8192
    s_add_u32 m0, s24, 32768
    v_mfma_f32_16x16x32_bf16 v[12:15], a[68:71], a[88:91], v[12:15]
    ds_read_b64_tr_b16 a[6:7], v200 offset:34824
    v_mfma_f32_16x16x32_bf16 v[44:47], a[68:71], a[92:95], v[44:47]
    v_mfma_f32_16x16x32_bf16 v[76:79], a[68:71], a[96:99], v[76:79]
    ds_read_b64_tr_b16 a[8:9], v201 offset:32768
    v_mfma_f32_16x16x32_bf16 v[108:111], a[68:71], a[100:103], v[108:111]
    v_mfma_f32_16x16x32_bf16 v[140:143], a[68:71], a[104:107], v[140:143]
    ds_read_b64_tr_b16 a[10:11], v201 offset:34816
    v_mfma_f32_16x16x32_bf16 v[172:175], a[68:71], a[108:111], v[172:175]
    buffer_load_dwordx4 v232, s[4:7], s28 offen offset:0 sc0 sc1 nt lds
    v_mfma_f32_16x16x32_bf16 v[16:19], a[72:75], a[88:91], v[16:19]
    ds_read_b64_tr_b16 a[12:13], v201 offset:32776
    v_mfma_f32_16x16x32_bf16 v[48:51], a[72:75], a[92:95], v[48:51]
    v_mfma_f32_16x16x32_bf16 v[80:83], a[72:75], a[96:99], v[80:83]
    ds_read_b64_tr_b16 a[14:15], v201 offset:34824
    v_mfma_f32_16x16x32_bf16 v[112:115], a[72:75], a[100:103], v[112:115]
    v_mfma_f32_16x16x32_bf16 v[144:147], a[72:75], a[104:107], v[144:147]
    ds_read_b64_tr_b16 a[16:17], v202 offset:32768
    v_mfma_f32_16x16x32_bf16 v[176:179], a[72:75], a[108:111], v[176:179]
    buffer_load_dwordx4 v232, s[4:7], s28 offen offset:1024 sc0 sc1 nt lds
    v_mfma_f32_16x16x32_bf16 v[20:23], a[76:79], a[88:91], v[20:23]
    ds_read_b64_tr_b16 a[18:19], v202 offset:34816
    v_mfma_f32_16x16x32_bf16 v[52:55], a[76:79], a[92:95], v[52:55]
    v_mfma_f32_16x16x32_bf16 v[84:87], a[76:79], a[96:99], v[84:87]
    ds_read_b64_tr_b16 a[20:21], v202 offset:32776
    v_mfma_f32_16x16x32_bf16 v[116:119], a[76:79], a[100:103], v[116:119]
    v_mfma_f32_16x16x32_bf16 v[148:151], a[76:79], a[104:107], v[148:151]
    ds_read_b64_tr_b16 a[22:23], v202 offset:34824
    v_mfma_f32_16x16x32_bf16 v[180:183], a[76:79], a[108:111], v[180:183]
    buffer_load_dwordx4 v233, s[4:7], s28 offen offset:2048 sc0 sc1 nt lds
    v_mfma_f32_16x16x32_bf16 v[24:27], a[80:83], a[88:91], v[24:27]
    ds_read_b64_tr_b16 a[24:25], v203 offset:32768
    v_mfma_f32_16x16x32_bf16 v[56:59], a[80:83], a[92:95], v[56:59]
    v_mfma_f32_16x16x32_bf16 v[88:91], a[80:83], a[96:99], v[88:91]
    ds_read_b64_tr_b16 a[26:27], v203 offset:34816
    v_mfma_f32_16x16x32_bf16 v[120:123], a[80:83], a[100:103], v[120:123]
    v_mfma_f32_16x16x32_bf16 v[152:155], a[80:83], a[104:107], v[152:155]
    ds_read_b64_tr_b16 a[28:29], v203 offset:32776
    v_mfma_f32_16x16x32_bf16 v[184:187], a[80:83], a[108:111], v[184:187]
    buffer_load_dwordx4 v233, s[4:7], s28 offen offset:3072 sc0 sc1 nt lds
    s_add_u32 s28, s28, 8192
    v_mfma_f32_16x16x32_bf16 v[28:31], a[84:87], a[88:91], v[28:31]
    ds_read_b64_tr_b16 a[30:31], v203 offset:34824
    v_mfma_f32_16x16x32_bf16 v[60:63], a[84:87], a[92:95], v[60:63]
    v_mfma_f32_16x16x32_bf16 v[92:95], a[84:87], a[96:99], v[92:95]
    v_mfma_f32_16x16x32_bf16 v[124:127], a[84:87], a[100:103], v[124:127]
    v_mfma_f32_16x16x32_bf16 v[156:159], a[84:87], a[104:107], v[156:159]
    v_mfma_f32_16x16x32_bf16 v[188:191], a[84:87], a[108:111], v[188:191]
    s_waitcnt vmcnt(8)
    s_waitcnt lgkmcnt(0)
    s_barrier
    v_mfma_f32_16x16x32_bf16 v[0:3], a[0:3], a[32:35], v[0:3]
    ds_read_b128 a[88:91], v199 offset:36864
    v_mfma_f32_16x16x32_bf16 v[32:35], a[0:3], a[36:39], v[32:35]
    s_add_u32 m0, s25, 16384
    s_nop 0
    buffer_load_dwordx4 v234, s[76:79], s29 offen offset:0 sc0 sc1 nt lds
    v_mfma_f32_16x16x32_bf16 v[64:67], a[0:3], a[40:43], v[64:67]
    ds_read_b128 a[92:95], v199 offset:37888
    v_mfma_f32_16x16x32_bf16 v[96:99], a[0:3], a[44:47], v[96:99]
    v_mfma_f32_16x16x32_bf16 v[128:131], a[0:3], a[48:51], v[128:131]
    ds_read_b128 a[96:99], v199 offset:38912
    v_mfma_f32_16x16x32_bf16 v[160:163], a[0:3], a[52:55], v[160:163]
    buffer_load_dwordx4 v234, s[76:79], s29 offen offset:1024 sc0 sc1 nt lds
    v_mfma_f32_16x16x32_bf16 v[4:7], a[4:7], a[32:35], v[4:7]
    ds_read_b128 a[100:103], v199 offset:39936
    v_mfma_f32_16x16x32_bf16 v[36:39], a[4:7], a[36:39], v[36:39]
    v_mfma_f32_16x16x32_bf16 v[68:71], a[4:7], a[40:43], v[68:71]
    ds_read_b128 a[104:107], v199 offset:40960
    v_mfma_f32_16x16x32_bf16 v[100:103], a[4:7], a[44:47], v[100:103]
    v_mfma_f32_16x16x32_bf16 v[132:135], a[4:7], a[48:51], v[132:135]
    ds_read_b128 a[108:111], v199 offset:41984
    v_mfma_f32_16x16x32_bf16 v[164:167], a[4:7], a[52:55], v[164:167]
    buffer_load_dwordx4 v235, s[76:79], s29 offen offset:2048 sc0 sc1 nt lds
    v_mfma_f32_16x16x32_bf16 v[8:11], a[8:11], a[32:35], v[8:11]
    ds_read_b64_tr_b16 a[56:57], v200 offset:49152
    v_mfma_f32_16x16x32_bf16 v[40:43], a[8:11], a[36:39], v[40:43]
    v_mfma_f32_16x16x32_bf16 v[72:75], a[8:11], a[40:43], v[72:75]
    ds_read_b64_tr_b16 a[58:59], v200 offset:51200
    v_mfma_f32_16x16x32_bf16 v[104:107], a[8:11], a[44:47], v[104:107]
    v_mfma_f32_16x16x32_bf16 v[136:139], a[8:11], a[48:51], v[136:139]
    ds_read_b64_tr_b16 a[60:61], v200 offset:49160
    v_mfma_f32_16x16x32_bf16 v[168:171], a[8:11], a[52:55], v[168:171]
    buffer_load_dwordx4 v235, s[76:79], s29 offen offset:3072 sc0 sc1 nt lds
    s_add_u32 s29, s29, 8192
    s_add_u32 m0, s24, 49152
    v_mfma_f32_16x16x32_bf16 v[12:15], a[12:15], a[32:35], v[12:15]
    ds_read_b64_tr_b16 a[62:63], v200 offset:51208
    v_mfma_f32_16x16x32_bf16 v[44:47], a[12:15], a[36:39], v[44:47]
    v_mfma_f32_16x16x32_bf16 v[76:79], a[12:15], a[40:43], v[76:79]
    ds_read_b64_tr_b16 a[64:65], v201 offset:49152
    v_mfma_f32_16x16x32_bf16 v[108:111], a[12:15], a[44:47], v[108:111]
    v_mfma_f32_16x16x32_bf16 v[140:143], a[12:15], a[48:51], v[140:143]
    ds_read_b64_tr_b16 a[66:67], v201 offset:51200
    v_mfma_f32_16x16x32_bf16 v[172:175], a[12:15], a[52:55], v[172:175]
    buffer_load_dwordx4 v232, s[4:7], s28 offen offset:0 sc0 sc1 nt lds
    v_mfma_f32_16x16x32_bf16 v[16:19], a[16:19], a[32:35], v[16:19]
    ds_read_b64_tr_b16 a[68:69], v201 offset:49160
    v_mfma_f32_16x16x32_bf16 v[48:51], a[16:19], a[36:39], v[48:51]
    v_mfma_f32_16x16x32_bf16 v[80:83], a[16:19], a[40:43], v[80:83]
    ds_read_b64_tr_b16 a[70:71], v201 offset:51208
    v_mfma_f32_16x16x32_bf16 v[112:115], a[16:19], a[44:47], v[112:115]
    v_mfma_f32_16x16x32_bf16 v[144:147], a[16:19], a[48:51], v[144:147]
    ds_read_b64_tr_b16 a[72:73], v202 offset:49152
    v_mfma_f32_16x16x32_bf16 v[176:179], a[16:19], a[52:55], v[176:179]
    buffer_load_dwordx4 v232, s[4:7], s28 offen offset:1024 sc0 sc1 nt lds
    v_mfma_f32_16x16x32_bf16 v[20:23], a[20:23], a[32:35], v[20:23]
    ds_read_b64_tr_b16 a[74:75], v202 offset:51200
    v_mfma_f32_16x16x32_bf16 v[52:55], a[20:23], a[36:39], v[52:55]
    v_mfma_f32_16x16x32_bf16 v[84:87], a[20:23], a[40:43], v[84:87]
    ds_read_b64_tr_b16 a[76:77], v202 offset:49160
    v_mfma_f32_16x16x32_bf16 v[116:119], a[20:23], a[44:47], v[116:119]
    v_mfma_f32_16x16x32_bf16 v[148:151], a[20:23], a[48:51], v[148:151]
    ds_read_b64_tr_b16 a[78:79], v202 offset:51208
    v_mfma_f32_16x16x32_bf16 v[180:183], a[20:23], a[52:55], v[180:183]
    buffer_load_dwordx4 v233, s[4:7], s28 offen offset:2048 sc0 sc1 nt lds
    v_mfma_f32_16x16x32_bf16 v[24:27], a[24:27], a[32:35], v[24:27]
    ds_read_b64_tr_b16 a[80:81], v203 offset:49152
    v_mfma_f32_16x16x32_bf16 v[56:59], a[24:27], a[36:39], v[56:59]
    v_mfma_f32_16x16x32_bf16 v[88:91], a[24:27], a[40:43], v[88:91]
    ds_read_b64_tr_b16 a[82:83], v203 offset:51200
    v_mfma_f32_16x16x32_bf16 v[120:123], a[24:27], a[44:47], v[120:123]
    v_mfma_f32_16x16x32_bf16 v[152:155], a[24:27], a[48:51], v[152:155]
    ds_read_b64_tr_b16 a[84:85], v203 offset:49160
    v_mfma_f32_16x16x32_bf16 v[184:187], a[24:27], a[52:55], v[184:187]
    buffer_load_dwordx4 v233, s[4:7], s28 offen offset:3072 sc0 sc1 nt lds
    s_add_u32 s28, s28, 8192
    v_mfma_f32_16x16x32_bf16 v[28:31], a[28:31], a[32:35], v[28:31]
    ds_read_b64_tr_b16 a[86:87], v203 offset:51208
    v_mfma_f32_16x16x32_bf16 v[60:63], a[28:31], a[36:39], v[60:63]
    v_mfma_f32_16x16x32_bf16 v[92:95], a[28:31], a[40:43], v[92:95]
    v_mfma_f32_16x16x32_bf16 v[124:127], a[28:31], a[44:47], v[124:127]
    v_mfma_f32_16x16x32_bf16 v[156:159], a[28:31], a[48:51], v[156:159]
    v_mfma_f32_16x16x32_bf16 v[188:191], a[28:31], a[52:55], v[188:191]
    s_waitcnt lgkmcnt(0)
    s_barrier
    v_mfma_f32_16x16x32_bf16 v[0:3], a[56:59], a[88:91], v[0:3]
    v_mfma_f32_16x16x32_bf16 v[32:35], a[56:59], a[92:95], v[32:35]
    s_add_u32 m0, s25, 32768
    s_nop 0
    buffer_load_dwordx4 v234, s[76:79], s29 offen offset:0 sc0 sc1 nt lds
    v_mfma_f32_16x16x32_bf16 v[64:67], a[56:59], a[96:99], v[64:67]
    v_mfma_f32_16x16x32_bf16 v[96:99], a[56:59], a[100:103], v[96:99]
    v_mfma_f32_16x16x32_bf16 v[128:131], a[56:59], a[104:107], v[128:131]
    v_mfma_f32_16x16x32_bf16 v[160:163], a[56:59], a[108:111], v[160:163]
    v_mfma_f32_16x16x32_bf16 v[4:7], a[60:63], a[88:91], v[4:7]
    v_mfma_f32_16x16x32_bf16 v[36:39], a[60:63], a[92:95], v[36:39]
    v_mfma_f32_16x16x32_bf16 v[68:71], a[60:63], a[96:99], v[68:71]
    v_mfma_f32_16x16x32_bf16 v[100:103], a[60:63], a[100:103], v[100:103]
    v_mfma_f32_16x16x32_bf16 v[132:135], a[60:63], a[104:107], v[132:135]
    v_mfma_f32_16x16x32_bf16 v[164:167], a[60:63], a[108:111], v[164:167]
    buffer_load_dwordx4 v234, s[76:79], s29 offen offset:1024 sc0 sc1 nt lds
    v_mfma_f32_16x16x32_bf16 v[8:11], a[64:67], a[88:91], v[8:11]
    v_mfma_f32_16x16x32_bf16 v[40:43], a[64:67], a[92:95], v[40:43]
    v_mfma_f32_16x16x32_bf16 v[72:75], a[64:67], a[96:99], v[72:75]
    v_mfma_f32_16x16x32_bf16 v[104:107], a[64:67], a[100:103], v[104:107]
    v_mfma_f32_16x16x32_bf16 v[136:139], a[64:67], a[104:107], v[136:139]
    v_mfma_f32_16x16x32_bf16 v[168:171], a[64:67], a[108:111], v[168:171]
    v_mfma_f32_16x16x32_bf16 v[12:15], a[68:71], a[88:91], v[12:15]
    v_mfma_f32_16x16x32_bf16 v[44:47], a[68:71], a[92:95], v[44:47]
    v_mfma_f32_16x16x32_bf16 v[76:79], a[68:71], a[96:99], v[76:79]
    v_mfma_f32_16x16x32_bf16 v[108:111], a[68:71], a[100:103], v[108:111]
    v_mfma_f32_16x16x32_bf16 v[140:143], a[68:71], a[104:107], v[140:143]
    v_mfma_f32_16x16x32_bf16 v[172:175], a[68:71], a[108:111], v[172:175]
    buffer_load_dwordx4 v235, s[76:79], s29 offen offset:2048 sc0 sc1 nt lds
    v_mfma_f32_16x16x32_bf16 v[16:19], a[72:75], a[88:91], v[16:19]
    v_mfma_f32_16x16x32_bf16 v[48:51], a[72:75], a[92:95], v[48:51]
    v_mfma_f32_16x16x32_bf16 v[80:83], a[72:75], a[96:99], v[80:83]
    v_mfma_f32_16x16x32_bf16 v[112:115], a[72:75], a[100:103], v[112:115]
    v_mfma_f32_16x16x32_bf16 v[144:147], a[72:75], a[104:107], v[144:147]
    v_mfma_f32_16x16x32_bf16 v[176:179], a[72:75], a[108:111], v[176:179]
    v_mfma_f32_16x16x32_bf16 v[20:23], a[76:79], a[88:91], v[20:23]
    v_mfma_f32_16x16x32_bf16 v[52:55], a[76:79], a[92:95], v[52:55]
    v_mfma_f32_16x16x32_bf16 v[84:87], a[76:79], a[96:99], v[84:87]
    v_mfma_f32_16x16x32_bf16 v[116:119], a[76:79], a[100:103], v[116:119]
    v_mfma_f32_16x16x32_bf16 v[148:151], a[76:79], a[104:107], v[148:151]
    v_mfma_f32_16x16x32_bf16 v[180:183], a[76:79], a[108:111], v[180:183]
    buffer_load_dwordx4 v235, s[76:79], s29 offen offset:3072 sc0 sc1 nt lds
    s_add_u32 s29, s29, 8192
    v_mfma_f32_16x16x32_bf16 v[24:27], a[80:83], a[88:91], v[24:27]
    v_mfma_f32_16x16x32_bf16 v[56:59], a[80:83], a[92:95], v[56:59]
    v_mfma_f32_16x16x32_bf16 v[88:91], a[80:83], a[96:99], v[88:91]
    v_mfma_f32_16x16x32_bf16 v[120:123], a[80:83], a[100:103], v[120:123]
    v_mfma_f32_16x16x32_bf16 v[152:155], a[80:83], a[104:107], v[152:155]
    v_mfma_f32_16x16x32_bf16 v[184:187], a[80:83], a[108:111], v[184:187]
    v_mfma_f32_16x16x32_bf16 v[28:31], a[84:87], a[88:91], v[28:31]
    v_mfma_f32_16x16x32_bf16 v[60:63], a[84:87], a[92:95], v[60:63]
    v_mfma_f32_16x16x32_bf16 v[92:95], a[84:87], a[96:99], v[92:95]
    v_mfma_f32_16x16x32_bf16 v[124:127], a[84:87], a[100:103], v[124:127]
    v_mfma_f32_16x16x32_bf16 v[156:159], a[84:87], a[104:107], v[156:159]
    v_mfma_f32_16x16x32_bf16 v[188:191], a[84:87], a[108:111], v[188:191]
    s_load_dwordx2 s[48:49], s[0:1], 32
    s_load_dwordx2 s[50:51], s[0:1], 72
    s_lshl_b32 s23, s82, 18
    s_and_b32 s31, s20, 1
    s_lshl_b32 s31, s31, 16
    s_add_u32 s35, s23, s31
    s_lshr_b32 s31, s20, 1
    s_lshl_b32 s31, s31, 9
    s_add_u32 s35, s35, s31
    s_waitcnt lgkmcnt(0)
    s_cmp_eq_u32 s80, 0
    s_cselect_b32 s48, s48, s50
    s_cselect_b32 s49, s49, s51
    s_add_u32 s72, s48, s35
    s_addc_u32 s73, s49, 0
    s_mov_b32 s74, 0
    s_mov_b32 s75, 0x00020000
    s_sub_u32 s74, 4194304, s35
    s_add_u32 s8, s48, s23
    s_addc_u32 s9, s49, 0
    s_mov_b32 s10, 262144
    s_mov_b32 s11, 0x00020000
    s_lshl_b32 s39, s20, 13
    s_lshl_b32 s38, s81, 2
    s_add_u32 s38, s38, s20
    s_lshl_b32 s38, s38, 13
    s_waitcnt vmcnt(63)
    s_barrier
    ds_read_b128 a[192:195], v220 offset:0
    ds_read_b128 a[208:211], v220 offset:1024
    ds_read_b128 a[196:199], v221 offset:0
    ds_read_b128 a[212:215], v221 offset:1024
    ds_read_b128 a[200:203], v222 offset:0
    ds_read_b128 a[216:219], v222 offset:1024
    ds_read_b128 a[204:207], v223 offset:0
    ds_read_b128 a[220:223], v223 offset:1024
    v_pk_mul_f32 v[0:1], v[0:1], s[32:33]
    v_pk_mul_f32 v[2:3], v[2:3], s[32:33]
    v_cvt_pk_bf16_f32 v0, v0, v1
    v_pk_mul_f32 v[4:5], v[4:5], s[32:33]
    v_cvt_pk_bf16_f32 v1, v2, v3
    v_pk_mul_f32 v[6:7], v[6:7], s[32:33]
    v_cvt_pk_bf16_f32 v2, v4, v5
    v_pk_mul_f32 v[8:9], v[8:9], s[32:33]
    v_cvt_pk_bf16_f32 v3, v6, v7
    v_pk_mul_f32 v[10:11], v[10:11], s[32:33]
    v_cvt_pk_bf16_f32 v4, v8, v9
    v_pk_mul_f32 v[12:13], v[12:13], s[32:33]
    v_cvt_pk_bf16_f32 v5, v10, v11
    v_pk_mul_f32 v[14:15], v[14:15], s[32:33]
    v_cvt_pk_bf16_f32 v6, v12, v13
    v_pk_mul_f32 v[16:17], v[16:17], s[32:33]
    v_cvt_pk_bf16_f32 v7, v14, v15
    v_pk_mul_f32 v[18:19], v[18:19], s[32:33]
    v_cvt_pk_bf16_f32 v8, v16, v17
    v_pk_mul_f32 v[20:21], v[20:21], s[32:33]
    v_cvt_pk_bf16_f32 v9, v18, v19
    v_pk_mul_f32 v[22:23], v[22:23], s[32:33]
    v_cvt_pk_bf16_f32 v10, v20, v21
    v_pk_mul_f32 v[24:25], v[24:25], s[32:33]
    v_cvt_pk_bf16_f32 v11, v22, v23
    v_pk_mul_f32 v[26:27], v[26:27], s[32:33]
    v_cvt_pk_bf16_f32 v12, v24, v25
    v_pk_mul_f32 v[28:29], v[28:29], s[32:33]
    v_cvt_pk_bf16_f32 v13, v26, v27
    v_pk_mul_f32 v[30:31], v[30:31], s[32:33]
    v_cvt_pk_bf16_f32 v14, v28, v29
    v_pk_mul_f32 v[32:33], v[32:33], s[32:33]
    v_cvt_pk_bf16_f32 v15, v30, v31
    v_pk_mul_f32 v[34:35], v[34:35], s[32:33]
    v_cvt_pk_bf16_f32 v16, v32, v33
    v_pk_mul_f32 v[36:37], v[36:37], s[32:33]
    v_cvt_pk_bf16_f32 v17, v34, v35
    v_pk_mul_f32 v[38:39], v[38:39], s[32:33]
    v_cvt_pk_bf16_f32 v18, v36, v37
    v_pk_mul_f32 v[40:41], v[40:41], s[32:33]
    v_cvt_pk_bf16_f32 v19, v38, v39
    v_pk_mul_f32 v[42:43], v[42:43], s[32:33]
    v_cvt_pk_bf16_f32 v20, v40, v41
    v_pk_mul_f32 v[44:45], v[44:45], s[32:33]
    v_cvt_pk_bf16_f32 v21, v42, v43
    v_pk_mul_f32 v[46:47], v[46:47], s[32:33]
    v_cvt_pk_bf16_f32 v22, v44, v45
    v_pk_mul_f32 v[48:49], v[48:49], s[32:33]
    v_cvt_pk_bf16_f32 v23, v46, v47
    v_pk_mul_f32 v[50:51], v[50:51], s[32:33]
    v_cvt_pk_bf16_f32 v24, v48, v49
    v_pk_mul_f32 v[52:53], v[52:53], s[32:33]
    v_cvt_pk_bf16_f32 v25, v50, v51
    v_pk_mul_f32 v[54:55], v[54:55], s[32:33]
    v_cvt_pk_bf16_f32 v26, v52, v53
    v_pk_mul_f32 v[56:57], v[56:57], s[32:33]
    v_cvt_pk_bf16_f32 v27, v54, v55
    v_pk_mul_f32 v[58:59], v[58:59], s[32:33]
    v_cvt_pk_bf16_f32 v28, v56, v57
    v_pk_mul_f32 v[60:61], v[60:61], s[32:33]
    v_cvt_pk_bf16_f32 v29, v58, v59
    v_pk_mul_f32 v[62:63], v[62:63], s[32:33]
    v_cvt_pk_bf16_f32 v30, v60, v61
    v_pk_mul_f32 v[64:65], v[64:65], s[32:33]
    v_cvt_pk_bf16_f32 v31, v62, v63
    v_pk_mul_f32 v[66:67], v[66:67], s[32:33]
    v_cvt_pk_bf16_f32 v32, v64, v65
    v_pk_mul_f32 v[68:69], v[68:69], s[32:33]
    v_cvt_pk_bf16_f32 v33, v66, v67
    v_pk_mul_f32 v[70:71], v[70:71], s[32:33]
    v_cvt_pk_bf16_f32 v34, v68, v69
    v_pk_mul_f32 v[72:73], v[72:73], s[32:33]
    v_cvt_pk_bf16_f32 v35, v70, v71
    v_pk_mul_f32 v[74:75], v[74:75], s[32:33]
    v_cvt_pk_bf16_f32 v36, v72, v73
    v_pk_mul_f32 v[76:77], v[76:77], s[32:33]
    v_cvt_pk_bf16_f32 v37, v74, v75
    v_pk_mul_f32 v[78:79], v[78:79], s[32:33]
    v_cvt_pk_bf16_f32 v38, v76, v77
    v_pk_mul_f32 v[80:81], v[80:81], s[32:33]
    v_cvt_pk_bf16_f32 v39, v78, v79
    v_pk_mul_f32 v[82:83], v[82:83], s[32:33]
    v_cvt_pk_bf16_f32 v40, v80, v81
    v_pk_mul_f32 v[84:85], v[84:85], s[32:33]
    v_cvt_pk_bf16_f32 v41, v82, v83
    v_pk_mul_f32 v[86:87], v[86:87], s[32:33]
    v_cvt_pk_bf16_f32 v42, v84, v85
    v_pk_mul_f32 v[88:89], v[88:89], s[32:33]
    v_cvt_pk_bf16_f32 v43, v86, v87
    v_pk_mul_f32 v[90:91], v[90:91], s[32:33]
    v_cvt_pk_bf16_f32 v44, v88, v89
    v_pk_mul_f32 v[92:93], v[92:93], s[32:33]
    v_cvt_pk_bf16_f32 v45, v90, v91
    v_pk_mul_f32 v[94:95], v[94:95], s[32:33]
    v_cvt_pk_bf16_f32 v46, v92, v93
    v_pk_mul_f32 v[96:97], v[96:97], s[32:33]
    v_cvt_pk_bf16_f32 v47, v94, v95
    v_pk_mul_f32 v[98:99], v[98:99], s[32:33]
    v_cvt_pk_bf16_f32 v48, v96, v97
    v_pk_mul_f32 v[100:101], v[100:101], s[32:33]
    v_cvt_pk_bf16_f32 v49, v98, v99
    v_pk_mul_f32 v[102:103], v[102:103], s[32:33]
    v_cvt_pk_bf16_f32 v50, v100, v101
    v_pk_mul_f32 v[104:105], v[104:105], s[32:33]
    v_cvt_pk_bf16_f32 v51, v102, v103
    v_pk_mul_f32 v[106:107], v[106:107], s[32:33]
    v_cvt_pk_bf16_f32 v52, v104, v105
    v_pk_mul_f32 v[108:109], v[108:109], s[32:33]
    v_cvt_pk_bf16_f32 v53, v106, v107
    v_pk_mul_f32 v[110:111], v[110:111], s[32:33]
    v_cvt_pk_bf16_f32 v54, v108, v109
    v_pk_mul_f32 v[112:113], v[112:113], s[32:33]
    v_cvt_pk_bf16_f32 v55, v110, v111
    v_pk_mul_f32 v[114:115], v[114:115], s[32:33]
    v_cvt_pk_bf16_f32 v56, v112, v113
    v_pk_mul_f32 v[116:117], v[116:117], s[32:33]
    v_cvt_pk_bf16_f32 v57, v114, v115
    v_pk_mul_f32 v[118:119], v[118:119], s[32:33]
    v_cvt_pk_bf16_f32 v58, v116, v117
    v_pk_mul_f32 v[120:121], v[120:121], s[32:33]
    v_cvt_pk_bf16_f32 v59, v118, v119
    v_pk_mul_f32 v[122:123], v[122:123], s[32:33]
    v_cvt_pk_bf16_f32 v60, v120, v121
    v_pk_mul_f32 v[124:125], v[124:125], s[32:33]
    v_cvt_pk_bf16_f32 v61, v122, v123
    v_pk_mul_f32 v[126:127], v[126:127], s[32:33]
    v_cvt_pk_bf16_f32 v62, v124, v125
    v_pk_mul_f32 v[128:129], v[128:129], s[32:33]
    v_cvt_pk_bf16_f32 v63, v126, v127
    v_pk_mul_f32 v[130:131], v[130:131], s[32:33]
    v_cvt_pk_bf16_f32 v64, v128, v129
    v_pk_mul_f32 v[132:133], v[132:133], s[32:33]
    v_cvt_pk_bf16_f32 v65, v130, v131
    v_pk_mul_f32 v[134:135], v[134:135], s[32:33]
    v_cvt_pk_bf16_f32 v66, v132, v133
    v_pk_mul_f32 v[136:137], v[136:137], s[32:33]
    v_cvt_pk_bf16_f32 v67, v134, v135
    v_pk_mul_f32 v[138:139], v[138:139], s[32:33]
    v_cvt_pk_bf16_f32 v68, v136, v137
    v_pk_mul_f32 v[140:141], v[140:141], s[32:33]
    v_cvt_pk_bf16_f32 v69, v138, v139
    v_pk_mul_f32 v[142:143], v[142:143], s[32:33]
    v_cvt_pk_bf16_f32 v70, v140, v141
    v_pk_mul_f32 v[144:145], v[144:145], s[32:33]
    v_cvt_pk_bf16_f32 v71, v142, v143
    v_pk_mul_f32 v[146:147], v[146:147], s[32:33]
    v_cvt_pk_bf16_f32 v72, v144, v145
    v_pk_mul_f32 v[148:149], v[148:149], s[32:33]
    v_cvt_pk_bf16_f32 v73, v146, v147
    v_pk_mul_f32 v[150:151], v[150:151], s[32:33]
    v_cvt_pk_bf16_f32 v74, v148, v149
    v_pk_mul_f32 v[152:153], v[152:153], s[32:33]
    v_cvt_pk_bf16_f32 v75, v150, v151
    v_pk_mul_f32 v[154:155], v[154:155], s[32:33]
    v_cvt_pk_bf16_f32 v76, v152, v153
    v_pk_mul_f32 v[156:157], v[156:157], s[32:33]
    v_cvt_pk_bf16_f32 v77, v154, v155
    v_pk_mul_f32 v[158:159], v[158:159], s[32:33]
    v_cvt_pk_bf16_f32 v78, v156, v157
    v_pk_mul_f32 v[160:161], v[160:161], s[32:33]
    v_cvt_pk_bf16_f32 v79, v158, v159
    v_pk_mul_f32 v[162:163], v[162:163], s[32:33]
    v_cvt_pk_bf16_f32 v80, v160, v161
    v_pk_mul_f32 v[164:165], v[164:165], s[32:33]
    v_cvt_pk_bf16_f32 v81, v162, v163
    v_pk_mul_f32 v[166:167], v[166:167], s[32:33]
    v_cvt_pk_bf16_f32 v82, v164, v165
    v_pk_mul_f32 v[168:169], v[168:169], s[32:33]
    v_cvt_pk_bf16_f32 v83, v166, v167
    v_pk_mul_f32 v[170:171], v[170:171], s[32:33]
    v_cvt_pk_bf16_f32 v84, v168, v169
    v_pk_mul_f32 v[172:173], v[172:173], s[32:33]
    v_cvt_pk_bf16_f32 v85, v170, v171
    v_pk_mul_f32 v[174:175], v[174:175], s[32:33]
    v_cvt_pk_bf16_f32 v86, v172, v173
    v_pk_mul_f32 v[176:177], v[176:177], s[32:33]
    v_cvt_pk_bf16_f32 v87, v174, v175
    v_pk_mul_f32 v[178:179], v[178:179], s[32:33]
    v_cvt_pk_bf16_f32 v88, v176, v177
    v_pk_mul_f32 v[180:181], v[180:181], s[32:33]
    v_cvt_pk_bf16_f32 v89, v178, v179
    v_pk_mul_f32 v[182:183], v[182:183], s[32:33]
    v_cvt_pk_bf16_f32 v90, v180, v181
    v_pk_mul_f32 v[184:185], v[184:185], s[32:33]
    v_cvt_pk_bf16_f32 v91, v182, v183
    v_pk_mul_f32 v[186:187], v[186:187], s[32:33]
    v_cvt_pk_bf16_f32 v92, v184, v185
    v_pk_mul_f32 v[188:189], v[188:189], s[32:33]
    v_cvt_pk_bf16_f32 v93, v186, v187
    v_pk_mul_f32 v[190:191], v[190:191], s[32:33]
    v_cvt_pk_bf16_f32 v94, v188, v189
    v_cvt_pk_bf16_f32 v95, v190, v191
    s_waitcnt lgkmcnt(0)
    v_mfma_f32_16x16x32_bf16 v[96:99], a[192:195], v[0:3], 0
    v_mfma_f32_16x16x32_bf16 v[100:103], a[208:211], v[0:3], 0
    v_mfma_f32_16x16x32_bf16 v[96:99], a[196:199], v[4:7], v[96:99]
    v_mfma_f32_16x16x32_bf16 v[100:103], a[212:215], v[4:7], v[100:103]
    v_mfma_f32_16x16x32_bf16 v[96:99], a[200:203], v[8:11], v[96:99]
    v_mfma_f32_16x16x32_bf16 v[100:103], a[216:219], v[8:11], v[100:103]
    v_mfma_f32_16x16x32_bf16 v[96:99], a[204:207], v[12:15], v[96:99]
    v_mfma_f32_16x16x32_bf16 v[100:103], a[220:223], v[12:15], v[100:103]
    v_mfma_f32_16x16x32_bf16 v[104:107], a[192:195], v[16:19], 0
    v_mfma_f32_16x16x32_bf16 v[108:111], a[208:211], v[16:19], 0
    v_mfma_f32_16x16x32_bf16 v[104:107], a[196:199], v[20:23], v[104:107]
    v_mfma_f32_16x16x32_bf16 v[108:111], a[212:215], v[20:23], v[108:111]
    v_mfma_f32_16x16x32_bf16 v[104:107], a[200:203], v[24:27], v[104:107]
    v_mfma_f32_16x16x32_bf16 v[108:111], a[216:219], v[24:27], v[108:111]
    v_mfma_f32_16x16x32_bf16 v[104:107], a[204:207], v[28:31], v[104:107]
    v_mfma_f32_16x16x32_bf16 v[108:111], a[220:223], v[28:31], v[108:111]
    s_nop 3
    v_max3_f32 v240, v96, v97, v98
    v_max3_f32 v240, v240, v99, v100
    v_max3_f32 v240, v240, v101, v102
    v_max_f32 v240, v240, v103
    v_mov_b32 v241, v240
    s_nop 1
    v_permlane16_swap_b32 v240, v241
    s_nop 1
    v_max_f32 v240, v240, v241
    v_mov_b32 v241, v240
    s_nop 1
    v_permlane32_swap_b32 v240, v241
    s_waitcnt vmcnt(24)
    s_nop 1
    v_max_f32 v240, v240, v241
    v_sub_f32 v144, 0, v240
    s_barrier
    v_sub_f32 v145, 0, v240
    v_sub_f32 v146, 0, v240
    v_sub_f32 v147, 0, v240
    s_add_u32 m0, s24, 0
    v_sub_f32 v96, v96, v240
    v_sub_f32 v97, v97, v240
    v_sub_f32 v98, v98, v240
    buffer_load_dwordx4 v232, s[4:7], s28 offen offset:0 sc0 sc1 nt lds
    ds_read_b64_tr_b16 a[224:225], v224 offset:49152
    v_sub_f32 v99, v99, v240
    v_sub_f32 v100, v100, v240
    v_sub_f32 v101, v101, v240
    v_sub_f32 v102, v102, v240
    buffer_load_dwordx4 v232, s[4:7], s28 offen offset:1024 sc0 sc1 nt lds
    ds_read_b64_tr_b16 a[226:227], v224 offset:50176
    v_sub_f32 v103, v103, v240
    v_exp_f32 v96, v96
    buffer_load_dwordx4 v233, s[4:7], s28 offen offset:2048 sc0 sc1 nt lds
    ds_read_b64_tr_b16 a[228:229], v225 offset:49152
    v_exp_f32 v97, v97
    buffer_load_dwordx4 v233, s[4:7], s28 offen offset:3072 sc0 sc1 nt lds
    ds_read_b64_tr_b16 a[230:231], v225 offset:50176
    v_exp_f32 v98, v98
    v_exp_f32 v99, v99
    s_add_u32 s28, s28, 8192
    ds_read_b64_tr_b16 a[232:233], v226 offset:49152
    v_cvt_pk_bf16_f32 v168, v96, v97
    v_exp_f32 v100, v100
    ds_read_b64_tr_b16 a[234:235], v226 offset:50176
    v_exp_f32 v101, v101
    v_cvt_pk_bf16_f32 v169, v98, v99
    ds_read_b64_tr_b16 a[236:237], v227 offset:49152
    v_exp_f32 v102, v102
    ds_read_b64_tr_b16 a[238:239], v227 offset:50176
    v_exp_f32 v103, v103
    v_cvt_pk_bf16_f32 v170, v100, v101
    v_cvt_pk_bf16_f32 v171, v102, v103
    v_mfma_f32_16x16x32_bf16 v[112:115], a[192:195], v[32:35], 0
    ds_read_b64_tr_b16 a[240:241], v228 offset:49152
    v_max3_f32 v242, v104, v105, v106
    v_max3_f32 v242, v242, v107, v108
    v_max3_f32 v242, v242, v109, v110
    v_mfma_f32_16x16x32_bf16 v[116:119], a[208:211], v[32:35], 0
    ds_read_b64_tr_b16 a[242:243], v228 offset:50176
    v_max_f32 v242, v242, v111
    v_mov_b32 v243, v242
    s_nop 1
    v_mfma_f32_16x16x32_bf16 v[112:115], a[196:199], v[36:39], v[112:115]
    ds_read_b64_tr_b16 a[244:245], v229 offset:49152
    v_permlane16_swap_b32 v242, v243
    s_nop 1
    v_max_f32 v242, v242, v243
    v_mfma_f32_16x16x32_bf16 v[116:119], a[212:215], v[36:39], v[116:119]
    ds_read_b64_tr_b16 a[246:247], v229 offset:50176
    v_mov_b32 v243, v242
    s_nop 1
    v_permlane32_swap_b32 v242, v243
    v_mfma_f32_16x16x32_bf16 v[112:115], a[200:203], v[40:43], v[112:115]
    ds_read_b64_tr_b16 a[248:249], v230 offset:49152
    s_nop 1
    v_max_f32 v242, v242, v243
    v_sub_f32 v148, 0, v242
    v_mfma_f32_16x16x32_bf16 v[116:119], a[216:219], v[40:43], v[116:119]
    ds_read_b64_tr_b16 a[250:251], v230 offset:50176
    v_sub_f32 v149, 0, v242
    v_sub_f32 v150, 0, v242
    v_sub_f32 v151, 0, v242
    v_mfma_f32_16x16x32_bf16 v[112:115], a[204:207], v[44:47], v[112:115]
    ds_read_b64_tr_b16 a[252:253], v231 offset:49152
    v_sub_f32 v104, v104, v242
    v_sub_f32 v105, v105, v242
    v_sub_f32 v106, v106, v242
    v_mfma_f32_16x16x32_bf16 v[116:119], a[220:223], v[44:47], v[116:119]
    ds_read_b64_tr_b16 a[254:255], v231 offset:50176
    v_sub_f32 v107, v107, v242
    v_sub_f32 v108, v108, v242
    v_sub_f32 v109, v109, v242
    v_sub_f32 v110, v110, v242
    v_mfma_f32_16x16x32_bf16 v[120:123], a[192:195], v[48:51], 0
    v_sub_f32 v111, v111, v242
    v_exp_f32 v104, v104
    v_mfma_f32_16x16x32_bf16 v[124:127], a[208:211], v[48:51], 0
    v_exp_f32 v105, v105
    v_mfma_f32_16x16x32_bf16 v[120:123], a[196:199], v[52:55], v[120:123]
    v_exp_f32 v106, v106
    v_exp_f32 v107, v107
    v_mfma_f32_16x16x32_bf16 v[124:127], a[212:215], v[52:55], v[124:127]
    v_cvt_pk_bf16_f32 v172, v104, v105
    v_exp_f32 v108, v108
    v_mfma_f32_16x16x32_bf16 v[120:123], a[200:203], v[56:59], v[120:123]
    v_exp_f32 v109, v109
    v_cvt_pk_bf16_f32 v173, v106, v107
    v_max3_f32 v240, v112, v113, v114
    v_max3_f32 v240, v240, v115, v116
    v_mfma_f32_16x16x32_bf16 v[124:127], a[216:219], v[56:59], v[124:127]
    v_exp_f32 v110, v110
    v_max3_f32 v240, v240, v117, v118
    v_max_f32 v240, v240, v119
    v_mov_b32 v241, v240
    v_mfma_f32_16x16x32_bf16 v[120:123], a[204:207], v[60:63], v[120:123]
    v_exp_f32 v111, v111
    v_cvt_pk_bf16_f32 v174, v108, v109
    v_cvt_pk_bf16_f32 v175, v110, v111
    s_nop 1
    v_permlane16_swap_b32 v240, v241
    v_mfma_f32_16x16x32_bf16 v[124:127], a[220:223], v[60:63], v[124:127]
    s_waitcnt vmcnt(24) lgkmcnt(0)
    s_nop 1
    v_max_f32 v240, v240, v241
    v_mov_b32 v241, v240
    v_mfma_f32_16x16x32_bf16 a[0:3], a[224:227], v[168:171], 0
    s_barrier
    s_nop 1
    v_permlane32_swap_b32 v240, v241
    v_mfma_f32_16x16x32_bf16 a[4:7], a[228:231], v[168:171], 0
    s_add_u32 m0, s25, 49152
    s_nop 1
    v_max_f32 v240, v240, v241
    v_sub_f32 v152, 0, v240
    v_mfma_f32_16x16x32_bf16 a[8:11], a[232:235], v[168:171], 0
    buffer_load_dwordx4 v234, s[76:79], s29 offen offset:0 sc0 sc1 nt lds
    v_sub_f32 v153, 0, v240
    v_sub_f32 v154, 0, v240
    v_mfma_f32_16x16x32_bf16 a[12:15], a[236:239], v[168:171], 0
    buffer_load_dwordx4 v234, s[76:79], s29 offen offset:1024 sc0 sc1 nt lds
    v_sub_f32 v155, 0, v240
    v_sub_f32 v112, v112, v240
    v_sub_f32 v113, v113, v240
    v_mfma_f32_16x16x32_bf16 a[16:19], a[240:243], v[168:171], 0
    buffer_load_dwordx4 v235, s[76:79], s29 offen offset:2048 sc0 sc1 nt lds
    v_sub_f32 v114, v114, v240
    v_sub_f32 v115, v115, v240
    v_mfma_f32_16x16x32_bf16 a[20:23], a[244:247], v[168:171], 0
    buffer_load_dwordx4 v235, s[76:79], s29 offen offset:3072 sc0 sc1 nt lds
    v_sub_f32 v116, v116, v240
    v_sub_f32 v117, v117, v240
    v_sub_f32 v118, v118, v240
    v_mfma_f32_16x16x32_bf16 a[24:27], a[248:251], v[168:171], 0
    s_add_u32 s29, s29, 8192
    v_sub_f32 v119, v119, v240
    v_exp_f32 v112, v112
    v_mfma_f32_16x16x32_bf16 a[28:31], a[252:255], v[168:171], 0
    v_exp_f32 v113, v113
    v_mfma_f32_16x16x32_bf16 v[192:195], v[216:219], v[168:171], 0
    v_exp_f32 v114, v114
    v_mfma_f32_16x16x32_bf16 a[32:35], a[224:227], v[172:175], 0
    v_exp_f32 v115, v115
    v_cvt_pk_bf16_f32 v176, v112, v113
    v_mfma_f32_16x16x32_bf16 a[36:39], a[228:231], v[172:175], 0
    v_exp_f32 v116, v116
    v_mfma_f32_16x16x32_bf16 a[40:43], a[232:235], v[172:175], 0
    v_exp_f32 v117, v117
    v_cvt_pk_bf16_f32 v177, v114, v115
    v_mfma_f32_16x16x32_bf16 a[44:47], a[236:239], v[172:175], 0
    v_exp_f32 v118, v118
    v_mfma_f32_16x16x32_bf16 a[48:51], a[240:243], v[172:175], 0
    v_exp_f32 v119, v119
    v_cvt_pk_bf16_f32 v178, v116, v117
    v_mfma_f32_16x16x32_bf16 a[52:55], a[244:247], v[172:175], 0
    v_cvt_pk_bf16_f32 v179, v118, v119
    v_max3_f32 v242, v120, v121, v122
    v_mfma_f32_16x16x32_bf16 a[56:59], a[248:251], v[172:175], 0
    v_max3_f32 v242, v242, v123, v124
    v_max3_f32 v242, v242, v125, v126
    v_max_f32 v242, v242, v127
    v_mfma_f32_16x16x32_bf16 a[60:63], a[252:255], v[172:175], 0
    v_mov_b32 v243, v242
    s_nop 1
    v_mfma_f32_16x16x32_bf16 v[196:199], v[216:219], v[172:175], 0
    v_permlane16_swap_b32 v242, v243
    s_nop 1
    v_max_f32 v242, v242, v243
    v_mfma_f32_16x16x32_bf16 v[128:131], a[192:195], v[64:67], 0
    v_mov_b32 v243, v242
    s_nop 1
    v_mfma_f32_16x16x32_bf16 v[132:135], a[208:211], v[64:67], 0
    v_permlane32_swap_b32 v242, v243
    s_nop 1
    v_max_f32 v242, v242, v243
    v_mfma_f32_16x16x32_bf16 v[128:131], a[196:199], v[68:71], v[128:131]
    v_sub_f32 v156, 0, v242
    v_sub_f32 v157, 0, v242
    v_mfma_f32_16x16x32_bf16 v[132:135], a[212:215], v[68:71], v[132:135]
    v_sub_f32 v158, 0, v242
    v_sub_f32 v159, 0, v242
    v_sub_f32 v120, v120, v242
    v_mfma_f32_16x16x32_bf16 v[128:131], a[200:203], v[72:75], v[128:131]
    v_sub_f32 v121, v121, v242
    v_sub_f32 v122, v122, v242
    v_mfma_f32_16x16x32_bf16 v[132:135], a[216:219], v[72:75], v[132:135]
    v_sub_f32 v123, v123, v242
    v_sub_f32 v124, v124, v242
    v_sub_f32 v125, v125, v242
    v_mfma_f32_16x16x32_bf16 v[128:131], a[204:207], v[76:79], v[128:131]
    v_sub_f32 v126, v126, v242
    v_sub_f32 v127, v127, v242
    v_mfma_f32_16x16x32_bf16 v[132:135], a[220:223], v[76:79], v[132:135]
    v_exp_f32 v120, v120
    v_mfma_f32_16x16x32_bf16 v[136:139], a[192:195], v[80:83], 0
    v_exp_f32 v121, v121
    v_exp_f32 v122, v122
    v_mfma_f32_16x16x32_bf16 v[140:143], a[208:211], v[80:83], 0
    ds_read_b128 a[192:195], v220 offset:16384
    v_exp_f32 v123, v123
    v_mfma_f32_16x16x32_bf16 v[136:139], a[196:199], v[84:87], v[136:139]
    ds_read_b128 a[208:211], v220 offset:17408
    v_cvt_pk_bf16_f32 v180, v120, v121
    v_exp_f32 v124, v124
    v_mfma_f32_16x16x32_bf16 v[140:143], a[212:215], v[84:87], v[140:143]
    ds_read_b128 a[196:199], v221 offset:16384
    v_exp_f32 v125, v125
    v_mfma_f32_16x16x32_bf16 v[136:139], a[200:203], v[88:91], v[136:139]
    ds_read_b128 a[212:215], v221 offset:17408
    v_cvt_pk_bf16_f32 v181, v122, v123
    v_exp_f32 v126, v126
    v_max3_f32 v240, v128, v129, v130
    v_max3_f32 v240, v240, v131, v132
    v_mfma_f32_16x16x32_bf16 v[140:143], a[216:219], v[88:91], v[140:143]
    ds_read_b128 a[200:203], v222 offset:16384
    v_exp_f32 v127, v127
    v_max3_f32 v240, v240, v133, v134
    v_max_f32 v240, v240, v135
    v_mov_b32 v241, v240
    v_mfma_f32_16x16x32_bf16 v[136:139], a[204:207], v[92:95], v[136:139]
    ds_read_b128 a[216:219], v222 offset:17408
    v_cvt_pk_bf16_f32 v182, v124, v125
    v_cvt_pk_bf16_f32 v183, v126, v127
    s_nop 1
    v_permlane16_swap_b32 v240, v241
    v_mfma_f32_16x16x32_bf16 v[140:143], a[220:223], v[92:95], v[140:143]
    ds_read_b128 a[204:207], v223 offset:16384
    s_nop 1
    v_max_f32 v240, v240, v241
    v_mov_b32 v241, v240
    v_mfma_f32_16x16x32_bf16 a[64:67], a[224:227], v[176:179], 0
    ds_read_b128 a[220:223], v223 offset:17408
    s_nop 1
    v_permlane32_swap_b32 v240, v241
    v_mfma_f32_16x16x32_bf16 a[68:71], a[228:231], v[176:179], 0
    s_nop 1
    v_max_f32 v240, v240, v241
    v_sub_f32 v160, 0, v240
    v_mfma_f32_16x16x32_bf16 a[72:75], a[232:235], v[176:179], 0
    v_sub_f32 v161, 0, v240
    v_sub_f32 v162, 0, v240
    v_mfma_f32_16x16x32_bf16 a[76:79], a[236:239], v[176:179], 0
    v_sub_f32 v163, 0, v240
    v_sub_f32 v128, v128, v240
    v_sub_f32 v129, v129, v240
    v_mfma_f32_16x16x32_bf16 a[80:83], a[240:243], v[176:179], 0
    v_sub_f32 v130, v130, v240
    v_sub_f32 v131, v131, v240
    v_mfma_f32_16x16x32_bf16 a[84:87], a[244:247], v[176:179], 0
    v_sub_f32 v132, v132, v240
    v_sub_f32 v133, v133, v240
    v_sub_f32 v134, v134, v240
    v_mfma_f32_16x16x32_bf16 a[88:91], a[248:251], v[176:179], 0
    v_sub_f32 v135, v135, v240
    v_exp_f32 v128, v128
    v_mfma_f32_16x16x32_bf16 a[92:95], a[252:255], v[176:179], 0
    v_exp_f32 v129, v129
    v_mfma_f32_16x16x32_bf16 v[200:203], v[216:219], v[176:179], 0
    v_exp_f32 v130, v130
    v_mfma_f32_16x16x32_bf16 a[96:99], a[224:227], v[180:183], 0
    v_exp_f32 v131, v131
    v_cvt_pk_bf16_f32 v184, v128, v129
    v_mfma_f32_16x16x32_bf16 a[100:103], a[228:231], v[180:183], 0
    v_exp_f32 v132, v132
    v_mfma_f32_16x16x32_bf16 a[104:107], a[232:235], v[180:183], 0
    v_exp_f32 v133, v133
    v_cvt_pk_bf16_f32 v185, v130, v131
    v_mfma_f32_16x16x32_bf16 a[108:111], a[236:239], v[180:183], 0
    v_exp_f32 v134, v134
    v_mfma_f32_16x16x32_bf16 a[112:115], a[240:243], v[180:183], 0
    v_exp_f32 v135, v135
    v_cvt_pk_bf16_f32 v186, v132, v133
    v_mfma_f32_16x16x32_bf16 a[116:119], a[244:247], v[180:183], 0
    v_cvt_pk_bf16_f32 v187, v134, v135
    v_max3_f32 v242, v136, v137, v138
    v_mfma_f32_16x16x32_bf16 a[120:123], a[248:251], v[180:183], 0
    v_max3_f32 v242, v242, v139, v140
    v_max3_f32 v242, v242, v141, v142
    v_max_f32 v242, v242, v143
    v_mfma_f32_16x16x32_bf16 a[124:127], a[252:255], v[180:183], 0
    v_mov_b32 v243, v242
    s_nop 1
    v_mfma_f32_16x16x32_bf16 v[204:207], v[216:219], v[180:183], 0
    s_waitcnt lgkmcnt(0)
    v_permlane16_swap_b32 v242, v243
    s_nop 1
    v_max_f32 v242, v242, v243
    v_mfma_f32_16x16x32_bf16 v[96:99], a[192:195], v[0:3], v[144:147]
    v_mov_b32 v243, v242
    s_nop 1
    v_mfma_f32_16x16x32_bf16 v[100:103], a[208:211], v[0:3], v[144:147]
    v_permlane32_swap_b32 v242, v243
    s_nop 1
    v_max_f32 v242, v242, v243
    v_mfma_f32_16x16x32_bf16 v[96:99], a[196:199], v[4:7], v[96:99]
    v_sub_f32 v164, 0, v242
    v_sub_f32 v165, 0, v242
    v_mfma_f32_16x16x32_bf16 v[100:103], a[212:215], v[4:7], v[100:103]
    v_sub_f32 v166, 0, v242
    v_sub_f32 v167, 0, v242
    v_sub_f32 v136, v136, v242
    v_mfma_f32_16x16x32_bf16 v[96:99], a[200:203], v[8:11], v[96:99]
    v_sub_f32 v137, v137, v242
    v_sub_f32 v138, v138, v242
    v_mfma_f32_16x16x32_bf16 v[100:103], a[216:219], v[8:11], v[100:103]
    v_sub_f32 v139, v139, v242
    v_sub_f32 v140, v140, v242
    v_sub_f32 v141, v141, v242
    v_mfma_f32_16x16x32_bf16 v[96:99], a[204:207], v[12:15], v[96:99]
    v_sub_f32 v142, v142, v242
    v_sub_f32 v143, v143, v242
    v_mfma_f32_16x16x32_bf16 v[100:103], a[220:223], v[12:15], v[100:103]
    v_exp_f32 v136, v136
    v_mfma_f32_16x16x32_bf16 v[104:107], a[192:195], v[16:19], v[148:151]
    v_exp_f32 v137, v137
    v_exp_f32 v138, v138
    v_mfma_f32_16x16x32_bf16 v[108:111], a[208:211], v[16:19], v[148:151]
    v_exp_f32 v139, v139
    v_mfma_f32_16x16x32_bf16 v[104:107], a[196:199], v[20:23], v[104:107]
    v_cvt_pk_bf16_f32 v188, v136, v137
    v_exp_f32 v140, v140
    v_mfma_f32_16x16x32_bf16 v[108:111], a[212:215], v[20:23], v[108:111]
    v_exp_f32 v141, v141
    v_mfma_f32_16x16x32_bf16 v[104:107], a[200:203], v[24:27], v[104:107]
    v_cvt_pk_bf16_f32 v189, v138, v139
    v_exp_f32 v142, v142
    v_mfma_f32_16x16x32_bf16 v[108:111], a[216:219], v[24:27], v[108:111]
    v_exp_f32 v143, v143
    v_mfma_f32_16x16x32_bf16 v[104:107], a[204:207], v[28:31], v[104:107]
    v_cvt_pk_bf16_f32 v190, v140, v141
    v_cvt_pk_bf16_f32 v191, v142, v143
    v_mfma_f32_16x16x32_bf16 v[108:111], a[220:223], v[28:31], v[108:111]
    v_mfma_f32_16x16x32_bf16 a[128:131], a[224:227], v[184:187], 0
    v_mfma_f32_16x16x32_bf16 a[132:135], a[228:231], v[184:187], 0
    v_mfma_f32_16x16x32_bf16 a[136:139], a[232:235], v[184:187], 0
    v_mfma_f32_16x16x32_bf16 a[140:143], a[236:239], v[184:187], 0
    v_max3_f32 v238, v96, v97, v98
    v_max3_f32 v238, v238, v99, v100
    v_mfma_f32_16x16x32_bf16 a[144:147], a[240:243], v[184:187], 0
    v_max3_f32 v238, v238, v101, v102
    v_max3_f32 v238, v238, v103, v104
    v_mfma_f32_16x16x32_bf16 a[148:151], a[244:247], v[184:187], 0
    v_max3_f32 v238, v238, v105, v106
    v_max3_f32 v238, v238, v107, v108
    v_mfma_f32_16x16x32_bf16 a[152:155], a[248:251], v[184:187], 0
    v_max3_f32 v238, v238, v109, v110
    v_max_f32 v238, v238, v111
    v_mfma_f32_16x16x32_bf16 a[156:159], a[252:255], v[184:187], 0
    s_waitcnt vmcnt(24)
    v_cmp_nge_f32 vcc, s34, v238
    v_mfma_f32_16x16x32_bf16 v[208:211], v[216:219], v[184:187], 0
    s_barrier
    s_cbranch_vccnz Ltr0
Lret0:
    v_mfma_f32_16x16x32_bf16 a[160:163], a[224:227], v[188:191], 0
    v_exp_f32 v96, v96
    v_mfma_f32_16x16x32_bf16 a[164:167], a[228:231], v[188:191], 0
    s_add_u32 m0, s24, 16384
    v_exp_f32 v97, v97
    v_mfma_f32_16x16x32_bf16 a[168:171], a[232:235], v[188:191], 0
    buffer_load_dwordx4 v232, s[4:7], s28 offen offset:0 sc0 sc1 nt lds
    ds_read_b64_tr_b16 a[224:225], v224 offset:0
    v_mfma_f32_16x16x32_bf16 a[172:175], a[236:239], v[188:191], 0
    v_exp_f32 v98, v98
    v_mfma_f32_16x16x32_bf16 a[176:179], a[240:243], v[188:191], 0
    buffer_load_dwordx4 v232, s[4:7], s28 offen offset:1024 sc0 sc1 nt lds
    ds_read_b64_tr_b16 a[226:227], v224 offset:1024
    v_mfma_f32_16x16x32_bf16 a[180:183], a[244:247], v[188:191], 0
    v_exp_f32 v99, v99
    v_mfma_f32_16x16x32_bf16 a[184:187], a[248:251], v[188:191], 0
    buffer_load_dwordx4 v233, s[4:7], s28 offen offset:2048 sc0 sc1 nt lds
    v_cvt_pk_bf16_f32 v168, v96, v97
    v_mfma_f32_16x16x32_bf16 a[188:191], a[252:255], v[188:191], 0
    v_exp_f32 v100, v100
    v_mfma_f32_16x16x32_bf16 v[212:215], v[216:219], v[188:191], 0
    buffer_load_dwordx4 v233, s[4:7], s28 offen offset:3072 sc0 sc1 nt lds
    s_add_u32 s28, s28, 8192
    ds_read_b64_tr_b16 a[228:229], v225 offset:0
    v_mfma_f32_16x16x32_bf16 v[112:115], a[192:195], v[32:35], v[152:155]
    v_exp_f32 v101, v101
    v_mfma_f32_16x16x32_bf16 v[116:119], a[208:211], v[32:35], v[152:155]
    ds_read_b64_tr_b16 a[230:231], v225 offset:1024
    v_cvt_pk_bf16_f32 v169, v98, v99
    v_mfma_f32_16x16x32_bf16 v[112:115], a[196:199], v[36:39], v[112:115]
    v_exp_f32 v102, v102
    v_mfma_f32_16x16x32_bf16 v[116:119], a[212:215], v[36:39], v[116:119]
    v_exp_f32 v103, v103
    v_mfma_f32_16x16x32_bf16 v[112:115], a[200:203], v[40:43], v[112:115]
    ds_read_b64_tr_b16 a[232:233], v226 offset:0
    v_cvt_pk_bf16_f32 v170, v100, v101
    v_mfma_f32_16x16x32_bf16 v[116:119], a[216:219], v[40:43], v[116:119]
    ds_read_b64_tr_b16 a[234:235], v226 offset:1024
    v_cvt_pk_bf16_f32 v171, v102, v103
    v_mfma_f32_16x16x32_bf16 v[112:115], a[204:207], v[44:47], v[112:115]
    v_exp_f32 v104, v104
    v_mfma_f32_16x16x32_bf16 v[116:119], a[220:223], v[44:47], v[116:119]
    v_exp_f32 v105, v105
    v_mfma_f32_16x16x32_bf16 v[120:123], a[192:195], v[48:51], v[156:159]
    ds_read_b64_tr_b16 a[236:237], v227 offset:0
    ds_read_b64_tr_b16 a[238:239], v227 offset:1024
    v_mfma_f32_16x16x32_bf16 v[124:127], a[208:211], v[48:51], v[156:159]
    ds_read_b64_tr_b16 a[240:241], v228 offset:0
    ds_read_b64_tr_b16 a[242:243], v228 offset:1024
    v_mfma_f32_16x16x32_bf16 v[120:123], a[196:199], v[52:55], v[120:123]
    ds_read_b64_tr_b16 a[244:245], v229 offset:0
    ds_read_b64_tr_b16 a[246:247], v229 offset:1024
    v_mfma_f32_16x16x32_bf16 v[124:127], a[212:215], v[52:55], v[124:127]
    ds_read_b64_tr_b16 a[248:249], v230 offset:0
    ds_read_b64_tr_b16 a[250:251], v230 offset:1024
    v_mfma_f32_16x16x32_bf16 v[120:123], a[200:203], v[56:59], v[120:123]
    ds_read_b64_tr_b16 a[252:253], v231 offset:0
    ds_read_b64_tr_b16 a[254:255], v231 offset:1024
    v_mfma_f32_16x16x32_bf16 v[124:127], a[216:219], v[56:59], v[124:127]
    v_exp_f32 v106, v106
    v_mfma_f32_16x16x32_bf16 v[120:123], a[204:207], v[60:63], v[120:123]
    v_exp_f32 v107, v107
    v_mfma_f32_16x16x32_bf16 v[124:127], a[220:223], v[60:63], v[124:127]
    s_waitcnt vmcnt(24) lgkmcnt(0)
    v_cvt_pk_bf16_f32 v172, v104, v105
    v_mfma_f32_16x16x32_bf16 a[0:3], a[224:227], v[168:171], a[0:3]
    s_barrier
    v_exp_f32 v108, v108
    v_mfma_f32_16x16x32_bf16 a[4:7], a[228:231], v[168:171], a[4:7]
    s_add_u32 m0, s25, 0
    v_exp_f32 v109, v109
    v_mfma_f32_16x16x32_bf16 a[8:11], a[232:235], v[168:171], a[8:11]
    buffer_load_dwordx4 v234, s[76:79], s29 offen offset:0 sc0 sc1 nt lds
    v_cvt_pk_bf16_f32 v173, v106, v107
    v_mfma_f32_16x16x32_bf16 a[12:15], a[236:239], v[168:171], a[12:15]
    v_exp_f32 v110, v110
    v_mfma_f32_16x16x32_bf16 a[16:19], a[240:243], v[168:171], a[16:19]
    v_exp_f32 v111, v111
    v_mfma_f32_16x16x32_bf16 a[20:23], a[244:247], v[168:171], a[20:23]
    buffer_load_dwordx4 v234, s[76:79], s29 offen offset:1024 sc0 sc1 nt lds
    v_cvt_pk_bf16_f32 v174, v108, v109
    v_mfma_f32_16x16x32_bf16 a[24:27], a[248:251], v[168:171], a[24:27]
    v_cvt_pk_bf16_f32 v175, v110, v111
    v_max3_f32 v239, v112, v113, v114
    v_mfma_f32_16x16x32_bf16 a[28:31], a[252:255], v[168:171], a[28:31]
    buffer_load_dwordx4 v235, s[76:79], s29 offen offset:2048 sc0 sc1 nt lds
    v_max3_f32 v239, v239, v115, v116
    v_mfma_f32_16x16x32_bf16 v[192:195], v[216:219], v[168:171], v[192:195]
    v_max3_f32 v239, v239, v117, v118
    v_max3_f32 v239, v239, v119, v120
    v_mfma_f32_16x16x32_bf16 a[32:35], a[224:227], v[172:175], a[32:35]
    buffer_load_dwordx4 v235, s[76:79], s29 offen offset:3072 sc0 sc1 nt lds
    v_max3_f32 v239, v239, v121, v122
    v_mfma_f32_16x16x32_bf16 a[36:39], a[228:231], v[172:175], a[36:39]
    s_add_u32 s29, s29, 8192
    v_max3_f32 v239, v239, v123, v124
    v_max3_f32 v239, v239, v125, v126
    v_mfma_f32_16x16x32_bf16 a[40:43], a[232:235], v[172:175], a[40:43]
    v_max_f32 v239, v239, v127
    v_cmp_nge_f32 vcc, s34, v239
    v_mfma_f32_16x16x32_bf16 a[44:47], a[236:239], v[172:175], a[44:47]
    s_cbranch_vccnz Ltr1
Lret1:
    v_mfma_f32_16x16x32_bf16 a[48:51], a[240:243], v[172:175], a[48:51]
    v_exp_f32 v112, v112
    v_mfma_f32_16x16x32_bf16 a[52:55], a[244:247], v[172:175], a[52:55]
    v_exp_f32 v113, v113
    v_mfma_f32_16x16x32_bf16 a[56:59], a[248:251], v[172:175], a[56:59]
    v_exp_f32 v114, v114
    v_mfma_f32_16x16x32_bf16 a[60:63], a[252:255], v[172:175], a[60:63]
    v_exp_f32 v115, v115
    v_mfma_f32_16x16x32_bf16 v[196:199], v[216:219], v[172:175], v[196:199]
    v_cvt_pk_bf16_f32 v176, v112, v113
    v_mfma_f32_16x16x32_bf16 v[128:131], a[192:195], v[64:67], v[160:163]
    v_exp_f32 v116, v116
    v_mfma_f32_16x16x32_bf16 v[132:135], a[208:211], v[64:67], v[160:163]
    v_exp_f32 v117, v117
    v_mfma_f32_16x16x32_bf16 v[128:131], a[196:199], v[68:71], v[128:131]
    v_cvt_pk_bf16_f32 v177, v114, v115
    v_mfma_f32_16x16x32_bf16 v[132:135], a[212:215], v[68:71], v[132:135]
    v_exp_f32 v118, v118
    v_mfma_f32_16x16x32_bf16 v[128:131], a[200:203], v[72:75], v[128:131]
    v_exp_f32 v119, v119
    v_mfma_f32_16x16x32_bf16 v[132:135], a[216:219], v[72:75], v[132:135]
    v_cvt_pk_bf16_f32 v178, v116, v117
    v_cvt_pk_bf16_f32 v179, v118, v119
    v_mfma_f32_16x16x32_bf16 v[128:131], a[204:207], v[76:79], v[128:131]
    v_exp_f32 v120, v120
    v_mfma_f32_16x16x32_bf16 v[132:135], a[220:223], v[76:79], v[132:135]
    v_exp_f32 v121, v121
    v_mfma_f32_16x16x32_bf16 v[136:139], a[192:195], v[80:83], v[164:167]
    v_exp_f32 v122, v122
    v_mfma_f32_16x16x32_bf16 v[140:143], a[208:211], v[80:83], v[164:167]
    v_exp_f32 v123, v123
    v_mfma_f32_16x16x32_bf16 v[136:139], a[196:199], v[84:87], v[136:139]
    ds_read_b128 a[192:195], v220 offset:32768
    v_cvt_pk_bf16_f32 v180, v120, v121
    v_mfma_f32_16x16x32_bf16 v[140:143], a[212:215], v[84:87], v[140:143]
    v_exp_f32 v124, v124
    v_mfma_f32_16x16x32_bf16 v[136:139], a[200:203], v[88:91], v[136:139]
    v_exp_f32 v125, v125
    v_mfma_f32_16x16x32_bf16 v[140:143], a[216:219], v[88:91], v[140:143]
    ds_read_b128 a[208:211], v220 offset:33792
    v_cvt_pk_bf16_f32 v181, v122, v123
    v_mfma_f32_16x16x32_bf16 v[136:139], a[204:207], v[92:95], v[136:139]
    v_exp_f32 v126, v126
    v_mfma_f32_16x16x32_bf16 v[140:143], a[220:223], v[92:95], v[140:143]
    v_exp_f32 v127, v127
    v_mfma_f32_16x16x32_bf16 a[64:67], a[224:227], v[176:179], a[64:67]
    ds_read_b128 a[196:199], v221 offset:32768
    v_cvt_pk_bf16_f32 v182, v124, v125
    v_mfma_f32_16x16x32_bf16 a[68:71], a[228:231], v[176:179], a[68:71]
    ds_read_b128 a[212:215], v221 offset:33792
    v_cvt_pk_bf16_f32 v183, v126, v127
    v_mfma_f32_16x16x32_bf16 a[72:75], a[232:235], v[176:179], a[72:75]
    ds_read_b128 a[200:203], v222 offset:32768
    v_mfma_f32_16x16x32_bf16 a[76:79], a[236:239], v[176:179], a[76:79]
    ds_read_b128 a[216:219], v222 offset:33792
    v_max3_f32 v238, v128, v129, v130
    v_mfma_f32_16x16x32_bf16 a[80:83], a[240:243], v[176:179], a[80:83]
    ds_read_b128 a[204:207], v223 offset:32768
    v_max3_f32 v238, v238, v131, v132
    v_mfma_f32_16x16x32_bf16 a[84:87], a[244:247], v[176:179], a[84:87]
    ds_read_b128 a[220:223], v223 offset:33792
    v_max3_f32 v238, v238, v133, v134
    v_mfma_f32_16x16x32_bf16 a[88:91], a[248:251], v[176:179], a[88:91]
    v_max3_f32 v238, v238, v135, v136
    v_max3_f32 v238, v238, v137, v138
    v_mfma_f32_16x16x32_bf16 a[92:95], a[252:255], v[176:179], a[92:95]
    v_max3_f32 v238, v238, v139, v140
    v_max3_f32 v238, v238, v141, v142
    v_mfma_f32_16x16x32_bf16 v[200:203], v[216:219], v[176:179], v[200:203]
    v_max_f32 v238, v238, v143
    v_cmp_nge_f32 vcc, s34, v238
    v_mfma_f32_16x16x32_bf16 a[96:99], a[224:227], v[180:183], a[96:99]
    s_cbranch_vccnz Ltr2
Lret2:
    v_mfma_f32_16x16x32_bf16 a[100:103], a[228:231], v[180:183], a[100:103]
    v_exp_f32 v128, v128
    v_mfma_f32_16x16x32_bf16 a[104:107], a[232:235], v[180:183], a[104:107]
    v_exp_f32 v129, v129
    v_mfma_f32_16x16x32_bf16 a[108:111], a[236:239], v[180:183], a[108:111]
    v_exp_f32 v130, v130
    v_mfma_f32_16x16x32_bf16 a[112:115], a[240:243], v[180:183], a[112:115]
    v_exp_f32 v131, v131
    v_mfma_f32_16x16x32_bf16 a[116:119], a[244:247], v[180:183], a[116:119]
    v_cvt_pk_bf16_f32 v184, v128, v129
    v_mfma_f32_16x16x32_bf16 a[120:123], a[248:251], v[180:183], a[120:123]
    v_exp_f32 v132, v132
    v_mfma_f32_16x16x32_bf16 a[124:127], a[252:255], v[180:183], a[124:127]
    v_exp_f32 v133, v133
    v_mfma_f32_16x16x32_bf16 v[204:207], v[216:219], v[180:183], v[204:207]
    s_waitcnt lgkmcnt(0)
    v_cvt_pk_bf16_f32 v185, v130, v131
    v_mfma_f32_16x16x32_bf16 v[96:99], a[192:195], v[0:3], v[144:147]
    v_exp_f32 v134, v134
    v_mfma_f32_16x16x32_bf16 v[100:103], a[208:211], v[0:3], v[144:147]
    v_exp_f32 v135, v135
    v_mfma_f32_16x16x32_bf16 v[96:99], a[196:199], v[4:7], v[96:99]
    v_cvt_pk_bf16_f32 v186, v132, v133
    v_cvt_pk_bf16_f32 v187, v134, v135
    v_mfma_f32_16x16x32_bf16 v[100:103], a[212:215], v[4:7], v[100:103]
    v_exp_f32 v136, v136
    v_mfma_f32_16x16x32_bf16 v[96:99], a[200:203], v[8:11], v[96:99]
    v_exp_f32 v137, v137
    v_mfma_f32_16x16x32_bf16 v[100:103], a[216:219], v[8:11], v[100:103]
    v_exp_f32 v138, v138
    v_mfma_f32_16x16x32_bf16 v[96:99], a[204:207], v[12:15], v[96:99]
    v_exp_f32 v139, v139
    v_mfma_f32_16x16x32_bf16 v[100:103], a[220:223], v[12:15], v[100:103]
    v_cvt_pk_bf16_f32 v188, v136, v137
    v_mfma_f32_16x16x32_bf16 v[104:107], a[192:195], v[16:19], v[148:151]
    v_exp_f32 v140, v140
    v_mfma_f32_16x16x32_bf16 v[108:111], a[208:211], v[16:19], v[148:151]
    v_exp_f32 v141, v141
    v_mfma_f32_16x16x32_bf16 v[104:107], a[196:199], v[20:23], v[104:107]
    v_cvt_pk_bf16_f32 v189, v138, v139
    v_mfma_f32_16x16x32_bf16 v[108:111], a[212:215], v[20:23], v[108:111]
    v_exp_f32 v142, v142
    v_mfma_f32_16x16x32_bf16 v[104:107], a[200:203], v[24:27], v[104:107]
    v_exp_f32 v143, v143
    v_mfma_f32_16x16x32_bf16 v[108:111], a[216:219], v[24:27], v[108:111]
    v_cvt_pk_bf16_f32 v190, v140, v141
    v_cvt_pk_bf16_f32 v191, v142, v143
    v_mfma_f32_16x16x32_bf16 v[104:107], a[204:207], v[28:31], v[104:107]
    v_mfma_f32_16x16x32_bf16 v[108:111], a[220:223], v[28:31], v[108:111]
    v_mfma_f32_16x16x32_bf16 a[128:131], a[224:227], v[184:187], a[128:131]
    v_mfma_f32_16x16x32_bf16 a[132:135], a[228:231], v[184:187], a[132:135]
    v_mfma_f32_16x16x32_bf16 a[136:139], a[232:235], v[184:187], a[136:139]
    v_mfma_f32_16x16x32_bf16 a[140:143], a[236:239], v[184:187], a[140:143]
    v_max3_f32 v238, v96, v97, v98
    v_max3_f32 v238, v238, v99, v100
    v_mfma_f32_16x16x32_bf16 a[144:147], a[240:243], v[184:187], a[144:147]
    v_max3_f32 v238, v238, v101, v102
    v_max3_f32 v238, v238, v103, v104
    v_mfma_f32_16x16x32_bf16 a[148:151], a[244:247], v[184:187], a[148:151]
    v_max3_f32 v238, v238, v105, v106
    v_max3_f32 v238, v238, v107, v108
    v_mfma_f32_16x16x32_bf16 a[152:155], a[248:251], v[184:187], a[152:155]
    v_max3_f32 v238, v238, v109, v110
    v_max_f32 v238, v238, v111
    v_mfma_f32_16x16x32_bf16 a[156:159], a[252:255], v[184:187], a[156:159]
    s_waitcnt vmcnt(24)
    v_cmp_nge_f32 vcc, s34, v238
    v_mfma_f32_16x16x32_bf16 v[208:211], v[216:219], v[184:187], v[208:211]
    s_barrier
    s_cbranch_vccnz Ltr3
Lret3:
    v_mfma_f32_16x16x32_bf16 a[160:163], a[224:227], v[188:191], a[160:163]
    v_exp_f32 v96, v96
    v_mfma_f32_16x16x32_bf16 a[164:167], a[228:231], v[188:191], a[164:167]
    s_add_u32 m0, s24, 32768
    v_exp_f32 v97, v97
    v_mfma_f32_16x16x32_bf16 a[168:171], a[232:235], v[188:191], a[168:171]
    buffer_load_dwordx4 v232, s[4:7], s28 offen offset:0 sc0 sc1 nt lds
    ds_read_b64_tr_b16 a[224:225], v224 offset:16384
    v_mfma_f32_16x16x32_bf16 a[172:175], a[236:239], v[188:191], a[172:175]
    v_exp_f32 v98, v98
    v_mfma_f32_16x16x32_bf16 a[176:179], a[240:243], v[188:191], a[176:179]
    buffer_load_dwordx4 v232, s[4:7], s28 offen offset:1024 sc0 sc1 nt lds
    ds_read_b64_tr_b16 a[226:227], v224 offset:17408
    v_mfma_f32_16x16x32_bf16 a[180:183], a[244:247], v[188:191], a[180:183]
    v_exp_f32 v99, v99
    v_mfma_f32_16x16x32_bf16 a[184:187], a[248:251], v[188:191], a[184:187]
    buffer_load_dwordx4 v233, s[4:7], s28 offen offset:2048 sc0 sc1 nt lds
    v_cvt_pk_bf16_f32 v168, v96, v97
    v_mfma_f32_16x16x32_bf16 a[188:191], a[252:255], v[188:191], a[188:191]
    v_exp_f32 v100, v100
    v_mfma_f32_16x16x32_bf16 v[212:215], v[216:219], v[188:191], v[212:215]
    buffer_load_dwordx4 v233, s[4:7], s28 offen offset:3072 sc0 sc1 nt lds
    s_add_u32 s28, s28, 8192
    ds_read_b64_tr_b16 a[228:229], v225 offset:16384
    v_mfma_f32_16x16x32_bf16 v[112:115], a[192:195], v[32:35], v[152:155]
    v_exp_f32 v101, v101
    v_mfma_f32_16x16x32_bf16 v[116:119], a[208:211], v[32:35], v[152:155]
    ds_read_b64_tr_b16 a[230:231], v225 offset:17408
    v_cvt_pk_bf16_f32 v169, v98, v99
    v_mfma_f32_16x16x32_bf16 v[112:115], a[196:199], v[36:39], v[112:115]
    v_exp_f32 v102, v102
    v_mfma_f32_16x16x32_bf16 v[116:119], a[212:215], v[36:39], v[116:119]
    v_exp_f32 v103, v103
    v_mfma_f32_16x16x32_bf16 v[112:115], a[200:203], v[40:43], v[112:115]
    ds_read_b64_tr_b16 a[232:233], v226 offset:16384
    v_cvt_pk_bf16_f32 v170, v100, v101
    v_mfma_f32_16x16x32_bf16 v[116:119], a[216:219], v[40:43], v[116:119]
    ds_read_b64_tr_b16 a[234:235], v226 offset:17408
    v_cvt_pk_bf16_f32 v171, v102, v103
    v_mfma_f32_16x16x32_bf16 v[112:115], a[204:207], v[44:47], v[112:115]
    v_exp_f32 v104, v104
    v_mfma_f32_16x16x32_bf16 v[116:119], a[220:223], v[44:47], v[116:119]
    v_exp_f32 v105, v105
    v_mfma_f32_16x16x32_bf16 v[120:123], a[192:195], v[48:51], v[156:159]
    ds_read_b64_tr_b16 a[236:237], v227 offset:16384
    ds_read_b64_tr_b16 a[238:239], v227 offset:17408
    v_mfma_f32_16x16x32_bf16 v[124:127], a[208:211], v[48:51], v[156:159]
    ds_read_b64_tr_b16 a[240:241], v228 offset:16384
    ds_read_b64_tr_b16 a[242:243], v228 offset:17408
    v_mfma_f32_16x16x32_bf16 v[120:123], a[196:199], v[52:55], v[120:123]
    ds_read_b64_tr_b16 a[244:245], v229 offset:16384
    ds_read_b64_tr_b16 a[246:247], v229 offset:17408
    v_mfma_f32_16x16x32_bf16 v[124:127], a[212:215], v[52:55], v[124:127]
    ds_read_b64_tr_b16 a[248:249], v230 offset:16384
    ds_read_b64_tr_b16 a[250:251], v230 offset:17408
    v_mfma_f32_16x16x32_bf16 v[120:123], a[200:203], v[56:59], v[120:123]
    ds_read_b64_tr_b16 a[252:253], v231 offset:16384
    ds_read_b64_tr_b16 a[254:255], v231 offset:17408
    v_mfma_f32_16x16x32_bf16 v[124:127], a[216:219], v[56:59], v[124:127]
    v_exp_f32 v106, v106
    v_mfma_f32_16x16x32_bf16 v[120:123], a[204:207], v[60:63], v[120:123]
    v_exp_f32 v107, v107
    v_mfma_f32_16x16x32_bf16 v[124:127], a[220:223], v[60:63], v[124:127]
    s_waitcnt vmcnt(24) lgkmcnt(0)
    v_cvt_pk_bf16_f32 v172, v104, v105
    v_mfma_f32_16x16x32_bf16 a[0:3], a[224:227], v[168:171], a[0:3]
    s_barrier
    v_exp_f32 v108, v108
    v_mfma_f32_16x16x32_bf16 a[4:7], a[228:231], v[168:171], a[4:7]
    s_add_u32 m0, s25, 16384
    v_exp_f32 v109, v109
    v_mfma_f32_16x16x32_bf16 a[8:11], a[232:235], v[168:171], a[8:11]
    buffer_load_dwordx4 v234, s[76:79], s29 offen offset:0 sc0 sc1 nt lds
    v_cvt_pk_bf16_f32 v173, v106, v107
    v_mfma_f32_16x16x32_bf16 a[12:15], a[236:239], v[168:171], a[12:15]
    v_exp_f32 v110, v110
    v_mfma_f32_16x16x32_bf16 a[16:19], a[240:243], v[168:171], a[16:19]
    v_exp_f32 v111, v111
    v_mfma_f32_16x16x32_bf16 a[20:23], a[244:247], v[168:171], a[20:23]
    buffer_load_dwordx4 v234, s[76:79], s29 offen offset:1024 sc0 sc1 nt lds
    v_cvt_pk_bf16_f32 v174, v108, v109
    v_mfma_f32_16x16x32_bf16 a[24:27], a[248:251], v[168:171], a[24:27]
    v_cvt_pk_bf16_f32 v175, v110, v111
    v_max3_f32 v239, v112, v113, v114
    v_mfma_f32_16x16x32_bf16 a[28:31], a[252:255], v[168:171], a[28:31]
    buffer_load_dwordx4 v235, s[76:79], s29 offen offset:2048 sc0 sc1 nt lds
    v_max3_f32 v239, v239, v115, v116
    v_mfma_f32_16x16x32_bf16 v[192:195], v[216:219], v[168:171], v[192:195]
    v_max3_f32 v239, v239, v117, v118
    v_max3_f32 v239, v239, v119, v120
    v_mfma_f32_16x16x32_bf16 a[32:35], a[224:227], v[172:175], a[32:35]
    buffer_load_dwordx4 v235, s[76:79], s29 offen offset:3072 sc0 sc1 nt lds
    v_max3_f32 v239, v239, v121, v122
    v_mfma_f32_16x16x32_bf16 a[36:39], a[228:231], v[172:175], a[36:39]
    s_add_u32 s29, s29, 8192
    v_max3_f32 v239, v239, v123, v124
    v_max3_f32 v239, v239, v125, v126
    v_mfma_f32_16x16x32_bf16 a[40:43], a[232:235], v[172:175], a[40:43]
    v_max_f32 v239, v239, v127
    v_cmp_nge_f32 vcc, s34, v239
    v_mfma_f32_16x16x32_bf16 a[44:47], a[236:239], v[172:175], a[44:47]
    s_cbranch_vccnz Ltr4
Lret4:
    v_mfma_f32_16x16x32_bf16 a[48:51], a[240:243], v[172:175], a[48:51]
    v_exp_f32 v112, v112
    v_mfma_f32_16x16x32_bf16 a[52:55], a[244:247], v[172:175], a[52:55]
    v_exp_f32 v113, v113
    v_mfma_f32_16x16x32_bf16 a[56:59], a[248:251], v[172:175], a[56:59]
    v_exp_f32 v114, v114
    v_mfma_f32_16x16x32_bf16 a[60:63], a[252:255], v[172:175], a[60:63]
    v_exp_f32 v115, v115
    v_mfma_f32_16x16x32_bf16 v[196:199], v[216:219], v[172:175], v[196:199]
    v_cvt_pk_bf16_f32 v176, v112, v113
    v_mfma_f32_16x16x32_bf16 v[128:131], a[192:195], v[64:67], v[160:163]
    v_exp_f32 v116, v116
    v_mfma_f32_16x16x32_bf16 v[132:135], a[208:211], v[64:67], v[160:163]
    v_exp_f32 v117, v117
    v_mfma_f32_16x16x32_bf16 v[128:131], a[196:199], v[68:71], v[128:131]
    v_cvt_pk_bf16_f32 v177, v114, v115
    v_mfma_f32_16x16x32_bf16 v[132:135], a[212:215], v[68:71], v[132:135]
    v_exp_f32 v118, v118
    v_mfma_f32_16x16x32_bf16 v[128:131], a[200:203], v[72:75], v[128:131]
    v_exp_f32 v119, v119
    v_mfma_f32_16x16x32_bf16 v[132:135], a[216:219], v[72:75], v[132:135]
    v_cvt_pk_bf16_f32 v178, v116, v117
    v_cvt_pk_bf16_f32 v179, v118, v119
    v_mfma_f32_16x16x32_bf16 v[128:131], a[204:207], v[76:79], v[128:131]
    v_exp_f32 v120, v120
    v_mfma_f32_16x16x32_bf16 v[132:135], a[220:223], v[76:79], v[132:135]
    v_exp_f32 v121, v121
    v_mfma_f32_16x16x32_bf16 v[136:139], a[192:195], v[80:83], v[164:167]
    v_exp_f32 v122, v122
    v_mfma_f32_16x16x32_bf16 v[140:143], a[208:211], v[80:83], v[164:167]
    v_exp_f32 v123, v123
    v_mfma_f32_16x16x32_bf16 v[136:139], a[196:199], v[84:87], v[136:139]
    ds_read_b128 a[192:195], v220 offset:49152
    v_cvt_pk_bf16_f32 v180, v120, v121
    v_mfma_f32_16x16x32_bf16 v[140:143], a[212:215], v[84:87], v[140:143]
    v_exp_f32 v124, v124
    v_mfma_f32_16x16x32_bf16 v[136:139], a[200:203], v[88:91], v[136:139]
    v_exp_f32 v125, v125
    v_mfma_f32_16x16x32_bf16 v[140:143], a[216:219], v[88:91], v[140:143]
    ds_read_b128 a[208:211], v220 offset:50176
    v_cvt_pk_bf16_f32 v181, v122, v123
    v_mfma_f32_16x16x32_bf16 v[136:139], a[204:207], v[92:95], v[136:139]
    v_exp_f32 v126, v126
    v_mfma_f32_16x16x32_bf16 v[140:143], a[220:223], v[92:95], v[140:143]
    v_exp_f32 v127, v127
    v_mfma_f32_16x16x32_bf16 a[64:67], a[224:227], v[176:179], a[64:67]
    ds_read_b128 a[196:199], v221 offset:49152
    v_cvt_pk_bf16_f32 v182, v124, v125
    v_mfma_f32_16x16x32_bf16 a[68:71], a[228:231], v[176:179], a[68:71]
    ds_read_b128 a[212:215], v221 offset:50176
    v_cvt_pk_bf16_f32 v183, v126, v127
    v_mfma_f32_16x16x32_bf16 a[72:75], a[232:235], v[176:179], a[72:75]
    ds_read_b128 a[200:203], v222 offset:49152
    v_mfma_f32_16x16x32_bf16 a[76:79], a[236:239], v[176:179], a[76:79]
    ds_read_b128 a[216:219], v222 offset:50176
    v_max3_f32 v238, v128, v129, v130
    v_mfma_f32_16x16x32_bf16 a[80:83], a[240:243], v[176:179], a[80:83]
    ds_read_b128 a[204:207], v223 offset:49152
    v_max3_f32 v238, v238, v131, v132
    v_mfma_f32_16x16x32_bf16 a[84:87], a[244:247], v[176:179], a[84:87]
    ds_read_b128 a[220:223], v223 offset:50176
    v_max3_f32 v238, v238, v133, v134
    v_mfma_f32_16x16x32_bf16 a[88:91], a[248:251], v[176:179], a[88:91]
    v_max3_f32 v238, v238, v135, v136
    v_max3_f32 v238, v238, v137, v138
    v_mfma_f32_16x16x32_bf16 a[92:95], a[252:255], v[176:179], a[92:95]
    v_max3_f32 v238, v238, v139, v140
    v_max3_f32 v238, v238, v141, v142
    v_mfma_f32_16x16x32_bf16 v[200:203], v[216:219], v[176:179], v[200:203]
    v_max_f32 v238, v238, v143
    v_cmp_nge_f32 vcc, s34, v238
    v_mfma_f32_16x16x32_bf16 a[96:99], a[224:227], v[180:183], a[96:99]
    s_cbranch_vccnz Ltr5
Lret5:
    v_mfma_f32_16x16x32_bf16 a[100:103], a[228:231], v[180:183], a[100:103]
    v_exp_f32 v128, v128
    v_mfma_f32_16x16x32_bf16 a[104:107], a[232:235], v[180:183], a[104:107]
    v_exp_f32 v129, v129
    v_mfma_f32_16x16x32_bf16 a[108:111], a[236:239], v[180:183], a[108:111]
    v_exp_f32 v130, v130
    v_mfma_f32_16x16x32_bf16 a[112:115], a[240:243], v[180:183], a[112:115]
    v_exp_f32 v131, v131
    v_mfma_f32_16x16x32_bf16 a[116:119], a[244:247], v[180:183], a[116:119]
    v_cvt_pk_bf16_f32 v184, v128, v129
    v_mfma_f32_16x16x32_bf16 a[120:123], a[248:251], v[180:183], a[120:123]
    v_exp_f32 v132, v132
    v_mfma_f32_16x16x32_bf16 a[124:127], a[252:255], v[180:183], a[124:127]
    v_exp_f32 v133, v133
    v_mfma_f32_16x16x32_bf16 v[204:207], v[216:219], v[180:183], v[204:207]
    s_waitcnt lgkmcnt(0)
    v_cvt_pk_bf16_f32 v185, v130, v131
    v_mfma_f32_16x16x32_bf16 v[96:99], a[192:195], v[0:3], v[144:147]
    v_exp_f32 v134, v134
    v_mfma_f32_16x16x32_bf16 v[100:103], a[208:211], v[0:3], v[144:147]
    v_exp_f32 v135, v135
    v_mfma_f32_16x16x32_bf16 v[96:99], a[196:199], v[4:7], v[96:99]
    v_cvt_pk_bf16_f32 v186, v132, v133
    v_cvt_pk_bf16_f32 v187, v134, v135
    v_mfma_f32_16x16x32_bf16 v[100:103], a[212:215], v[4:7], v[100:103]
    v_exp_f32 v136, v136
    v_mfma_f32_16x16x32_bf16 v[96:99], a[200:203], v[8:11], v[96:99]
    v_exp_f32 v137, v137
    v_mfma_f32_16x16x32_bf16 v[100:103], a[216:219], v[8:11], v[100:103]
    v_exp_f32 v138, v138
    v_mfma_f32_16x16x32_bf16 v[96:99], a[204:207], v[12:15], v[96:99]
    v_exp_f32 v139, v139
    v_mfma_f32_16x16x32_bf16 v[100:103], a[220:223], v[12:15], v[100:103]
    v_cvt_pk_bf16_f32 v188, v136, v137
    v_mfma_f32_16x16x32_bf16 v[104:107], a[192:195], v[16:19], v[148:151]
    v_exp_f32 v140, v140
    v_mfma_f32_16x16x32_bf16 v[108:111], a[208:211], v[16:19], v[148:151]
    v_exp_f32 v141, v141
    v_mfma_f32_16x16x32_bf16 v[104:107], a[196:199], v[20:23], v[104:107]
    v_cvt_pk_bf16_f32 v189, v138, v139
    v_mfma_f32_16x16x32_bf16 v[108:111], a[212:215], v[20:23], v[108:111]
    v_exp_f32 v142, v142
    v_mfma_f32_16x16x32_bf16 v[104:107], a[200:203], v[24:27], v[104:107]
    v_exp_f32 v143, v143
    v_mfma_f32_16x16x32_bf16 v[108:111], a[216:219], v[24:27], v[108:111]
    v_cvt_pk_bf16_f32 v190, v140, v141
    v_cvt_pk_bf16_f32 v191, v142, v143
    v_mfma_f32_16x16x32_bf16 v[104:107], a[204:207], v[28:31], v[104:107]
    v_mfma_f32_16x16x32_bf16 v[108:111], a[220:223], v[28:31], v[108:111]
    v_mfma_f32_16x16x32_bf16 a[128:131], a[224:227], v[184:187], a[128:131]
    v_mfma_f32_16x16x32_bf16 a[132:135], a[228:231], v[184:187], a[132:135]
    v_mfma_f32_16x16x32_bf16 a[136:139], a[232:235], v[184:187], a[136:139]
    v_mfma_f32_16x16x32_bf16 a[140:143], a[236:239], v[184:187], a[140:143]
    v_max3_f32 v238, v96, v97, v98
    v_max3_f32 v238, v238, v99, v100
    v_mfma_f32_16x16x32_bf16 a[144:147], a[240:243], v[184:187], a[144:147]
    v_max3_f32 v238, v238, v101, v102
    v_max3_f32 v238, v238, v103, v104
    v_mfma_f32_16x16x32_bf16 a[148:151], a[244:247], v[184:187], a[148:151]
    v_max3_f32 v238, v238, v105, v106
    v_max3_f32 v238, v238, v107, v108
    v_mfma_f32_16x16x32_bf16 a[152:155], a[248:251], v[184:187], a[152:155]
    v_max3_f32 v238, v238, v109, v110
    v_max_f32 v238, v238, v111
    v_mfma_f32_16x16x32_bf16 a[156:159], a[252:255], v[184:187], a[156:159]
    s_waitcnt vmcnt(24)
    v_cmp_nge_f32 vcc, s34, v238
    v_mfma_f32_16x16x32_bf16 v[208:211], v[216:219], v[184:187], v[208:211]
    s_barrier
    s_cbranch_vccnz Ltr6
Lret6:
    v_mfma_f32_16x16x32_bf16 a[160:163], a[224:227], v[188:191], a[160:163]
    v_exp_f32 v96, v96
    v_mfma_f32_16x16x32_bf16 a[164:167], a[228:231], v[188:191], a[164:167]
    s_add_u32 m0, s24, 49152
    v_exp_f32 v97, v97
    v_mfma_f32_16x16x32_bf16 a[168:171], a[232:235], v[188:191], a[168:171]
    buffer_load_dwordx4 v232, s[4:7], s28 offen offset:0 sc0 sc1 nt lds
    ds_read_b64_tr_b16 a[224:225], v224 offset:32768
    v_mfma_f32_16x16x32_bf16 a[172:175], a[236:239], v[188:191], a[172:175]
    v_exp_f32 v98, v98
    v_mfma_f32_16x16x32_bf16 a[176:179], a[240:243], v[188:191], a[176:179]
    buffer_load_dwordx4 v232, s[4:7], s28 offen offset:1024 sc0 sc1 nt lds
    ds_read_b64_tr_b16 a[226:227], v224 offset:33792
    v_mfma_f32_16x16x32_bf16 a[180:183], a[244:247], v[188:191], a[180:183]
    v_exp_f32 v99, v99
    v_mfma_f32_16x16x32_bf16 a[184:187], a[248:251], v[188:191], a[184:187]
    buffer_load_dwordx4 v233, s[4:7], s28 offen offset:2048 sc0 sc1 nt lds
    v_cvt_pk_bf16_f32 v168, v96, v97
    v_mfma_f32_16x16x32_bf16 a[188:191], a[252:255], v[188:191], a[188:191]
    v_exp_f32 v100, v100
    v_mfma_f32_16x16x32_bf16 v[212:215], v[216:219], v[188:191], v[212:215]
    buffer_load_dwordx4 v233, s[4:7], s28 offen offset:3072 sc0 sc1 nt lds
    s_add_u32 s28, s28, 8192
    ds_read_b64_tr_b16 a[228:229], v225 offset:32768
    v_mfma_f32_16x16x32_bf16 v[112:115], a[192:195], v[32:35], v[152:155]
    v_exp_f32 v101, v101
    v_mfma_f32_16x16x32_bf16 v[116:119], a[208:211], v[32:35], v[152:155]
    ds_read_b64_tr_b16 a[230:231], v225 offset:33792
    v_cvt_pk_bf16_f32 v169, v98, v99
    v_mfma_f32_16x16x32_bf16 v[112:115], a[196:199], v[36:39], v[112:115]
    v_exp_f32 v102, v102
    v_mfma_f32_16x16x32_bf16 v[116:119], a[212:215], v[36:39], v[116:119]
    v_exp_f32 v103, v103
    v_mfma_f32_16x16x32_bf16 v[112:115], a[200:203], v[40:43], v[112:115]
    ds_read_b64_tr_b16 a[232:233], v226 offset:32768
    v_cvt_pk_bf16_f32 v170, v100, v101
    v_mfma_f32_16x16x32_bf16 v[116:119], a[216:219], v[40:43], v[116:119]
    ds_read_b64_tr_b16 a[234:235], v226 offset:33792
    v_cvt_pk_bf16_f32 v171, v102, v103
    v_mfma_f32_16x16x32_bf16 v[112:115], a[204:207], v[44:47], v[112:115]
    v_exp_f32 v104, v104
    v_mfma_f32_16x16x32_bf16 v[116:119], a[220:223], v[44:47], v[116:119]
    v_exp_f32 v105, v105
    v_mfma_f32_16x16x32_bf16 v[120:123], a[192:195], v[48:51], v[156:159]
    ds_read_b64_tr_b16 a[236:237], v227 offset:32768
    ds_read_b64_tr_b16 a[238:239], v227 offset:33792
    v_mfma_f32_16x16x32_bf16 v[124:127], a[208:211], v[48:51], v[156:159]
    ds_read_b64_tr_b16 a[240:241], v228 offset:32768
    ds_read_b64_tr_b16 a[242:243], v228 offset:33792
    v_mfma_f32_16x16x32_bf16 v[120:123], a[196:199], v[52:55], v[120:123]
    ds_read_b64_tr_b16 a[244:245], v229 offset:32768
    ds_read_b64_tr_b16 a[246:247], v229 offset:33792
    v_mfma_f32_16x16x32_bf16 v[124:127], a[212:215], v[52:55], v[124:127]
    ds_read_b64_tr_b16 a[248:249], v230 offset:32768
    ds_read_b64_tr_b16 a[250:251], v230 offset:33792
    v_mfma_f32_16x16x32_bf16 v[120:123], a[200:203], v[56:59], v[120:123]
    ds_read_b64_tr_b16 a[252:253], v231 offset:32768
    ds_read_b64_tr_b16 a[254:255], v231 offset:33792
    v_mfma_f32_16x16x32_bf16 v[124:127], a[216:219], v[56:59], v[124:127]
    v_exp_f32 v106, v106
    v_mfma_f32_16x16x32_bf16 v[120:123], a[204:207], v[60:63], v[120:123]
    v_exp_f32 v107, v107
    v_mfma_f32_16x16x32_bf16 v[124:127], a[220:223], v[60:63], v[124:127]
    s_waitcnt vmcnt(24) lgkmcnt(0)
    v_cvt_pk_bf16_f32 v172, v104, v105
    v_mfma_f32_16x16x32_bf16 a[0:3], a[224:227], v[168:171], a[0:3]
    s_barrier
    v_exp_f32 v108, v108
    v_mfma_f32_16x16x32_bf16 a[4:7], a[228:231], v[168:171], a[4:7]
    s_add_u32 m0, s25, 32768
    v_exp_f32 v109, v109
    v_mfma_f32_16x16x32_bf16 a[8:11], a[232:235], v[168:171], a[8:11]
    buffer_load_dwordx4 v234, s[76:79], s29 offen offset:0 sc0 sc1 nt lds
    v_cvt_pk_bf16_f32 v173, v106, v107
    v_mfma_f32_16x16x32_bf16 a[12:15], a[236:239], v[168:171], a[12:15]
    v_exp_f32 v110, v110
    v_mfma_f32_16x16x32_bf16 a[16:19], a[240:243], v[168:171], a[16:19]
    v_exp_f32 v111, v111
    v_mfma_f32_16x16x32_bf16 a[20:23], a[244:247], v[168:171], a[20:23]
    buffer_load_dwordx4 v234, s[76:79], s29 offen offset:1024 sc0 sc1 nt lds
    v_cvt_pk_bf16_f32 v174, v108, v109
    v_mfma_f32_16x16x32_bf16 a[24:27], a[248:251], v[168:171], a[24:27]
    v_cvt_pk_bf16_f32 v175, v110, v111
    v_max3_f32 v239, v112, v113, v114
    v_mfma_f32_16x16x32_bf16 a[28:31], a[252:255], v[168:171], a[28:31]
    buffer_load_dwordx4 v235, s[76:79], s29 offen offset:2048 sc0 sc1 nt lds
    v_max3_f32 v239, v239, v115, v116
    v_mfma_f32_16x16x32_bf16 v[192:195], v[216:219], v[168:171], v[192:195]
    v_max3_f32 v239, v239, v117, v118
    v_max3_f32 v239, v239, v119, v120
    v_mfma_f32_16x16x32_bf16 a[32:35], a[224:227], v[172:175], a[32:35]
    buffer_load_dwordx4 v235, s[76:79], s29 offen offset:3072 sc0 sc1 nt lds
    v_max3_f32 v239, v239, v121, v122
    v_mfma_f32_16x16x32_bf16 a[36:39], a[228:231], v[172:175], a[36:39]
    s_add_u32 s29, s29, 8192
    v_max3_f32 v239, v239, v123, v124
    v_max3_f32 v239, v239, v125, v126
    v_mfma_f32_16x16x32_bf16 a[40:43], a[232:235], v[172:175], a[40:43]
    v_max_f32 v239, v239, v127
    v_cmp_nge_f32 vcc, s34, v239
    v_mfma_f32_16x16x32_bf16 a[44:47], a[236:239], v[172:175], a[44:47]
    s_cbranch_vccnz Ltr7
Lret7:
    v_mfma_f32_16x16x32_bf16 a[48:51], a[240:243], v[172:175], a[48:51]
    v_exp_f32 v112, v112
    v_mfma_f32_16x16x32_bf16 a[52:55], a[244:247], v[172:175], a[52:55]
    v_exp_f32 v113, v113
    v_mfma_f32_16x16x32_bf16 a[56:59], a[248:251], v[172:175], a[56:59]
    v_exp_f32 v114, v114
    v_mfma_f32_16x16x32_bf16 a[60:63], a[252:255], v[172:175], a[60:63]
    v_exp_f32 v115, v115
    v_mfma_f32_16x16x32_bf16 v[196:199], v[216:219], v[172:175], v[196:199]
    v_cvt_pk_bf16_f32 v176, v112, v113
    v_mfma_f32_16x16x32_bf16 v[128:131], a[192:195], v[64:67], v[160:163]
    v_exp_f32 v116, v116
    v_mfma_f32_16x16x32_bf16 v[132:135], a[208:211], v[64:67], v[160:163]
    v_exp_f32 v117, v117
    v_mfma_f32_16x16x32_bf16 v[128:131], a[196:199], v[68:71], v[128:131]
    v_cvt_pk_bf16_f32 v177, v114, v115
    v_mfma_f32_16x16x32_bf16 v[132:135], a[212:215], v[68:71], v[132:135]
    v_exp_f32 v118, v118
    v_mfma_f32_16x16x32_bf16 v[128:131], a[200:203], v[72:75], v[128:131]
    v_exp_f32 v119, v119
    v_mfma_f32_16x16x32_bf16 v[132:135], a[216:219], v[72:75], v[132:135]
    v_cvt_pk_bf16_f32 v178, v116, v117
    v_cvt_pk_bf16_f32 v179, v118, v119
    v_mfma_f32_16x16x32_bf16 v[128:131], a[204:207], v[76:79], v[128:131]
    v_exp_f32 v120, v120
    v_mfma_f32_16x16x32_bf16 v[132:135], a[220:223], v[76:79], v[132:135]
    v_exp_f32 v121, v121
    v_mfma_f32_16x16x32_bf16 v[136:139], a[192:195], v[80:83], v[164:167]
    v_exp_f32 v122, v122
    v_mfma_f32_16x16x32_bf16 v[140:143], a[208:211], v[80:83], v[164:167]
    v_exp_f32 v123, v123
    v_mfma_f32_16x16x32_bf16 v[136:139], a[196:199], v[84:87], v[136:139]
    ds_read_b128 a[192:195], v220 offset:0
    v_cvt_pk_bf16_f32 v180, v120, v121
    v_mfma_f32_16x16x32_bf16 v[140:143], a[212:215], v[84:87], v[140:143]
    v_exp_f32 v124, v124
    v_mfma_f32_16x16x32_bf16 v[136:139], a[200:203], v[88:91], v[136:139]
    v_exp_f32 v125, v125
    v_mfma_f32_16x16x32_bf16 v[140:143], a[216:219], v[88:91], v[140:143]
    ds_read_b128 a[208:211], v220 offset:1024
    v_cvt_pk_bf16_f32 v181, v122, v123
    v_mfma_f32_16x16x32_bf16 v[136:139], a[204:207], v[92:95], v[136:139]
    v_exp_f32 v126, v126
    v_mfma_f32_16x16x32_bf16 v[140:143], a[220:223], v[92:95], v[140:143]
    v_exp_f32 v127, v127
    v_mfma_f32_16x16x32_bf16 a[64:67], a[224:227], v[176:179], a[64:67]
    ds_read_b128 a[196:199], v221 offset:0
    v_cvt_pk_bf16_f32 v182, v124, v125
    v_mfma_f32_16x16x32_bf16 a[68:71], a[228:231], v[176:179], a[68:71]
    ds_read_b128 a[212:215], v221 offset:1024
    v_cvt_pk_bf16_f32 v183, v126, v127
    v_mfma_f32_16x16x32_bf16 a[72:75], a[232:235], v[176:179], a[72:75]
    ds_read_b128 a[200:203], v222 offset:0
    v_mfma_f32_16x16x32_bf16 a[76:79], a[236:239], v[176:179], a[76:79]
    ds_read_b128 a[216:219], v222 offset:1024
    v_max3_f32 v238, v128, v129, v130
    v_mfma_f32_16x16x32_bf16 a[80:83], a[240:243], v[176:179], a[80:83]
    ds_read_b128 a[204:207], v223 offset:0
    v_max3_f32 v238, v238, v131, v132
    v_mfma_f32_16x16x32_bf16 a[84:87], a[244:247], v[176:179], a[84:87]
    ds_read_b128 a[220:223], v223 offset:1024
    v_max3_f32 v238, v238, v133, v134
    v_mfma_f32_16x16x32_bf16 a[88:91], a[248:251], v[176:179], a[88:91]
    v_max3_f32 v238, v238, v135, v136
    v_max3_f32 v238, v238, v137, v138
    v_mfma_f32_16x16x32_bf16 a[92:95], a[252:255], v[176:179], a[92:95]
    v_max3_f32 v238, v238, v139, v140
    v_max3_f32 v238, v238, v141, v142
    v_mfma_f32_16x16x32_bf16 v[200:203], v[216:219], v[176:179], v[200:203]
    v_max_f32 v238, v238, v143
    v_cmp_nge_f32 vcc, s34, v238
    v_mfma_f32_16x16x32_bf16 a[96:99], a[224:227], v[180:183], a[96:99]
    s_cbranch_vccnz Ltr8
Lret8:
    v_mfma_f32_16x16x32_bf16 a[100:103], a[228:231], v[180:183], a[100:103]
    v_exp_f32 v128, v128
    v_mfma_f32_16x16x32_bf16 a[104:107], a[232:235], v[180:183], a[104:107]
    v_exp_f32 v129, v129
    v_mfma_f32_16x16x32_bf16 a[108:111], a[236:239], v[180:183], a[108:111]
    v_exp_f32 v130, v130
    v_mfma_f32_16x16x32_bf16 a[112:115], a[240:243], v[180:183], a[112:115]
    v_exp_f32 v131, v131
    v_mfma_f32_16x16x32_bf16 a[116:119], a[244:247], v[180:183], a[116:119]
    v_cvt_pk_bf16_f32 v184, v128, v129
    v_mfma_f32_16x16x32_bf16 a[120:123], a[248:251], v[180:183], a[120:123]
    v_exp_f32 v132, v132
    v_mfma_f32_16x16x32_bf16 a[124:127], a[252:255], v[180:183], a[124:127]
    v_exp_f32 v133, v133
    v_mfma_f32_16x16x32_bf16 v[204:207], v[216:219], v[180:183], v[204:207]
    s_waitcnt lgkmcnt(0)
    v_cvt_pk_bf16_f32 v185, v130, v131
    s_mov_b32 s30, 7
    v_mfma_f32_16x16x32_bf16 v[96:99], a[192:195], v[0:3], v[144:147]
    v_exp_f32 v134, v134
    v_mfma_f32_16x16x32_bf16 v[100:103], a[208:211], v[0:3], v[144:147]
    v_exp_f32 v135, v135
    v_mfma_f32_16x16x32_bf16 v[96:99], a[196:199], v[4:7], v[96:99]
    v_cvt_pk_bf16_f32 v186, v132, v133
    v_cvt_pk_bf16_f32 v187, v134, v135
    v_mfma_f32_16x16x32_bf16 v[100:103], a[212:215], v[4:7], v[100:103]
    v_exp_f32 v136, v136
    v_mfma_f32_16x16x32_bf16 v[96:99], a[200:203], v[8:11], v[96:99]
    v_exp_f32 v137, v137
    v_mfma_f32_16x16x32_bf16 v[100:103], a[216:219], v[8:11], v[100:103]
    v_exp_f32 v138, v138
    v_mfma_f32_16x16x32_bf16 v[96:99], a[204:207], v[12:15], v[96:99]
    v_exp_f32 v139, v139
    v_mfma_f32_16x16x32_bf16 v[100:103], a[220:223], v[12:15], v[100:103]
    v_cvt_pk_bf16_f32 v188, v136, v137
    v_mfma_f32_16x16x32_bf16 v[104:107], a[192:195], v[16:19], v[148:151]
    v_exp_f32 v140, v140
    v_mfma_f32_16x16x32_bf16 v[108:111], a[208:211], v[16:19], v[148:151]
    v_exp_f32 v141, v141
    v_mfma_f32_16x16x32_bf16 v[104:107], a[196:199], v[20:23], v[104:107]
    v_cvt_pk_bf16_f32 v189, v138, v139
    v_mfma_f32_16x16x32_bf16 v[108:111], a[212:215], v[20:23], v[108:111]
    v_exp_f32 v142, v142
    v_mfma_f32_16x16x32_bf16 v[104:107], a[200:203], v[24:27], v[104:107]
    v_exp_f32 v143, v143
    v_mfma_f32_16x16x32_bf16 v[108:111], a[216:219], v[24:27], v[108:111]
    v_cvt_pk_bf16_f32 v190, v140, v141
    v_cvt_pk_bf16_f32 v191, v142, v143
    v_mfma_f32_16x16x32_bf16 v[104:107], a[204:207], v[28:31], v[104:107]
    v_mfma_f32_16x16x32_bf16 v[108:111], a[220:223], v[28:31], v[108:111]
Lloop:
    s_cmp_lg_u32 s30, 1
    s_cbranch_scc1 Lnowo
    v_lshlrev_b32 v244, 3, v236
    buffer_load_dword v255, v244, s[8:11], s38 offen
    v_mov_b32 v244, v237
    v_add_u32 v245, 7168, v237
    v_add_u32 v246, 14336, v237
    v_add_u32 v247, 21504, v237
    s_add_u32 m0, s39, 65536
    s_mov_b32 s36, 0
    buffer_load_dwordx4 v244, s[72:75], s36 offen offset:0 lds
    buffer_load_dwordx4 v245, s[72:75], s36 offen offset:1024 lds
    buffer_load_dwordx4 v246, s[72:75], s36 offen offset:2048 lds
    buffer_load_dwordx4 v247, s[72:75], s36 offen offset:3072 lds
    s_add_u32 m0, s39, 69632
    s_mov_b32 s36, 32768
    buffer_load_dwordx4 v244, s[72:75], s36 offen offset:0 lds
    buffer_load_dwordx4 v245, s[72:75], s36 offen offset:1024 lds
    buffer_load_dwordx4 v246, s[72:75], s36 offen offset:2048 lds
    buffer_load_dwordx4 v247, s[72:75], s36 offen offset:3072 lds
Lnowo:
    v_mfma_f32_16x16x32_bf16 a[128:131], a[224:227], v[184:187], a[128:131]
    v_mfma_f32_16x16x32_bf16 a[132:135], a[228:231], v[184:187], a[132:135]
    v_mfma_f32_16x16x32_bf16 a[136:139], a[232:235], v[184:187], a[136:139]
    v_mfma_f32_16x16x32_bf16 a[140:143], a[236:239], v[184:187], a[140:143]
    v_max3_f32 v238, v96, v97, v98
    v_max3_f32 v238, v238, v99, v100
    v_mfma_f32_16x16x32_bf16 a[144:147], a[240:243], v[184:187], a[144:147]
    v_max3_f32 v238, v238, v101, v102
    v_max3_f32 v238, v238, v103, v104
    v_mfma_f32_16x16x32_bf16 a[148:151], a[244:247], v[184:187], a[148:151]
    v_max3_f32 v238, v238, v105, v106
    v_max3_f32 v238, v238, v107, v108
    v_mfma_f32_16x16x32_bf16 a[152:155], a[248:251], v[184:187], a[152:155]
    v_max3_f32 v238, v238, v109, v110
    v_max_f32 v238, v238, v111
    v_mfma_f32_16x16x32_bf16 a[156:159], a[252:255], v[184:187], a[156:159]
    s_waitcnt vmcnt(24)
    v_cmp_nge_f32 vcc, s34, v238
    v_mfma_f32_16x16x32_bf16 v[208:211], v[216:219], v[184:187], v[208:211]
    s_barrier
    s_cbranch_vccnz Ltr9
Lret9:
    v_mfma_f32_16x16x32_bf16 a[160:163], a[224:227], v[188:191], a[160:163]
    v_exp_f32 v96, v96
    v_mfma_f32_16x16x32_bf16 a[164:167], a[228:231], v[188:191], a[164:167]
    s_add_u32 m0, s24, 0
    v_exp_f32 v97, v97
    v_mfma_f32_16x16x32_bf16 a[168:171], a[232:235], v[188:191], a[168:171]
    buffer_load_dwordx4 v232, s[4:7], s28 offen offset:0 sc0 sc1 nt lds
    ds_read_b64_tr_b16 a[224:225], v224 offset:49152
    v_mfma_f32_16x16x32_bf16 a[172:175], a[236:239], v[188:191], a[172:175]
    v_exp_f32 v98, v98
    v_mfma_f32_16x16x32_bf16 a[176:179], a[240:243], v[188:191], a[176:179]
    buffer_load_dwordx4 v232, s[4:7], s28 offen offset:1024 sc0 sc1 nt lds
    ds_read_b64_tr_b16 a[226:227], v224 offset:50176
    v_mfma_f32_16x16x32_bf16 a[180:183], a[244:247], v[188:191], a[180:183]
    v_exp_f32 v99, v99
    v_mfma_f32_16x16x32_bf16 a[184:187], a[248:251], v[188:191], a[184:187]
    buffer_load_dwordx4 v233, s[4:7], s28 offen offset:2048 sc0 sc1 nt lds
    v_cvt_pk_bf16_f32 v168, v96, v97
    v_mfma_f32_16x16x32_bf16 a[188:191], a[252:255], v[188:191], a[188:191]
    v_exp_f32 v100, v100
    v_mfma_f32_16x16x32_bf16 v[212:215], v[216:219], v[188:191], v[212:215]
    buffer_load_dwordx4 v233, s[4:7], s28 offen offset:3072 sc0 sc1 nt lds
    s_add_u32 s28, s28, 8192
    ds_read_b64_tr_b16 a[228:229], v225 offset:49152
    v_mfma_f32_16x16x32_bf16 v[112:115], a[192:195], v[32:35], v[152:155]
    v_exp_f32 v101, v101
    v_mfma_f32_16x16x32_bf16 v[116:119], a[208:211], v[32:35], v[152:155]
    ds_read_b64_tr_b16 a[230:231], v225 offset:50176
    v_cvt_pk_bf16_f32 v169, v98, v99
    v_mfma_f32_16x16x32_bf16 v[112:115], a[196:199], v[36:39], v[112:115]
    v_exp_f32 v102, v102
    v_mfma_f32_16x16x32_bf16 v[116:119], a[212:215], v[36:39], v[116:119]
    v_exp_f32 v103, v103
    v_mfma_f32_16x16x32_bf16 v[112:115], a[200:203], v[40:43], v[112:115]
    ds_read_b64_tr_b16 a[232:233], v226 offset:49152
    v_cvt_pk_bf16_f32 v170, v100, v101
    v_mfma_f32_16x16x32_bf16 v[116:119], a[216:219], v[40:43], v[116:119]
    ds_read_b64_tr_b16 a[234:235], v226 offset:50176
    v_cvt_pk_bf16_f32 v171, v102, v103
    v_mfma_f32_16x16x32_bf16 v[112:115], a[204:207], v[44:47], v[112:115]
    v_exp_f32 v104, v104
    v_mfma_f32_16x16x32_bf16 v[116:119], a[220:223], v[44:47], v[116:119]
    v_exp_f32 v105, v105
    v_mfma_f32_16x16x32_bf16 v[120:123], a[192:195], v[48:51], v[156:159]
    ds_read_b64_tr_b16 a[236:237], v227 offset:49152
    ds_read_b64_tr_b16 a[238:239], v227 offset:50176
    v_mfma_f32_16x16x32_bf16 v[124:127], a[208:211], v[48:51], v[156:159]
    ds_read_b64_tr_b16 a[240:241], v228 offset:49152
    ds_read_b64_tr_b16 a[242:243], v228 offset:50176
    v_mfma_f32_16x16x32_bf16 v[120:123], a[196:199], v[52:55], v[120:123]
    ds_read_b64_tr_b16 a[244:245], v229 offset:49152
    ds_read_b64_tr_b16 a[246:247], v229 offset:50176
    v_mfma_f32_16x16x32_bf16 v[124:127], a[212:215], v[52:55], v[124:127]
    ds_read_b64_tr_b16 a[248:249], v230 offset:49152
    ds_read_b64_tr_b16 a[250:251], v230 offset:50176
    v_mfma_f32_16x16x32_bf16 v[120:123], a[200:203], v[56:59], v[120:123]
    ds_read_b64_tr_b16 a[252:253], v231 offset:49152
    ds_read_b64_tr_b16 a[254:255], v231 offset:50176
    v_mfma_f32_16x16x32_bf16 v[124:127], a[216:219], v[56:59], v[124:127]
    v_exp_f32 v106, v106
    v_mfma_f32_16x16x32_bf16 v[120:123], a[204:207], v[60:63], v[120:123]
    v_exp_f32 v107, v107
    v_mfma_f32_16x16x32_bf16 v[124:127], a[220:223], v[60:63], v[124:127]
    s_waitcnt vmcnt(24) lgkmcnt(0)
    v_cvt_pk_bf16_f32 v172, v104, v105
    v_mfma_f32_16x16x32_bf16 a[0:3], a[224:227], v[168:171], a[0:3]
    s_barrier
    v_exp_f32 v108, v108
    v_mfma_f32_16x16x32_bf16 a[4:7], a[228:231], v[168:171], a[4:7]
    s_add_u32 m0, s25, 49152
    v_exp_f32 v109, v109
    v_mfma_f32_16x16x32_bf16 a[8:11], a[232:235], v[168:171], a[8:11]
    buffer_load_dwordx4 v234, s[76:79], s29 offen offset:0 sc0 sc1 nt lds
    v_cvt_pk_bf16_f32 v173, v106, v107
    v_mfma_f32_16x16x32_bf16 a[12:15], a[236:239], v[168:171], a[12:15]
    v_exp_f32 v110, v110
    v_mfma_f32_16x16x32_bf16 a[16:19], a[240:243], v[168:171], a[16:19]
    v_exp_f32 v111, v111
    v_mfma_f32_16x16x32_bf16 a[20:23], a[244:247], v[168:171], a[20:23]
    buffer_load_dwordx4 v234, s[76:79], s29 offen offset:1024 sc0 sc1 nt lds
    v_cvt_pk_bf16_f32 v174, v108, v109
    v_mfma_f32_16x16x32_bf16 a[24:27], a[248:251], v[168:171], a[24:27]
    v_cvt_pk_bf16_f32 v175, v110, v111
    v_max3_f32 v239, v112, v113, v114
    v_mfma_f32_16x16x32_bf16 a[28:31], a[252:255], v[168:171], a[28:31]
    buffer_load_dwordx4 v235, s[76:79], s29 offen offset:2048 sc0 sc1 nt lds
    v_max3_f32 v239, v239, v115, v116
    v_mfma_f32_16x16x32_bf16 v[192:195], v[216:219], v[168:171], v[192:195]
    v_max3_f32 v239, v239, v117, v118
    v_max3_f32 v239, v239, v119, v120
    v_mfma_f32_16x16x32_bf16 a[32:35], a[224:227], v[172:175], a[32:35]
    buffer_load_dwordx4 v235, s[76:79], s29 offen offset:3072 sc0 sc1 nt lds
    v_max3_f32 v239, v239, v121, v122
    v_mfma_f32_16x16x32_bf16 a[36:39], a[228:231], v[172:175], a[36:39]
    s_add_u32 s29, s29, 8192
    v_max3_f32 v239, v239, v123, v124
    v_max3_f32 v239, v239, v125, v126
    v_mfma_f32_16x16x32_bf16 a[40:43], a[232:235], v[172:175], a[40:43]
    v_max_f32 v239, v239, v127
    v_cmp_nge_f32 vcc, s34, v239
    v_mfma_f32_16x16x32_bf16 a[44:47], a[236:239], v[172:175], a[44:47]
    s_cbranch_vccnz Ltr10
Lret10:
    v_mfma_f32_16x16x32_bf16 a[48:51], a[240:243], v[172:175], a[48:51]
    v_exp_f32 v112, v112
    v_mfma_f32_16x16x32_bf16 a[52:55], a[244:247], v[172:175], a[52:55]
    v_exp_f32 v113, v113
    v_mfma_f32_16x16x32_bf16 a[56:59], a[248:251], v[172:175], a[56:59]
    v_exp_f32 v114, v114
    v_mfma_f32_16x16x32_bf16 a[60:63], a[252:255], v[172:175], a[60:63]
    v_exp_f32 v115, v115
    v_mfma_f32_16x16x32_bf16 v[196:199], v[216:219], v[172:175], v[196:199]
    v_cvt_pk_bf16_f32 v176, v112, v113
    v_mfma_f32_16x16x32_bf16 v[128:131], a[192:195], v[64:67], v[160:163]
    v_exp_f32 v116, v116
    v_mfma_f32_16x16x32_bf16 v[132:135], a[208:211], v[64:67], v[160:163]
    v_exp_f32 v117, v117
    v_mfma_f32_16x16x32_bf16 v[128:131], a[196:199], v[68:71], v[128:131]
    v_cvt_pk_bf16_f32 v177, v114, v115
    v_mfma_f32_16x16x32_bf16 v[132:135], a[212:215], v[68:71], v[132:135]
    v_exp_f32 v118, v118
    v_mfma_f32_16x16x32_bf16 v[128:131], a[200:203], v[72:75], v[128:131]
    v_exp_f32 v119, v119
    v_mfma_f32_16x16x32_bf16 v[132:135], a[216:219], v[72:75], v[132:135]
    v_cvt_pk_bf16_f32 v178, v116, v117
    v_cvt_pk_bf16_f32 v179, v118, v119
    v_mfma_f32_16x16x32_bf16 v[128:131], a[204:207], v[76:79], v[128:131]
    v_exp_f32 v120, v120
    v_mfma_f32_16x16x32_bf16 v[132:135], a[220:223], v[76:79], v[132:135]
    v_exp_f32 v121, v121
    v_mfma_f32_16x16x32_bf16 v[136:139], a[192:195], v[80:83], v[164:167]
    v_exp_f32 v122, v122
    v_mfma_f32_16x16x32_bf16 v[140:143], a[208:211], v[80:83], v[164:167]
    v_exp_f32 v123, v123
    v_mfma_f32_16x16x32_bf16 v[136:139], a[196:199], v[84:87], v[136:139]
    ds_read_b128 a[192:195], v220 offset:16384
    v_cvt_pk_bf16_f32 v180, v120, v121
    v_mfma_f32_16x16x32_bf16 v[140:143], a[212:215], v[84:87], v[140:143]
    v_exp_f32 v124, v124
    v_mfma_f32_16x16x32_bf16 v[136:139], a[200:203], v[88:91], v[136:139]
    v_exp_f32 v125, v125
    v_mfma_f32_16x16x32_bf16 v[140:143], a[216:219], v[88:91], v[140:143]
    ds_read_b128 a[208:211], v220 offset:17408
    v_cvt_pk_bf16_f32 v181, v122, v123
    v_mfma_f32_16x16x32_bf16 v[136:139], a[204:207], v[92:95], v[136:139]
    v_exp_f32 v126, v126
    v_mfma_f32_16x16x32_bf16 v[140:143], a[220:223], v[92:95], v[140:143]
    v_exp_f32 v127, v127
    v_mfma_f32_16x16x32_bf16 a[64:67], a[224:227], v[176:179], a[64:67]
    ds_read_b128 a[196:199], v221 offset:16384
    v_cvt_pk_bf16_f32 v182, v124, v125
    v_mfma_f32_16x16x32_bf16 a[68:71], a[228:231], v[176:179], a[68:71]
    ds_read_b128 a[212:215], v221 offset:17408
    v_cvt_pk_bf16_f32 v183, v126, v127
    v_mfma_f32_16x16x32_bf16 a[72:75], a[232:235], v[176:179], a[72:75]
    ds_read_b128 a[200:203], v222 offset:16384
    v_mfma_f32_16x16x32_bf16 a[76:79], a[236:239], v[176:179], a[76:79]
    ds_read_b128 a[216:219], v222 offset:17408
    v_max3_f32 v238, v128, v129, v130
    v_mfma_f32_16x16x32_bf16 a[80:83], a[240:243], v[176:179], a[80:83]
    ds_read_b128 a[204:207], v223 offset:16384
    v_max3_f32 v238, v238, v131, v132
    v_mfma_f32_16x16x32_bf16 a[84:87], a[244:247], v[176:179], a[84:87]
    ds_read_b128 a[220:223], v223 offset:17408
    v_max3_f32 v238, v238, v133, v134
    v_mfma_f32_16x16x32_bf16 a[88:91], a[248:251], v[176:179], a[88:91]
    v_max3_f32 v238, v238, v135, v136
    v_max3_f32 v238, v238, v137, v138
    v_mfma_f32_16x16x32_bf16 a[92:95], a[252:255], v[176:179], a[92:95]
    v_max3_f32 v238, v238, v139, v140
    v_max3_f32 v238, v238, v141, v142
    v_mfma_f32_16x16x32_bf16 v[200:203], v[216:219], v[176:179], v[200:203]
    v_max_f32 v238, v238, v143
    v_cmp_nge_f32 vcc, s34, v238
    v_mfma_f32_16x16x32_bf16 a[96:99], a[224:227], v[180:183], a[96:99]
    s_cbranch_vccnz Ltr11
Lret11:
    v_mfma_f32_16x16x32_bf16 a[100:103], a[228:231], v[180:183], a[100:103]
    v_exp_f32 v128, v128
    v_mfma_f32_16x16x32_bf16 a[104:107], a[232:235], v[180:183], a[104:107]
    v_exp_f32 v129, v129
    v_mfma_f32_16x16x32_bf16 a[108:111], a[236:239], v[180:183], a[108:111]
    v_exp_f32 v130, v130
    v_mfma_f32_16x16x32_bf16 a[112:115], a[240:243], v[180:183], a[112:115]
    v_exp_f32 v131, v131
    v_mfma_f32_16x16x32_bf16 a[116:119], a[244:247], v[180:183], a[116:119]
    v_cvt_pk_bf16_f32 v184, v128, v129
    v_mfma_f32_16x16x32_bf16 a[120:123], a[248:251], v[180:183], a[120:123]
    v_exp_f32 v132, v132
    v_mfma_f32_16x16x32_bf16 a[124:127], a[252:255], v[180:183], a[124:127]
    v_exp_f32 v133, v133
    v_mfma_f32_16x16x32_bf16 v[204:207], v[216:219], v[180:183], v[204:207]
    s_waitcnt lgkmcnt(0)
    v_cvt_pk_bf16_f32 v185, v130, v131
    v_mfma_f32_16x16x32_bf16 v[96:99], a[192:195], v[0:3], v[144:147]
    v_exp_f32 v134, v134
    v_mfma_f32_16x16x32_bf16 v[100:103], a[208:211], v[0:3], v[144:147]
    v_exp_f32 v135, v135
    v_mfma_f32_16x16x32_bf16 v[96:99], a[196:199], v[4:7], v[96:99]
    v_cvt_pk_bf16_f32 v186, v132, v133
    v_cvt_pk_bf16_f32 v187, v134, v135
    v_mfma_f32_16x16x32_bf16 v[100:103], a[212:215], v[4:7], v[100:103]
    v_exp_f32 v136, v136
    v_mfma_f32_16x16x32_bf16 v[96:99], a[200:203], v[8:11], v[96:99]
    v_exp_f32 v137, v137
    v_mfma_f32_16x16x32_bf16 v[100:103], a[216:219], v[8:11], v[100:103]
    v_exp_f32 v138, v138
    v_mfma_f32_16x16x32_bf16 v[96:99], a[204:207], v[12:15], v[96:99]
    v_exp_f32 v139, v139
    v_mfma_f32_16x16x32_bf16 v[100:103], a[220:223], v[12:15], v[100:103]
    v_cvt_pk_bf16_f32 v188, v136, v137
    v_mfma_f32_16x16x32_bf16 v[104:107], a[192:195], v[16:19], v[148:151]
    v_exp_f32 v140, v140
    v_mfma_f32_16x16x32_bf16 v[108:111], a[208:211], v[16:19], v[148:151]
    v_exp_f32 v141, v141
    v_mfma_f32_16x16x32_bf16 v[104:107], a[196:199], v[20:23], v[104:107]
    v_cvt_pk_bf16_f32 v189, v138, v139
    v_mfma_f32_16x16x32_bf16 v[108:111], a[212:215], v[20:23], v[108:111]
    v_exp_f32 v142, v142
    v_mfma_f32_16x16x32_bf16 v[104:107], a[200:203], v[24:27], v[104:107]
    v_exp_f32 v143, v143
    v_mfma_f32_16x16x32_bf16 v[108:111], a[216:219], v[24:27], v[108:111]
    v_cvt_pk_bf16_f32 v190, v140, v141
    v_cvt_pk_bf16_f32 v191, v142, v143
    v_mfma_f32_16x16x32_bf16 v[104:107], a[204:207], v[28:31], v[104:107]
    v_mfma_f32_16x16x32_bf16 v[108:111], a[220:223], v[28:31], v[108:111]
    v_mfma_f32_16x16x32_bf16 a[128:131], a[224:227], v[184:187], a[128:131]
    v_mfma_f32_16x16x32_bf16 a[132:135], a[228:231], v[184:187], a[132:135]
    v_mfma_f32_16x16x32_bf16 a[136:139], a[232:235], v[184:187], a[136:139]
    v_mfma_f32_16x16x32_bf16 a[140:143], a[236:239], v[184:187], a[140:143]
    v_max3_f32 v238, v96, v97, v98
    v_max3_f32 v238, v238, v99, v100
    v_mfma_f32_16x16x32_bf16 a[144:147], a[240:243], v[184:187], a[144:147]
    v_max3_f32 v238, v238, v101, v102
    v_max3_f32 v238, v238, v103, v104
    v_mfma_f32_16x16x32_bf16 a[148:151], a[244:247], v[184:187], a[148:151]
    v_max3_f32 v238, v238, v105, v106
    v_max3_f32 v238, v238, v107, v108
    v_mfma_f32_16x16x32_bf16 a[152:155], a[248:251], v[184:187], a[152:155]
    v_max3_f32 v238, v238, v109, v110
    v_max_f32 v238, v238, v111
    v_mfma_f32_16x16x32_bf16 a[156:159], a[252:255], v[184:187], a[156:159]
    s_waitcnt vmcnt(24)
    v_cmp_nge_f32 vcc, s34, v238
    v_mfma_f32_16x16x32_bf16 v[208:211], v[216:219], v[184:187], v[208:211]
    s_barrier
    s_cbranch_vccnz Ltr12
Lret12:
    v_mfma_f32_16x16x32_bf16 a[160:163], a[224:227], v[188:191], a[160:163]
    v_exp_f32 v96, v96
    v_mfma_f32_16x16x32_bf16 a[164:167], a[228:231], v[188:191], a[164:167]
    s_add_u32 m0, s24, 16384
    v_exp_f32 v97, v97
    v_mfma_f32_16x16x32_bf16 a[168:171], a[232:235], v[188:191], a[168:171]
    buffer_load_dwordx4 v232, s[4:7], s28 offen offset:0 sc0 sc1 nt lds
    ds_read_b64_tr_b16 a[224:225], v224 offset:0
    v_mfma_f32_16x16x32_bf16 a[172:175], a[236:239], v[188:191], a[172:175]
    v_exp_f32 v98, v98
    v_mfma_f32_16x16x32_bf16 a[176:179], a[240:243], v[188:191], a[176:179]
    buffer_load_dwordx4 v232, s[4:7], s28 offen offset:1024 sc0 sc1 nt lds
    ds_read_b64_tr_b16 a[226:227], v224 offset:1024
    v_mfma_f32_16x16x32_bf16 a[180:183], a[244:247], v[188:191], a[180:183]
    v_exp_f32 v99, v99
    v_mfma_f32_16x16x32_bf16 a[184:187], a[248:251], v[188:191], a[184:187]
    buffer_load_dwordx4 v233, s[4:7], s28 offen offset:2048 sc0 sc1 nt lds
    v_cvt_pk_bf16_f32 v168, v96, v97
    v_mfma_f32_16x16x32_bf16 a[188:191], a[252:255], v[188:191], a[188:191]
    v_exp_f32 v100, v100
    v_mfma_f32_16x16x32_bf16 v[212:215], v[216:219], v[188:191], v[212:215]
    buffer_load_dwordx4 v233, s[4:7], s28 offen offset:3072 sc0 sc1 nt lds
    s_add_u32 s28, s28, 8192
    ds_read_b64_tr_b16 a[228:229], v225 offset:0
    v_mfma_f32_16x16x32_bf16 v[112:115], a[192:195], v[32:35], v[152:155]
    v_exp_f32 v101, v101
    v_mfma_f32_16x16x32_bf16 v[116:119], a[208:211], v[32:35], v[152:155]
    ds_read_b64_tr_b16 a[230:231], v225 offset:1024
    v_cvt_pk_bf16_f32 v169, v98, v99
    v_mfma_f32_16x16x32_bf16 v[112:115], a[196:199], v[36:39], v[112:115]
    v_exp_f32 v102, v102
    v_mfma_f32_16x16x32_bf16 v[116:119], a[212:215], v[36:39], v[116:119]
    v_exp_f32 v103, v103
    v_mfma_f32_16x16x32_bf16 v[112:115], a[200:203], v[40:43], v[112:115]
    ds_read_b64_tr_b16 a[232:233], v226 offset:0
    v_cvt_pk_bf16_f32 v170, v100, v101
    v_mfma_f32_16x16x32_bf16 v[116:119], a[216:219], v[40:43], v[116:119]
    ds_read_b64_tr_b16 a[234:235], v226 offset:1024
    v_cvt_pk_bf16_f32 v171, v102, v103
    v_mfma_f32_16x16x32_bf16 v[112:115], a[204:207], v[44:47], v[112:115]
    v_exp_f32 v104, v104
    v_mfma_f32_16x16x32_bf16 v[116:119], a[220:223], v[44:47], v[116:119]
    v_exp_f32 v105, v105
    v_mfma_f32_16x16x32_bf16 v[120:123], a[192:195], v[48:51], v[156:159]
    ds_read_b64_tr_b16 a[236:237], v227 offset:0
    ds_read_b64_tr_b16 a[238:239], v227 offset:1024
    v_mfma_f32_16x16x32_bf16 v[124:127], a[208:211], v[48:51], v[156:159]
    ds_read_b64_tr_b16 a[240:241], v228 offset:0
    ds_read_b64_tr_b16 a[242:243], v228 offset:1024
    v_mfma_f32_16x16x32_bf16 v[120:123], a[196:199], v[52:55], v[120:123]
    ds_read_b64_tr_b16 a[244:245], v229 offset:0
    ds_read_b64_tr_b16 a[246:247], v229 offset:1024
    v_mfma_f32_16x16x32_bf16 v[124:127], a[212:215], v[52:55], v[124:127]
    ds_read_b64_tr_b16 a[248:249], v230 offset:0
    ds_read_b64_tr_b16 a[250:251], v230 offset:1024
    v_mfma_f32_16x16x32_bf16 v[120:123], a[200:203], v[56:59], v[120:123]
    ds_read_b64_tr_b16 a[252:253], v231 offset:0
    ds_read_b64_tr_b16 a[254:255], v231 offset:1024
    v_mfma_f32_16x16x32_bf16 v[124:127], a[216:219], v[56:59], v[124:127]
    v_exp_f32 v106, v106
    v_mfma_f32_16x16x32_bf16 v[120:123], a[204:207], v[60:63], v[120:123]
    v_exp_f32 v107, v107
    v_mfma_f32_16x16x32_bf16 v[124:127], a[220:223], v[60:63], v[124:127]
    s_waitcnt vmcnt(24) lgkmcnt(0)
    v_cvt_pk_bf16_f32 v172, v104, v105
    v_mfma_f32_16x16x32_bf16 a[0:3], a[224:227], v[168:171], a[0:3]
    s_barrier
    v_exp_f32 v108, v108
    v_mfma_f32_16x16x32_bf16 a[4:7], a[228:231], v[168:171], a[4:7]
    s_add_u32 m0, s25, 0
    v_exp_f32 v109, v109
    v_mfma_f32_16x16x32_bf16 a[8:11], a[232:235], v[168:171], a[8:11]
    buffer_load_dwordx4 v234, s[76:79], s29 offen offset:0 sc0 sc1 nt lds
    v_cvt_pk_bf16_f32 v173, v106, v107
    v_mfma_f32_16x16x32_bf16 a[12:15], a[236:239], v[168:171], a[12:15]
    v_exp_f32 v110, v110
    v_mfma_f32_16x16x32_bf16 a[16:19], a[240:243], v[168:171], a[16:19]
    v_exp_f32 v111, v111
    v_mfma_f32_16x16x32_bf16 a[20:23], a[244:247], v[168:171], a[20:23]
    buffer_load_dwordx4 v234, s[76:79], s29 offen offset:1024 sc0 sc1 nt lds
    v_cvt_pk_bf16_f32 v174, v108, v109
    v_mfma_f32_16x16x32_bf16 a[24:27], a[248:251], v[168:171], a[24:27]
    v_cvt_pk_bf16_f32 v175, v110, v111
    v_max3_f32 v239, v112, v113, v114
    v_mfma_f32_16x16x32_bf16 a[28:31], a[252:255], v[168:171], a[28:31]
    buffer_load_dwordx4 v235, s[76:79], s29 offen offset:2048 sc0 sc1 nt lds
    v_max3_f32 v239, v239, v115, v116
    v_mfma_f32_16x16x32_bf16 v[192:195], v[216:219], v[168:171], v[192:195]
    v_max3_f32 v239, v239, v117, v118
    v_max3_f32 v239, v239, v119, v120
    v_mfma_f32_16x16x32_bf16 a[32:35], a[224:227], v[172:175], a[32:35]
    buffer_load_dwordx4 v235, s[76:79], s29 offen offset:3072 sc0 sc1 nt lds
    v_max3_f32 v239, v239, v121, v122
    v_mfma_f32_16x16x32_bf16 a[36:39], a[228:231], v[172:175], a[36:39]
    s_add_u32 s29, s29, 8192
    v_max3_f32 v239, v239, v123, v124
    v_max3_f32 v239, v239, v125, v126
    v_mfma_f32_16x16x32_bf16 a[40:43], a[232:235], v[172:175], a[40:43]
    v_max_f32 v239, v239, v127
    v_cmp_nge_f32 vcc, s34, v239
    v_mfma_f32_16x16x32_bf16 a[44:47], a[236:239], v[172:175], a[44:47]
    s_cbranch_vccnz Ltr13
Lret13:
    v_mfma_f32_16x16x32_bf16 a[48:51], a[240:243], v[172:175], a[48:51]
    v_exp_f32 v112, v112
    v_mfma_f32_16x16x32_bf16 a[52:55], a[244:247], v[172:175], a[52:55]
    v_exp_f32 v113, v113
    v_mfma_f32_16x16x32_bf16 a[56:59], a[248:251], v[172:175], a[56:59]
    v_exp_f32 v114, v114
    v_mfma_f32_16x16x32_bf16 a[60:63], a[252:255], v[172:175], a[60:63]
    v_exp_f32 v115, v115
    v_mfma_f32_16x16x32_bf16 v[196:199], v[216:219], v[172:175], v[196:199]
    v_cvt_pk_bf16_f32 v176, v112, v113
    v_mfma_f32_16x16x32_bf16 v[128:131], a[192:195], v[64:67], v[160:163]
    v_exp_f32 v116, v116
    v_mfma_f32_16x16x32_bf16 v[132:135], a[208:211], v[64:67], v[160:163]
    v_exp_f32 v117, v117
    v_mfma_f32_16x16x32_bf16 v[128:131], a[196:199], v[68:71], v[128:131]
    v_cvt_pk_bf16_f32 v177, v114, v115
    v_mfma_f32_16x16x32_bf16 v[132:135], a[212:215], v[68:71], v[132:135]
    v_exp_f32 v118, v118
    v_mfma_f32_16x16x32_bf16 v[128:131], a[200:203], v[72:75], v[128:131]
    v_exp_f32 v119, v119
    v_mfma_f32_16x16x32_bf16 v[132:135], a[216:219], v[72:75], v[132:135]
    v_cvt_pk_bf16_f32 v178, v116, v117
    v_cvt_pk_bf16_f32 v179, v118, v119
    v_mfma_f32_16x16x32_bf16 v[128:131], a[204:207], v[76:79], v[128:131]
    v_exp_f32 v120, v120
    v_mfma_f32_16x16x32_bf16 v[132:135], a[220:223], v[76:79], v[132:135]
    v_exp_f32 v121, v121
    v_mfma_f32_16x16x32_bf16 v[136:139], a[192:195], v[80:83], v[164:167]
    v_exp_f32 v122, v122
    v_mfma_f32_16x16x32_bf16 v[140:143], a[208:211], v[80:83], v[164:167]
    v_exp_f32 v123, v123
    v_mfma_f32_16x16x32_bf16 v[136:139], a[196:199], v[84:87], v[136:139]
    ds_read_b128 a[192:195], v220 offset:32768
    v_cvt_pk_bf16_f32 v180, v120, v121
    v_mfma_f32_16x16x32_bf16 v[140:143], a[212:215], v[84:87], v[140:143]
    v_exp_f32 v124, v124
    v_mfma_f32_16x16x32_bf16 v[136:139], a[200:203], v[88:91], v[136:139]
    v_exp_f32 v125, v125
    v_mfma_f32_16x16x32_bf16 v[140:143], a[216:219], v[88:91], v[140:143]
    ds_read_b128 a[208:211], v220 offset:33792
    v_cvt_pk_bf16_f32 v181, v122, v123
    v_mfma_f32_16x16x32_bf16 v[136:139], a[204:207], v[92:95], v[136:139]
    v_exp_f32 v126, v126
    v_mfma_f32_16x16x32_bf16 v[140:143], a[220:223], v[92:95], v[140:143]
    v_exp_f32 v127, v127
    v_mfma_f32_16x16x32_bf16 a[64:67], a[224:227], v[176:179], a[64:67]
    ds_read_b128 a[196:199], v221 offset:32768
    v_cvt_pk_bf16_f32 v182, v124, v125
    v_mfma_f32_16x16x32_bf16 a[68:71], a[228:231], v[176:179], a[68:71]
    ds_read_b128 a[212:215], v221 offset:33792
    v_cvt_pk_bf16_f32 v183, v126, v127
    v_mfma_f32_16x16x32_bf16 a[72:75], a[232:235], v[176:179], a[72:75]
    ds_read_b128 a[200:203], v222 offset:32768
    v_mfma_f32_16x16x32_bf16 a[76:79], a[236:239], v[176:179], a[76:79]
    ds_read_b128 a[216:219], v222 offset:33792
    v_max3_f32 v238, v128, v129, v130
    v_mfma_f32_16x16x32_bf16 a[80:83], a[240:243], v[176:179], a[80:83]
    ds_read_b128 a[204:207], v223 offset:32768
    v_max3_f32 v238, v238, v131, v132
    v_mfma_f32_16x16x32_bf16 a[84:87], a[244:247], v[176:179], a[84:87]
    ds_read_b128 a[220:223], v223 offset:33792
    v_max3_f32 v238, v238, v133, v134
    v_mfma_f32_16x16x32_bf16 a[88:91], a[248:251], v[176:179], a[88:91]
    v_max3_f32 v238, v238, v135, v136
    v_max3_f32 v238, v238, v137, v138
    v_mfma_f32_16x16x32_bf16 a[92:95], a[252:255], v[176:179], a[92:95]
    v_max3_f32 v238, v238, v139, v140
    v_max3_f32 v238, v238, v141, v142
    v_mfma_f32_16x16x32_bf16 v[200:203], v[216:219], v[176:179], v[200:203]
    v_max_f32 v238, v238, v143
    v_cmp_nge_f32 vcc, s34, v238
    v_mfma_f32_16x16x32_bf16 a[96:99], a[224:227], v[180:183], a[96:99]
    s_cbranch_vccnz Ltr14
Lret14:
    v_mfma_f32_16x16x32_bf16 a[100:103], a[228:231], v[180:183], a[100:103]
    v_exp_f32 v128, v128
    v_mfma_f32_16x16x32_bf16 a[104:107], a[232:235], v[180:183], a[104:107]
    v_exp_f32 v129, v129
    v_mfma_f32_16x16x32_bf16 a[108:111], a[236:239], v[180:183], a[108:111]
    v_exp_f32 v130, v130
    v_mfma_f32_16x16x32_bf16 a[112:115], a[240:243], v[180:183], a[112:115]
    v_exp_f32 v131, v131
    v_mfma_f32_16x16x32_bf16 a[116:119], a[244:247], v[180:183], a[116:119]
    v_cvt_pk_bf16_f32 v184, v128, v129
    v_mfma_f32_16x16x32_bf16 a[120:123], a[248:251], v[180:183], a[120:123]
    v_exp_f32 v132, v132
    v_mfma_f32_16x16x32_bf16 a[124:127], a[252:255], v[180:183], a[124:127]
    v_exp_f32 v133, v133
    v_mfma_f32_16x16x32_bf16 v[204:207], v[216:219], v[180:183], v[204:207]
    s_waitcnt lgkmcnt(0)
    v_cvt_pk_bf16_f32 v185, v130, v131
    v_mfma_f32_16x16x32_bf16 v[96:99], a[192:195], v[0:3], v[144:147]
    v_exp_f32 v134, v134
    v_mfma_f32_16x16x32_bf16 v[100:103], a[208:211], v[0:3], v[144:147]
    v_exp_f32 v135, v135
    v_mfma_f32_16x16x32_bf16 v[96:99], a[196:199], v[4:7], v[96:99]
    v_cvt_pk_bf16_f32 v186, v132, v133
    v_cvt_pk_bf16_f32 v187, v134, v135
    v_mfma_f32_16x16x32_bf16 v[100:103], a[212:215], v[4:7], v[100:103]
    v_exp_f32 v136, v136
    v_mfma_f32_16x16x32_bf16 v[96:99], a[200:203], v[8:11], v[96:99]
    v_exp_f32 v137, v137
    v_mfma_f32_16x16x32_bf16 v[100:103], a[216:219], v[8:11], v[100:103]
    v_exp_f32 v138, v138
    v_mfma_f32_16x16x32_bf16 v[96:99], a[204:207], v[12:15], v[96:99]
    v_exp_f32 v139, v139
    v_mfma_f32_16x16x32_bf16 v[100:103], a[220:223], v[12:15], v[100:103]
    v_cvt_pk_bf16_f32 v188, v136, v137
    v_mfma_f32_16x16x32_bf16 v[104:107], a[192:195], v[16:19], v[148:151]
    v_exp_f32 v140, v140
    v_mfma_f32_16x16x32_bf16 v[108:111], a[208:211], v[16:19], v[148:151]
    v_exp_f32 v141, v141
    v_mfma_f32_16x16x32_bf16 v[104:107], a[196:199], v[20:23], v[104:107]
    v_cvt_pk_bf16_f32 v189, v138, v139
    v_mfma_f32_16x16x32_bf16 v[108:111], a[212:215], v[20:23], v[108:111]
    v_exp_f32 v142, v142
    v_mfma_f32_16x16x32_bf16 v[104:107], a[200:203], v[24:27], v[104:107]
    v_exp_f32 v143, v143
    v_mfma_f32_16x16x32_bf16 v[108:111], a[216:219], v[24:27], v[108:111]
    v_cvt_pk_bf16_f32 v190, v140, v141
    v_cvt_pk_bf16_f32 v191, v142, v143
    v_mfma_f32_16x16x32_bf16 v[104:107], a[204:207], v[28:31], v[104:107]
    v_mfma_f32_16x16x32_bf16 v[108:111], a[220:223], v[28:31], v[108:111]
    v_mfma_f32_16x16x32_bf16 a[128:131], a[224:227], v[184:187], a[128:131]
    v_mfma_f32_16x16x32_bf16 a[132:135], a[228:231], v[184:187], a[132:135]
    v_mfma_f32_16x16x32_bf16 a[136:139], a[232:235], v[184:187], a[136:139]
    v_mfma_f32_16x16x32_bf16 a[140:143], a[236:239], v[184:187], a[140:143]
    v_max3_f32 v238, v96, v97, v98
    v_max3_f32 v238, v238, v99, v100
    v_mfma_f32_16x16x32_bf16 a[144:147], a[240:243], v[184:187], a[144:147]
    v_max3_f32 v238, v238, v101, v102
    v_max3_f32 v238, v238, v103, v104
    v_mfma_f32_16x16x32_bf16 a[148:151], a[244:247], v[184:187], a[148:151]
    v_max3_f32 v238, v238, v105, v106
    v_max3_f32 v238, v238, v107, v108
    v_mfma_f32_16x16x32_bf16 a[152:155], a[248:251], v[184:187], a[152:155]
    v_max3_f32 v238, v238, v109, v110
    v_max_f32 v238, v238, v111
    v_mfma_f32_16x16x32_bf16 a[156:159], a[252:255], v[184:187], a[156:159]
    s_waitcnt vmcnt(24)
    v_cmp_nge_f32 vcc, s34, v238
    v_mfma_f32_16x16x32_bf16 v[208:211], v[216:219], v[184:187], v[208:211]
    s_barrier
    s_cbranch_vccnz Ltr15
Lret15:
    v_mfma_f32_16x16x32_bf16 a[160:163], a[224:227], v[188:191], a[160:163]
    v_exp_f32 v96, v96
    v_mfma_f32_16x16x32_bf16 a[164:167], a[228:231], v[188:191], a[164:167]
    s_add_u32 m0, s24, 32768
    v_exp_f32 v97, v97
    v_mfma_f32_16x16x32_bf16 a[168:171], a[232:235], v[188:191], a[168:171]
    buffer_load_dwordx4 v232, s[4:7], s28 offen offset:0 sc0 sc1 nt lds
    ds_read_b64_tr_b16 a[224:225], v224 offset:16384
    v_mfma_f32_16x16x32_bf16 a[172:175], a[236:239], v[188:191], a[172:175]
    v_exp_f32 v98, v98
    v_mfma_f32_16x16x32_bf16 a[176:179], a[240:243], v[188:191], a[176:179]
    buffer_load_dwordx4 v232, s[4:7], s28 offen offset:1024 sc0 sc1 nt lds
    ds_read_b64_tr_b16 a[226:227], v224 offset:17408
    v_mfma_f32_16x16x32_bf16 a[180:183], a[244:247], v[188:191], a[180:183]
    v_exp_f32 v99, v99
    v_mfma_f32_16x16x32_bf16 a[184:187], a[248:251], v[188:191], a[184:187]
    buffer_load_dwordx4 v233, s[4:7], s28 offen offset:2048 sc0 sc1 nt lds
    v_cvt_pk_bf16_f32 v168, v96, v97
    v_mfma_f32_16x16x32_bf16 a[188:191], a[252:255], v[188:191], a[188:191]
    v_exp_f32 v100, v100
    v_mfma_f32_16x16x32_bf16 v[212:215], v[216:219], v[188:191], v[212:215]
    buffer_load_dwordx4 v233, s[4:7], s28 offen offset:3072 sc0 sc1 nt lds
    s_add_u32 s28, s28, 8192
    ds_read_b64_tr_b16 a[228:229], v225 offset:16384
    v_mfma_f32_16x16x32_bf16 v[112:115], a[192:195], v[32:35], v[152:155]
    v_exp_f32 v101, v101
    v_mfma_f32_16x16x32_bf16 v[116:119], a[208:211], v[32:35], v[152:155]
    ds_read_b64_tr_b16 a[230:231], v225 offset:17408
    v_cvt_pk_bf16_f32 v169, v98, v99
    v_mfma_f32_16x16x32_bf16 v[112:115], a[196:199], v[36:39], v[112:115]
    v_exp_f32 v102, v102
    v_mfma_f32_16x16x32_bf16 v[116:119], a[212:215], v[36:39], v[116:119]
    v_exp_f32 v103, v103
    v_mfma_f32_16x16x32_bf16 v[112:115], a[200:203], v[40:43], v[112:115]
    ds_read_b64_tr_b16 a[232:233], v226 offset:16384
    v_cvt_pk_bf16_f32 v170, v100, v101
    v_mfma_f32_16x16x32_bf16 v[116:119], a[216:219], v[40:43], v[116:119]
    ds_read_b64_tr_b16 a[234:235], v226 offset:17408
    v_cvt_pk_bf16_f32 v171, v102, v103
    v_mfma_f32_16x16x32_bf16 v[112:115], a[204:207], v[44:47], v[112:115]
    v_exp_f32 v104, v104
    v_mfma_f32_16x16x32_bf16 v[116:119], a[220:223], v[44:47], v[116:119]
    v_exp_f32 v105, v105
    v_mfma_f32_16x16x32_bf16 v[120:123], a[192:195], v[48:51], v[156:159]
    ds_read_b64_tr_b16 a[236:237], v227 offset:16384
    ds_read_b64_tr_b16 a[238:239], v227 offset:17408
    v_mfma_f32_16x16x32_bf16 v[124:127], a[208:211], v[48:51], v[156:159]
    ds_read_b64_tr_b16 a[240:241], v228 offset:16384
    ds_read_b64_tr_b16 a[242:243], v228 offset:17408
    v_mfma_f32_16x16x32_bf16 v[120:123], a[196:199], v[52:55], v[120:123]
    ds_read_b64_tr_b16 a[244:245], v229 offset:16384
    ds_read_b64_tr_b16 a[246:247], v229 offset:17408
    v_mfma_f32_16x16x32_bf16 v[124:127], a[212:215], v[52:55], v[124:127]
    ds_read_b64_tr_b16 a[248:249], v230 offset:16384
    ds_read_b64_tr_b16 a[250:251], v230 offset:17408
    v_mfma_f32_16x16x32_bf16 v[120:123], a[200:203], v[56:59], v[120:123]
    ds_read_b64_tr_b16 a[252:253], v231 offset:16384
    ds_read_b64_tr_b16 a[254:255], v231 offset:17408
    v_mfma_f32_16x16x32_bf16 v[124:127], a[216:219], v[56:59], v[124:127]
    v_exp_f32 v106, v106
    v_mfma_f32_16x16x32_bf16 v[120:123], a[204:207], v[60:63], v[120:123]
    v_exp_f32 v107, v107
    v_mfma_f32_16x16x32_bf16 v[124:127], a[220:223], v[60:63], v[124:127]
    s_waitcnt vmcnt(24) lgkmcnt(0)
    v_cvt_pk_bf16_f32 v172, v104, v105
    v_mfma_f32_16x16x32_bf16 a[0:3], a[224:227], v[168:171], a[0:3]
    s_barrier
    v_exp_f32 v108, v108
    v_mfma_f32_16x16x32_bf16 a[4:7], a[228:231], v[168:171], a[4:7]
    s_add_u32 m0, s25, 16384
    v_exp_f32 v109, v109
    v_mfma_f32_16x16x32_bf16 a[8:11], a[232:235], v[168:171], a[8:11]
    buffer_load_dwordx4 v234, s[76:79], s29 offen offset:0 sc0 sc1 nt lds
    v_cvt_pk_bf16_f32 v173, v106, v107
    v_mfma_f32_16x16x32_bf16 a[12:15], a[236:239], v[168:171], a[12:15]
    v_exp_f32 v110, v110
    v_mfma_f32_16x16x32_bf16 a[16:19], a[240:243], v[168:171], a[16:19]
    v_exp_f32 v111, v111
    v_mfma_f32_16x16x32_bf16 a[20:23], a[244:247], v[168:171], a[20:23]
    buffer_load_dwordx4 v234, s[76:79], s29 offen offset:1024 sc0 sc1 nt lds
    v_cvt_pk_bf16_f32 v174, v108, v109
    v_mfma_f32_16x16x32_bf16 a[24:27], a[248:251], v[168:171], a[24:27]
    v_cvt_pk_bf16_f32 v175, v110, v111
    v_max3_f32 v239, v112, v113, v114
    v_mfma_f32_16x16x32_bf16 a[28:31], a[252:255], v[168:171], a[28:31]
    buffer_load_dwordx4 v235, s[76:79], s29 offen offset:2048 sc0 sc1 nt lds
    v_max3_f32 v239, v239, v115, v116
    v_mfma_f32_16x16x32_bf16 v[192:195], v[216:219], v[168:171], v[192:195]
    v_max3_f32 v239, v239, v117, v118
    v_max3_f32 v239, v239, v119, v120
    v_mfma_f32_16x16x32_bf16 a[32:35], a[224:227], v[172:175], a[32:35]
    buffer_load_dwordx4 v235, s[76:79], s29 offen offset:3072 sc0 sc1 nt lds
    v_max3_f32 v239, v239, v121, v122
    v_mfma_f32_16x16x32_bf16 a[36:39], a[228:231], v[172:175], a[36:39]
    s_add_u32 s29, s29, 8192
    v_max3_f32 v239, v239, v123, v124
    v_max3_f32 v239, v239, v125, v126
    v_mfma_f32_16x16x32_bf16 a[40:43], a[232:235], v[172:175], a[40:43]
    v_max_f32 v239, v239, v127
    v_cmp_nge_f32 vcc, s34, v239
    v_mfma_f32_16x16x32_bf16 a[44:47], a[236:239], v[172:175], a[44:47]
    s_cbranch_vccnz Ltr16
Lret16:
    v_mfma_f32_16x16x32_bf16 a[48:51], a[240:243], v[172:175], a[48:51]
    v_exp_f32 v112, v112
    v_mfma_f32_16x16x32_bf16 a[52:55], a[244:247], v[172:175], a[52:55]
    v_exp_f32 v113, v113
    v_mfma_f32_16x16x32_bf16 a[56:59], a[248:251], v[172:175], a[56:59]
    v_exp_f32 v114, v114
    v_mfma_f32_16x16x32_bf16 a[60:63], a[252:255], v[172:175], a[60:63]
    v_exp_f32 v115, v115
    v_mfma_f32_16x16x32_bf16 v[196:199], v[216:219], v[172:175], v[196:199]
    v_cvt_pk_bf16_f32 v176, v112, v113
    v_mfma_f32_16x16x32_bf16 v[128:131], a[192:195], v[64:67], v[160:163]
    v_exp_f32 v116, v116
    v_mfma_f32_16x16x32_bf16 v[132:135], a[208:211], v[64:67], v[160:163]
    v_exp_f32 v117, v117
    v_mfma_f32_16x16x32_bf16 v[128:131], a[196:199], v[68:71], v[128:131]
    v_cvt_pk_bf16_f32 v177, v114, v115
    v_mfma_f32_16x16x32_bf16 v[132:135], a[212:215], v[68:71], v[132:135]
    v_exp_f32 v118, v118
    v_mfma_f32_16x16x32_bf16 v[128:131], a[200:203], v[72:75], v[128:131]
    v_exp_f32 v119, v119
    v_mfma_f32_16x16x32_bf16 v[132:135], a[216:219], v[72:75], v[132:135]
    v_cvt_pk_bf16_f32 v178, v116, v117
    v_cvt_pk_bf16_f32 v179, v118, v119
    v_mfma_f32_16x16x32_bf16 v[128:131], a[204:207], v[76:79], v[128:131]
    v_exp_f32 v120, v120
    v_mfma_f32_16x16x32_bf16 v[132:135], a[220:223], v[76:79], v[132:135]
    v_exp_f32 v121, v121
    v_mfma_f32_16x16x32_bf16 v[136:139], a[192:195], v[80:83], v[164:167]
    v_exp_f32 v122, v122
    v_mfma_f32_16x16x32_bf16 v[140:143], a[208:211], v[80:83], v[164:167]
    v_exp_f32 v123, v123
    v_mfma_f32_16x16x32_bf16 v[136:139], a[196:199], v[84:87], v[136:139]
    ds_read_b128 a[192:195], v220 offset:49152
    v_cvt_pk_bf16_f32 v180, v120, v121
    v_mfma_f32_16x16x32_bf16 v[140:143], a[212:215], v[84:87], v[140:143]
    v_exp_f32 v124, v124
    v_mfma_f32_16x16x32_bf16 v[136:139], a[200:203], v[88:91], v[136:139]
    v_exp_f32 v125, v125
    v_mfma_f32_16x16x32_bf16 v[140:143], a[216:219], v[88:91], v[140:143]
    ds_read_b128 a[208:211], v220 offset:50176
    v_cvt_pk_bf16_f32 v181, v122, v123
    v_mfma_f32_16x16x32_bf16 v[136:139], a[204:207], v[92:95], v[136:139]
    v_exp_f32 v126, v126
    v_mfma_f32_16x16x32_bf16 v[140:143], a[220:223], v[92:95], v[140:143]
    v_exp_f32 v127, v127
    v_mfma_f32_16x16x32_bf16 a[64:67], a[224:227], v[176:179], a[64:67]
    ds_read_b128 a[196:199], v221 offset:49152
    v_cvt_pk_bf16_f32 v182, v124, v125
    v_mfma_f32_16x16x32_bf16 a[68:71], a[228:231], v[176:179], a[68:71]
    ds_read_b128 a[212:215], v221 offset:50176
    v_cvt_pk_bf16_f32 v183, v126, v127
    v_mfma_f32_16x16x32_bf16 a[72:75], a[232:235], v[176:179], a[72:75]
    ds_read_b128 a[200:203], v222 offset:49152
    v_mfma_f32_16x16x32_bf16 a[76:79], a[236:239], v[176:179], a[76:79]
    ds_read_b128 a[216:219], v222 offset:50176
    v_max3_f32 v238, v128, v129, v130
    v_mfma_f32_16x16x32_bf16 a[80:83], a[240:243], v[176:179], a[80:83]
    ds_read_b128 a[204:207], v223 offset:49152
    v_max3_f32 v238, v238, v131, v132
    v_mfma_f32_16x16x32_bf16 a[84:87], a[244:247], v[176:179], a[84:87]
    ds_read_b128 a[220:223], v223 offset:50176
    v_max3_f32 v238, v238, v133, v134
    v_mfma_f32_16x16x32_bf16 a[88:91], a[248:251], v[176:179], a[88:91]
    v_max3_f32 v238, v238, v135, v136
    v_max3_f32 v238, v238, v137, v138
    v_mfma_f32_16x16x32_bf16 a[92:95], a[252:255], v[176:179], a[92:95]
    v_max3_f32 v238, v238, v139, v140
    v_max3_f32 v238, v238, v141, v142
    v_mfma_f32_16x16x32_bf16 v[200:203], v[216:219], v[176:179], v[200:203]
    v_max_f32 v238, v238, v143
    v_cmp_nge_f32 vcc, s34, v238
    v_mfma_f32_16x16x32_bf16 a[96:99], a[224:227], v[180:183], a[96:99]
    s_cbranch_vccnz Ltr17
Lret17:
    v_mfma_f32_16x16x32_bf16 a[100:103], a[228:231], v[180:183], a[100:103]
    v_exp_f32 v128, v128
    v_mfma_f32_16x16x32_bf16 a[104:107], a[232:235], v[180:183], a[104:107]
    v_exp_f32 v129, v129
    v_mfma_f32_16x16x32_bf16 a[108:111], a[236:239], v[180:183], a[108:111]
    v_exp_f32 v130, v130
    v_mfma_f32_16x16x32_bf16 a[112:115], a[240:243], v[180:183], a[112:115]
    v_exp_f32 v131, v131
    v_mfma_f32_16x16x32_bf16 a[116:119], a[244:247], v[180:183], a[116:119]
    v_cvt_pk_bf16_f32 v184, v128, v129
    v_mfma_f32_16x16x32_bf16 a[120:123], a[248:251], v[180:183], a[120:123]
    v_exp_f32 v132, v132
    v_mfma_f32_16x16x32_bf16 a[124:127], a[252:255], v[180:183], a[124:127]
    v_exp_f32 v133, v133
    v_mfma_f32_16x16x32_bf16 v[204:207], v[216:219], v[180:183], v[204:207]
    s_waitcnt lgkmcnt(0)
    v_cvt_pk_bf16_f32 v185, v130, v131
    v_mfma_f32_16x16x32_bf16 v[96:99], a[192:195], v[0:3], v[144:147]
    v_exp_f32 v134, v134
    v_mfma_f32_16x16x32_bf16 v[100:103], a[208:211], v[0:3], v[144:147]
    v_exp_f32 v135, v135
    v_mfma_f32_16x16x32_bf16 v[96:99], a[196:199], v[4:7], v[96:99]
    v_cvt_pk_bf16_f32 v186, v132, v133
    v_cvt_pk_bf16_f32 v187, v134, v135
    v_mfma_f32_16x16x32_bf16 v[100:103], a[212:215], v[4:7], v[100:103]
    v_exp_f32 v136, v136
    v_mfma_f32_16x16x32_bf16 v[96:99], a[200:203], v[8:11], v[96:99]
    v_exp_f32 v137, v137
    v_mfma_f32_16x16x32_bf16 v[100:103], a[216:219], v[8:11], v[100:103]
    v_exp_f32 v138, v138
    v_mfma_f32_16x16x32_bf16 v[96:99], a[204:207], v[12:15], v[96:99]
    v_exp_f32 v139, v139
    v_mfma_f32_16x16x32_bf16 v[100:103], a[220:223], v[12:15], v[100:103]
    v_cvt_pk_bf16_f32 v188, v136, v137
    v_mfma_f32_16x16x32_bf16 v[104:107], a[192:195], v[16:19], v[148:151]
    v_exp_f32 v140, v140
    v_mfma_f32_16x16x32_bf16 v[108:111], a[208:211], v[16:19], v[148:151]
    v_exp_f32 v141, v141
    v_mfma_f32_16x16x32_bf16 v[104:107], a[196:199], v[20:23], v[104:107]
    v_cvt_pk_bf16_f32 v189, v138, v139
    v_mfma_f32_16x16x32_bf16 v[108:111], a[212:215], v[20:23], v[108:111]
    v_exp_f32 v142, v142
    v_mfma_f32_16x16x32_bf16 v[104:107], a[200:203], v[24:27], v[104:107]
    v_exp_f32 v143, v143
    v_mfma_f32_16x16x32_bf16 v[108:111], a[216:219], v[24:27], v[108:111]
    v_cvt_pk_bf16_f32 v190, v140, v141
    v_cvt_pk_bf16_f32 v191, v142, v143
    v_mfma_f32_16x16x32_bf16 v[104:107], a[204:207], v[28:31], v[104:107]
    v_mfma_f32_16x16x32_bf16 v[108:111], a[220:223], v[28:31], v[108:111]
    v_mfma_f32_16x16x32_bf16 a[128:131], a[224:227], v[184:187], a[128:131]
    v_mfma_f32_16x16x32_bf16 a[132:135], a[228:231], v[184:187], a[132:135]
    v_mfma_f32_16x16x32_bf16 a[136:139], a[232:235], v[184:187], a[136:139]
    v_mfma_f32_16x16x32_bf16 a[140:143], a[236:239], v[184:187], a[140:143]
    v_max3_f32 v238, v96, v97, v98
    v_max3_f32 v238, v238, v99, v100
    v_mfma_f32_16x16x32_bf16 a[144:147], a[240:243], v[184:187], a[144:147]
    v_max3_f32 v238, v238, v101, v102
    v_max3_f32 v238, v238, v103, v104
    v_mfma_f32_16x16x32_bf16 a[148:151], a[244:247], v[184:187], a[148:151]
    v_max3_f32 v238, v238, v105, v106
    v_max3_f32 v238, v238, v107, v108
    v_mfma_f32_16x16x32_bf16 a[152:155], a[248:251], v[184:187], a[152:155]
    v_max3_f32 v238, v238, v109, v110
    v_max_f32 v238, v238, v111
    v_mfma_f32_16x16x32_bf16 a[156:159], a[252:255], v[184:187], a[156:159]
    s_waitcnt vmcnt(24)
    v_cmp_nge_f32 vcc, s34, v238
    v_mfma_f32_16x16x32_bf16 v[208:211], v[216:219], v[184:187], v[208:211]
    s_barrier
    s_cbranch_vccnz Ltr18
Lret18:
    v_mfma_f32_16x16x32_bf16 a[160:163], a[224:227], v[188:191], a[160:163]
    v_exp_f32 v96, v96
    v_mfma_f32_16x16x32_bf16 a[164:167], a[228:231], v[188:191], a[164:167]
    s_add_u32 m0, s24, 49152
    v_exp_f32 v97, v97
    v_mfma_f32_16x16x32_bf16 a[168:171], a[232:235], v[188:191], a[168:171]
    buffer_load_dwordx4 v232, s[4:7], s28 offen offset:0 sc0 sc1 nt lds
    ds_read_b64_tr_b16 a[224:225], v224 offset:32768
    v_mfma_f32_16x16x32_bf16 a[172:175], a[236:239], v[188:191], a[172:175]
    v_exp_f32 v98, v98
    v_mfma_f32_16x16x32_bf16 a[176:179], a[240:243], v[188:191], a[176:179]
    buffer_load_dwordx4 v232, s[4:7], s28 offen offset:1024 sc0 sc1 nt lds
    ds_read_b64_tr_b16 a[226:227], v224 offset:33792
    v_mfma_f32_16x16x32_bf16 a[180:183], a[244:247], v[188:191], a[180:183]
    v_exp_f32 v99, v99
    v_mfma_f32_16x16x32_bf16 a[184:187], a[248:251], v[188:191], a[184:187]
    buffer_load_dwordx4 v233, s[4:7], s28 offen offset:2048 sc0 sc1 nt lds
    v_cvt_pk_bf16_f32 v168, v96, v97
    v_mfma_f32_16x16x32_bf16 a[188:191], a[252:255], v[188:191], a[188:191]
    v_exp_f32 v100, v100
    v_mfma_f32_16x16x32_bf16 v[212:215], v[216:219], v[188:191], v[212:215]
    buffer_load_dwordx4 v233, s[4:7], s28 offen offset:3072 sc0 sc1 nt lds
    s_add_u32 s28, s28, 8192
    ds_read_b64_tr_b16 a[228:229], v225 offset:32768
    v_mfma_f32_16x16x32_bf16 v[112:115], a[192:195], v[32:35], v[152:155]
    v_exp_f32 v101, v101
    v_mfma_f32_16x16x32_bf16 v[116:119], a[208:211], v[32:35], v[152:155]
    ds_read_b64_tr_b16 a[230:231], v225 offset:33792
    v_cvt_pk_bf16_f32 v169, v98, v99
    v_mfma_f32_16x16x32_bf16 v[112:115], a[196:199], v[36:39], v[112:115]
    v_exp_f32 v102, v102
    v_mfma_f32_16x16x32_bf16 v[116:119], a[212:215], v[36:39], v[116:119]
    v_exp_f32 v103, v103
    v_mfma_f32_16x16x32_bf16 v[112:115], a[200:203], v[40:43], v[112:115]
    ds_read_b64_tr_b16 a[232:233], v226 offset:32768
    v_cvt_pk_bf16_f32 v170, v100, v101
    v_mfma_f32_16x16x32_bf16 v[116:119], a[216:219], v[40:43], v[116:119]
    ds_read_b64_tr_b16 a[234:235], v226 offset:33792
    v_cvt_pk_bf16_f32 v171, v102, v103
    v_mfma_f32_16x16x32_bf16 v[112:115], a[204:207], v[44:47], v[112:115]
    v_exp_f32 v104, v104
    v_mfma_f32_16x16x32_bf16 v[116:119], a[220:223], v[44:47], v[116:119]
    v_exp_f32 v105, v105
    v_mfma_f32_16x16x32_bf16 v[120:123], a[192:195], v[48:51], v[156:159]
    ds_read_b64_tr_b16 a[236:237], v227 offset:32768
    ds_read_b64_tr_b16 a[238:239], v227 offset:33792
    v_mfma_f32_16x16x32_bf16 v[124:127], a[208:211], v[48:51], v[156:159]
    ds_read_b64_tr_b16 a[240:241], v228 offset:32768
    ds_read_b64_tr_b16 a[242:243], v228 offset:33792
    v_mfma_f32_16x16x32_bf16 v[120:123], a[196:199], v[52:55], v[120:123]
    ds_read_b64_tr_b16 a[244:245], v229 offset:32768
    ds_read_b64_tr_b16 a[246:247], v229 offset:33792
    v_mfma_f32_16x16x32_bf16 v[124:127], a[212:215], v[52:55], v[124:127]
    ds_read_b64_tr_b16 a[248:249], v230 offset:32768
    ds_read_b64_tr_b16 a[250:251], v230 offset:33792
    v_mfma_f32_16x16x32_bf16 v[120:123], a[200:203], v[56:59], v[120:123]
    ds_read_b64_tr_b16 a[252:253], v231 offset:32768
    ds_read_b64_tr_b16 a[254:255], v231 offset:33792
    v_mfma_f32_16x16x32_bf16 v[124:127], a[216:219], v[56:59], v[124:127]
    v_exp_f32 v106, v106
    v_mfma_f32_16x16x32_bf16 v[120:123], a[204:207], v[60:63], v[120:123]
    v_exp_f32 v107, v107
    v_mfma_f32_16x16x32_bf16 v[124:127], a[220:223], v[60:63], v[124:127]
    s_waitcnt vmcnt(24) lgkmcnt(0)
    v_cvt_pk_bf16_f32 v172, v104, v105
    v_mfma_f32_16x16x32_bf16 a[0:3], a[224:227], v[168:171], a[0:3]
    s_barrier
    v_exp_f32 v108, v108
    v_mfma_f32_16x16x32_bf16 a[4:7], a[228:231], v[168:171], a[4:7]
    s_add_u32 m0, s25, 32768
    v_exp_f32 v109, v109
    v_mfma_f32_16x16x32_bf16 a[8:11], a[232:235], v[168:171], a[8:11]
    buffer_load_dwordx4 v234, s[76:79], s29 offen offset:0 sc0 sc1 nt lds
    v_cvt_pk_bf16_f32 v173, v106, v107
    v_mfma_f32_16x16x32_bf16 a[12:15], a[236:239], v[168:171], a[12:15]
    v_exp_f32 v110, v110
    v_mfma_f32_16x16x32_bf16 a[16:19], a[240:243], v[168:171], a[16:19]
    v_exp_f32 v111, v111
    v_mfma_f32_16x16x32_bf16 a[20:23], a[244:247], v[168:171], a[20:23]
    buffer_load_dwordx4 v234, s[76:79], s29 offen offset:1024 sc0 sc1 nt lds
    v_cvt_pk_bf16_f32 v174, v108, v109
    v_mfma_f32_16x16x32_bf16 a[24:27], a[248:251], v[168:171], a[24:27]
    v_cvt_pk_bf16_f32 v175, v110, v111
    v_max3_f32 v239, v112, v113, v114
    v_mfma_f32_16x16x32_bf16 a[28:31], a[252:255], v[168:171], a[28:31]
    buffer_load_dwordx4 v235, s[76:79], s29 offen offset:2048 sc0 sc1 nt lds
    v_max3_f32 v239, v239, v115, v116
    v_mfma_f32_16x16x32_bf16 v[192:195], v[216:219], v[168:171], v[192:195]
    v_max3_f32 v239, v239, v117, v118
    v_max3_f32 v239, v239, v119, v120
    v_mfma_f32_16x16x32_bf16 a[32:35], a[224:227], v[172:175], a[32:35]
    buffer_load_dwordx4 v235, s[76:79], s29 offen offset:3072 sc0 sc1 nt lds
    v_max3_f32 v239, v239, v121, v122
    v_mfma_f32_16x16x32_bf16 a[36:39], a[228:231], v[172:175], a[36:39]
    s_add_u32 s29, s29, 8192
    v_max3_f32 v239, v239, v123, v124
    v_max3_f32 v239, v239, v125, v126
    v_mfma_f32_16x16x32_bf16 a[40:43], a[232:235], v[172:175], a[40:43]
    v_max_f32 v239, v239, v127
    v_cmp_nge_f32 vcc, s34, v239
    v_mfma_f32_16x16x32_bf16 a[44:47], a[236:239], v[172:175], a[44:47]
    s_cbranch_vccnz Ltr19
Lret19:
    v_mfma_f32_16x16x32_bf16 a[48:51], a[240:243], v[172:175], a[48:51]
    v_exp_f32 v112, v112
    v_mfma_f32_16x16x32_bf16 a[52:55], a[244:247], v[172:175], a[52:55]
    v_exp_f32 v113, v113
    v_mfma_f32_16x16x32_bf16 a[56:59], a[248:251], v[172:175], a[56:59]
    v_exp_f32 v114, v114
    v_mfma_f32_16x16x32_bf16 a[60:63], a[252:255], v[172:175], a[60:63]
    v_exp_f32 v115, v115
    v_mfma_f32_16x16x32_bf16 v[196:199], v[216:219], v[172:175], v[196:199]
    v_cvt_pk_bf16_f32 v176, v112, v113
    v_mfma_f32_16x16x32_bf16 v[128:131], a[192:195], v[64:67], v[160:163]
    v_exp_f32 v116, v116
    v_mfma_f32_16x16x32_bf16 v[132:135], a[208:211], v[64:67], v[160:163]
    v_exp_f32 v117, v117
    v_mfma_f32_16x16x32_bf16 v[128:131], a[196:199], v[68:71], v[128:131]
    v_cvt_pk_bf16_f32 v177, v114, v115
    v_mfma_f32_16x16x32_bf16 v[132:135], a[212:215], v[68:71], v[132:135]
    v_exp_f32 v118, v118
    v_mfma_f32_16x16x32_bf16 v[128:131], a[200:203], v[72:75], v[128:131]
    v_exp_f32 v119, v119
    v_mfma_f32_16x16x32_bf16 v[132:135], a[216:219], v[72:75], v[132:135]
    v_cvt_pk_bf16_f32 v178, v116, v117
    v_cvt_pk_bf16_f32 v179, v118, v119
    v_mfma_f32_16x16x32_bf16 v[128:131], a[204:207], v[76:79], v[128:131]
    v_exp_f32 v120, v120
    v_mfma_f32_16x16x32_bf16 v[132:135], a[220:223], v[76:79], v[132:135]
    v_exp_f32 v121, v121
    v_mfma_f32_16x16x32_bf16 v[136:139], a[192:195], v[80:83], v[164:167]
    v_exp_f32 v122, v122
    v_mfma_f32_16x16x32_bf16 v[140:143], a[208:211], v[80:83], v[164:167]
    v_exp_f32 v123, v123
    v_mfma_f32_16x16x32_bf16 v[136:139], a[196:199], v[84:87], v[136:139]
    ds_read_b128 a[192:195], v220 offset:0
    v_cvt_pk_bf16_f32 v180, v120, v121
    v_mfma_f32_16x16x32_bf16 v[140:143], a[212:215], v[84:87], v[140:143]
    v_exp_f32 v124, v124
    v_mfma_f32_16x16x32_bf16 v[136:139], a[200:203], v[88:91], v[136:139]
    v_exp_f32 v125, v125
    v_mfma_f32_16x16x32_bf16 v[140:143], a[216:219], v[88:91], v[140:143]
    ds_read_b128 a[208:211], v220 offset:1024
    v_cvt_pk_bf16_f32 v181, v122, v123
    v_mfma_f32_16x16x32_bf16 v[136:139], a[204:207], v[92:95], v[136:139]
    v_exp_f32 v126, v126
    v_mfma_f32_16x16x32_bf16 v[140:143], a[220:223], v[92:95], v[140:143]
    v_exp_f32 v127, v127
    v_mfma_f32_16x16x32_bf16 a[64:67], a[224:227], v[176:179], a[64:67]
    ds_read_b128 a[196:199], v221 offset:0
    v_cvt_pk_bf16_f32 v182, v124, v125
    v_mfma_f32_16x16x32_bf16 a[68:71], a[228:231], v[176:179], a[68:71]
    ds_read_b128 a[212:215], v221 offset:1024
    v_cvt_pk_bf16_f32 v183, v126, v127
    v_mfma_f32_16x16x32_bf16 a[72:75], a[232:235], v[176:179], a[72:75]
    ds_read_b128 a[200:203], v222 offset:0
    v_mfma_f32_16x16x32_bf16 a[76:79], a[236:239], v[176:179], a[76:79]
    ds_read_b128 a[216:219], v222 offset:1024
    v_max3_f32 v238, v128, v129, v130
    v_mfma_f32_16x16x32_bf16 a[80:83], a[240:243], v[176:179], a[80:83]
    ds_read_b128 a[204:207], v223 offset:0
    v_max3_f32 v238, v238, v131, v132
    v_mfma_f32_16x16x32_bf16 a[84:87], a[244:247], v[176:179], a[84:87]
    ds_read_b128 a[220:223], v223 offset:1024
    v_max3_f32 v238, v238, v133, v134
    v_mfma_f32_16x16x32_bf16 a[88:91], a[248:251], v[176:179], a[88:91]
    v_max3_f32 v238, v238, v135, v136
    v_max3_f32 v238, v238, v137, v138
    v_mfma_f32_16x16x32_bf16 a[92:95], a[252:255], v[176:179], a[92:95]
    v_max3_f32 v238, v238, v139, v140
    v_max3_f32 v238, v238, v141, v142
    v_mfma_f32_16x16x32_bf16 v[200:203], v[216:219], v[176:179], v[200:203]
    v_max_f32 v238, v238, v143
    v_cmp_nge_f32 vcc, s34, v238
    v_mfma_f32_16x16x32_bf16 a[96:99], a[224:227], v[180:183], a[96:99]
    s_cbranch_vccnz Ltr20
Lret20:
    v_mfma_f32_16x16x32_bf16 a[100:103], a[228:231], v[180:183], a[100:103]
    v_exp_f32 v128, v128
    v_mfma_f32_16x16x32_bf16 a[104:107], a[232:235], v[180:183], a[104:107]
    v_exp_f32 v129, v129
    v_mfma_f32_16x16x32_bf16 a[108:111], a[236:239], v[180:183], a[108:111]
    v_exp_f32 v130, v130
    v_mfma_f32_16x16x32_bf16 a[112:115], a[240:243], v[180:183], a[112:115]
    v_exp_f32 v131, v131
    v_mfma_f32_16x16x32_bf16 a[116:119], a[244:247], v[180:183], a[116:119]
    v_cvt_pk_bf16_f32 v184, v128, v129
    v_mfma_f32_16x16x32_bf16 a[120:123], a[248:251], v[180:183], a[120:123]
    v_exp_f32 v132, v132
    v_mfma_f32_16x16x32_bf16 a[124:127], a[252:255], v[180:183], a[124:127]
    v_exp_f32 v133, v133
    v_mfma_f32_16x16x32_bf16 v[204:207], v[216:219], v[180:183], v[204:207]
    s_waitcnt lgkmcnt(0)
    v_cvt_pk_bf16_f32 v185, v130, v131
    v_mfma_f32_16x16x32_bf16 v[96:99], a[192:195], v[0:3], v[144:147]
    v_exp_f32 v134, v134
    v_mfma_f32_16x16x32_bf16 v[100:103], a[208:211], v[0:3], v[144:147]
    v_exp_f32 v135, v135
    v_mfma_f32_16x16x32_bf16 v[96:99], a[196:199], v[4:7], v[96:99]
    v_cvt_pk_bf16_f32 v186, v132, v133
    v_cvt_pk_bf16_f32 v187, v134, v135
    v_mfma_f32_16x16x32_bf16 v[100:103], a[212:215], v[4:7], v[100:103]
    v_exp_f32 v136, v136
    v_mfma_f32_16x16x32_bf16 v[96:99], a[200:203], v[8:11], v[96:99]
    v_exp_f32 v137, v137
    v_mfma_f32_16x16x32_bf16 v[100:103], a[216:219], v[8:11], v[100:103]
    v_exp_f32 v138, v138
    v_mfma_f32_16x16x32_bf16 v[96:99], a[204:207], v[12:15], v[96:99]
    v_exp_f32 v139, v139
    v_mfma_f32_16x16x32_bf16 v[100:103], a[220:223], v[12:15], v[100:103]
    v_cvt_pk_bf16_f32 v188, v136, v137
    v_mfma_f32_16x16x32_bf16 v[104:107], a[192:195], v[16:19], v[148:151]
    v_exp_f32 v140, v140
    v_mfma_f32_16x16x32_bf16 v[108:111], a[208:211], v[16:19], v[148:151]
    v_exp_f32 v141, v141
    v_mfma_f32_16x16x32_bf16 v[104:107], a[196:199], v[20:23], v[104:107]
    v_cvt_pk_bf16_f32 v189, v138, v139
    v_mfma_f32_16x16x32_bf16 v[108:111], a[212:215], v[20:23], v[108:111]
    v_exp_f32 v142, v142
    v_mfma_f32_16x16x32_bf16 v[104:107], a[200:203], v[24:27], v[104:107]
    v_exp_f32 v143, v143
    v_mfma_f32_16x16x32_bf16 v[108:111], a[216:219], v[24:27], v[108:111]
    s_sub_u32 s30, s30, 1
    s_cmp_lg_u32 s30, 0
    v_cvt_pk_bf16_f32 v190, v140, v141
    v_cvt_pk_bf16_f32 v191, v142, v143
    v_mfma_f32_16x16x32_bf16 v[104:107], a[204:207], v[28:31], v[104:107]
    v_mfma_f32_16x16x32_bf16 v[108:111], a[220:223], v[28:31], v[108:111]
    s_cbranch_scc1 Lloop
Lepi:
    v_mfma_f32_16x16x32_bf16 a[128:131], a[224:227], v[184:187], a[128:131]
    v_mfma_f32_16x16x32_bf16 a[132:135], a[228:231], v[184:187], a[132:135]
    v_mfma_f32_16x16x32_bf16 a[136:139], a[232:235], v[184:187], a[136:139]
    v_mfma_f32_16x16x32_bf16 a[140:143], a[236:239], v[184:187], a[140:143]
    v_mfma_f32_16x16x32_bf16 a[144:147], a[240:243], v[184:187], a[144:147]
    v_mfma_f32_16x16x32_bf16 a[148:151], a[244:247], v[184:187], a[148:151]
    v_mfma_f32_16x16x32_bf16 a[152:155], a[248:251], v[184:187], a[152:155]
    v_mfma_f32_16x16x32_bf16 a[156:159], a[252:255], v[184:187], a[156:159]
    v_mfma_f32_16x16x32_bf16 v[208:211], v[216:219], v[184:187], v[208:211]
    v_mfma_f32_16x16x32_bf16 a[160:163], a[224:227], v[188:191], a[160:163]
    v_mfma_f32_16x16x32_bf16 a[164:167], a[228:231], v[188:191], a[164:167]
    v_mfma_f32_16x16x32_bf16 a[168:171], a[232:235], v[188:191], a[168:171]
    v_mfma_f32_16x16x32_bf16 a[172:175], a[236:239], v[188:191], a[172:175]
    v_mfma_f32_16x16x32_bf16 a[176:179], a[240:243], v[188:191], a[176:179]
    v_mfma_f32_16x16x32_bf16 a[180:183], a[244:247], v[188:191], a[180:183]
    v_mfma_f32_16x16x32_bf16 a[184:187], a[248:251], v[188:191], a[184:187]
    v_mfma_f32_16x16x32_bf16 a[188:191], a[252:255], v[188:191], a[188:191]
    v_mfma_f32_16x16x32_bf16 v[212:215], v[216:219], v[188:191], v[212:215]
    s_nop 7
    v_rcp_f32 v192, v192
    v_rcp_f32 v193, v193
    v_rcp_f32 v196, v196
    v_rcp_f32 v197, v197
    v_rcp_f32 v200, v200
    v_rcp_f32 v201, v201
    v_rcp_f32 v204, v204
    v_rcp_f32 v205, v205
    v_rcp_f32 v208, v208
    v_rcp_f32 v209, v209
    v_rcp_f32 v212, v212
    v_rcp_f32 v213, v213
    s_nop 1
    v_accvgpr_read_b32 v96, a0
    v_accvgpr_read_b32 v97, a1
    v_accvgpr_read_b32 v98, a2
    v_accvgpr_read_b32 v99, a3
    v_accvgpr_read_b32 v100, a4
    v_accvgpr_read_b32 v101, a5
    v_accvgpr_read_b32 v102, a6
    v_accvgpr_read_b32 v103, a7
    v_pk_mul_f32 v[96:97], v[96:97], v[192:193]
    v_pk_mul_f32 v[98:99], v[98:99], v[192:193]
    v_pk_mul_f32 v[100:101], v[100:101], v[192:193]
    v_pk_mul_f32 v[102:103], v[102:103], v[192:193]
    v_cvt_pk_bf16_f32 v0, v96, v97
    v_cvt_pk_bf16_f32 v1, v98, v99
    v_cvt_pk_bf16_f32 v2, v100, v101
    v_cvt_pk_bf16_f32 v3, v102, v103
    v_accvgpr_read_b32 v104, a8
    v_accvgpr_read_b32 v105, a9
    v_accvgpr_read_b32 v106, a10
    v_accvgpr_read_b32 v107, a11
    v_accvgpr_read_b32 v108, a12
    v_accvgpr_read_b32 v109, a13
    v_accvgpr_read_b32 v110, a14
    v_accvgpr_read_b32 v111, a15
    v_pk_mul_f32 v[104:105], v[104:105], v[192:193]
    v_pk_mul_f32 v[106:107], v[106:107], v[192:193]
    v_pk_mul_f32 v[108:109], v[108:109], v[192:193]
    v_pk_mul_f32 v[110:111], v[110:111], v[192:193]
    v_cvt_pk_bf16_f32 v4, v104, v105
    v_cvt_pk_bf16_f32 v5, v106, v107
    v_cvt_pk_bf16_f32 v6, v108, v109
    v_cvt_pk_bf16_f32 v7, v110, v111
    v_accvgpr_read_b32 v112, a16
    v_accvgpr_read_b32 v113, a17
    v_accvgpr_read_b32 v114, a18
    v_accvgpr_read_b32 v115, a19
    v_accvgpr_read_b32 v116, a20
    v_accvgpr_read_b32 v117, a21
    v_accvgpr_read_b32 v118, a22
    v_accvgpr_read_b32 v119, a23
    v_pk_mul_f32 v[112:113], v[112:113], v[192:193]
    v_pk_mul_f32 v[114:115], v[114:115], v[192:193]
    v_pk_mul_f32 v[116:117], v[116:117], v[192:193]
    v_pk_mul_f32 v[118:119], v[118:119], v[192:193]
    v_cvt_pk_bf16_f32 v8, v112, v113
    v_cvt_pk_bf16_f32 v9, v114, v115
    v_cvt_pk_bf16_f32 v10, v116, v117
    v_cvt_pk_bf16_f32 v11, v118, v119
    v_accvgpr_read_b32 v120, a24
    v_accvgpr_read_b32 v121, a25
    v_accvgpr_read_b32 v122, a26
    v_accvgpr_read_b32 v123, a27
    v_accvgpr_read_b32 v124, a28
    v_accvgpr_read_b32 v125, a29
    v_accvgpr_read_b32 v126, a30
    v_accvgpr_read_b32 v127, a31
    v_pk_mul_f32 v[120:121], v[120:121], v[192:193]
    v_pk_mul_f32 v[122:123], v[122:123], v[192:193]
    v_pk_mul_f32 v[124:125], v[124:125], v[192:193]
    v_pk_mul_f32 v[126:127], v[126:127], v[192:193]
    v_cvt_pk_bf16_f32 v12, v120, v121
    v_cvt_pk_bf16_f32 v13, v122, v123
    v_cvt_pk_bf16_f32 v14, v124, v125
    v_cvt_pk_bf16_f32 v15, v126, v127
    v_accvgpr_read_b32 v96, a32
    v_accvgpr_read_b32 v97, a33
    v_accvgpr_read_b32 v98, a34
    v_accvgpr_read_b32 v99, a35
    v_accvgpr_read_b32 v100, a36
    v_accvgpr_read_b32 v101, a37
    v_accvgpr_read_b32 v102, a38
    v_accvgpr_read_b32 v103, a39
    v_pk_mul_f32 v[96:97], v[96:97], v[196:197]
    v_pk_mul_f32 v[98:99], v[98:99], v[196:197]
    v_pk_mul_f32 v[100:101], v[100:101], v[196:197]
    v_pk_mul_f32 v[102:103], v[102:103], v[196:197]
    v_cvt_pk_bf16_f32 v16, v96, v97
    v_cvt_pk_bf16_f32 v17, v98, v99
    v_cvt_pk_bf16_f32 v18, v100, v101
    v_cvt_pk_bf16_f32 v19, v102, v103
    v_accvgpr_read_b32 v104, a40
    v_accvgpr_read_b32 v105, a41
    v_accvgpr_read_b32 v106, a42
    v_accvgpr_read_b32 v107, a43
    v_accvgpr_read_b32 v108, a44
    v_accvgpr_read_b32 v109, a45
    v_accvgpr_read_b32 v110, a46
    v_accvgpr_read_b32 v111, a47
    v_pk_mul_f32 v[104:105], v[104:105], v[196:197]
    v_pk_mul_f32 v[106:107], v[106:107], v[196:197]
    v_pk_mul_f32 v[108:109], v[108:109], v[196:197]
    v_pk_mul_f32 v[110:111], v[110:111], v[196:197]
    v_cvt_pk_bf16_f32 v20, v104, v105
    v_cvt_pk_bf16_f32 v21, v106, v107
    v_cvt_pk_bf16_f32 v22, v108, v109
    v_cvt_pk_bf16_f32 v23, v110, v111
    v_accvgpr_read_b32 v112, a48
    v_accvgpr_read_b32 v113, a49
    v_accvgpr_read_b32 v114, a50
    v_accvgpr_read_b32 v115, a51
    v_accvgpr_read_b32 v116, a52
    v_accvgpr_read_b32 v117, a53
    v_accvgpr_read_b32 v118, a54
    v_accvgpr_read_b32 v119, a55
    v_pk_mul_f32 v[112:113], v[112:113], v[196:197]
    v_pk_mul_f32 v[114:115], v[114:115], v[196:197]
    v_pk_mul_f32 v[116:117], v[116:117], v[196:197]
    v_pk_mul_f32 v[118:119], v[118:119], v[196:197]
    v_cvt_pk_bf16_f32 v24, v112, v113
    v_cvt_pk_bf16_f32 v25, v114, v115
    v_cvt_pk_bf16_f32 v26, v116, v117
    v_cvt_pk_bf16_f32 v27, v118, v119
    v_accvgpr_read_b32 v120, a56
    v_accvgpr_read_b32 v121, a57
    v_accvgpr_read_b32 v122, a58
    v_accvgpr_read_b32 v123, a59
    v_accvgpr_read_b32 v124, a60
    v_accvgpr_read_b32 v125, a61
    v_accvgpr_read_b32 v126, a62
    v_accvgpr_read_b32 v127, a63
    v_pk_mul_f32 v[120:121], v[120:121], v[196:197]
    v_pk_mul_f32 v[122:123], v[122:123], v[196:197]
    v_pk_mul_f32 v[124:125], v[124:125], v[196:197]
    v_pk_mul_f32 v[126:127], v[126:127], v[196:197]
    v_cvt_pk_bf16_f32 v28, v120, v121
    v_cvt_pk_bf16_f32 v29, v122, v123
    v_cvt_pk_bf16_f32 v30, v124, v125
    v_cvt_pk_bf16_f32 v31, v126, v127
    v_accvgpr_read_b32 v96, a64
    v_accvgpr_read_b32 v97, a65
    v_accvgpr_read_b32 v98, a66
    v_accvgpr_read_b32 v99, a67
    v_accvgpr_read_b32 v100, a68
    v_accvgpr_read_b32 v101, a69
    v_accvgpr_read_b32 v102, a70
    v_accvgpr_read_b32 v103, a71
    v_pk_mul_f32 v[96:97], v[96:97], v[200:201]
    v_pk_mul_f32 v[98:99], v[98:99], v[200:201]
    v_pk_mul_f32 v[100:101], v[100:101], v[200:201]
    v_pk_mul_f32 v[102:103], v[102:103], v[200:201]
    v_cvt_pk_bf16_f32 v32, v96, v97
    v_cvt_pk_bf16_f32 v33, v98, v99
    v_cvt_pk_bf16_f32 v34, v100, v101
    v_cvt_pk_bf16_f32 v35, v102, v103
    v_accvgpr_read_b32 v104, a72
    v_accvgpr_read_b32 v105, a73
    v_accvgpr_read_b32 v106, a74
    v_accvgpr_read_b32 v107, a75
    v_accvgpr_read_b32 v108, a76
    v_accvgpr_read_b32 v109, a77
    v_accvgpr_read_b32 v110, a78
    v_accvgpr_read_b32 v111, a79
    v_pk_mul_f32 v[104:105], v[104:105], v[200:201]
    v_pk_mul_f32 v[106:107], v[106:107], v[200:201]
    v_pk_mul_f32 v[108:109], v[108:109], v[200:201]
    v_pk_mul_f32 v[110:111], v[110:111], v[200:201]
    v_cvt_pk_bf16_f32 v36, v104, v105
    v_cvt_pk_bf16_f32 v37, v106, v107
    v_cvt_pk_bf16_f32 v38, v108, v109
    v_cvt_pk_bf16_f32 v39, v110, v111
    v_accvgpr_read_b32 v112, a80
    v_accvgpr_read_b32 v113, a81
    v_accvgpr_read_b32 v114, a82
    v_accvgpr_read_b32 v115, a83
    v_accvgpr_read_b32 v116, a84
    v_accvgpr_read_b32 v117, a85
    v_accvgpr_read_b32 v118, a86
    v_accvgpr_read_b32 v119, a87
    v_pk_mul_f32 v[112:113], v[112:113], v[200:201]
    v_pk_mul_f32 v[114:115], v[114:115], v[200:201]
    v_pk_mul_f32 v[116:117], v[116:117], v[200:201]
    v_pk_mul_f32 v[118:119], v[118:119], v[200:201]
    v_cvt_pk_bf16_f32 v40, v112, v113
    v_cvt_pk_bf16_f32 v41, v114, v115
    v_cvt_pk_bf16_f32 v42, v116, v117
    v_cvt_pk_bf16_f32 v43, v118, v119
    v_accvgpr_read_b32 v120, a88
    v_accvgpr_read_b32 v121, a89
    v_accvgpr_read_b32 v122, a90
    v_accvgpr_read_b32 v123, a91
    v_accvgpr_read_b32 v124, a92
    v_accvgpr_read_b32 v125, a93
    v_accvgpr_read_b32 v126, a94
    v_accvgpr_read_b32 v127, a95
    v_pk_mul_f32 v[120:121], v[120:121], v[200:201]
    v_pk_mul_f32 v[122:123], v[122:123], v[200:201]
    v_pk_mul_f32 v[124:125], v[124:125], v[200:201]
    v_pk_mul_f32 v[126:127], v[126:127], v[200:201]
    v_cvt_pk_bf16_f32 v44, v120, v121
    v_cvt_pk_bf16_f32 v45, v122, v123
    v_cvt_pk_bf16_f32 v46, v124, v125
    v_cvt_pk_bf16_f32 v47, v126, v127
    v_accvgpr_read_b32 v96, a96
    v_accvgpr_read_b32 v97, a97
    v_accvgpr_read_b32 v98, a98
    v_accvgpr_read_b32 v99, a99
    v_accvgpr_read_b32 v100, a100
    v_accvgpr_read_b32 v101, a101
    v_accvgpr_read_b32 v102, a102
    v_accvgpr_read_b32 v103, a103
    v_pk_mul_f32 v[96:97], v[96:97], v[204:205]
    v_pk_mul_f32 v[98:99], v[98:99], v[204:205]
    v_pk_mul_f32 v[100:101], v[100:101], v[204:205]
    v_pk_mul_f32 v[102:103], v[102:103], v[204:205]
    v_cvt_pk_bf16_f32 v48, v96, v97
    v_cvt_pk_bf16_f32 v49, v98, v99
    v_cvt_pk_bf16_f32 v50, v100, v101
    v_cvt_pk_bf16_f32 v51, v102, v103
    v_accvgpr_read_b32 v104, a104
    v_accvgpr_read_b32 v105, a105
    v_accvgpr_read_b32 v106, a106
    v_accvgpr_read_b32 v107, a107
    v_accvgpr_read_b32 v108, a108
    v_accvgpr_read_b32 v109, a109
    v_accvgpr_read_b32 v110, a110
    v_accvgpr_read_b32 v111, a111
    v_pk_mul_f32 v[104:105], v[104:105], v[204:205]
    v_pk_mul_f32 v[106:107], v[106:107], v[204:205]
    v_pk_mul_f32 v[108:109], v[108:109], v[204:205]
    v_pk_mul_f32 v[110:111], v[110:111], v[204:205]
    v_cvt_pk_bf16_f32 v52, v104, v105
    v_cvt_pk_bf16_f32 v53, v106, v107
    v_cvt_pk_bf16_f32 v54, v108, v109
    v_cvt_pk_bf16_f32 v55, v110, v111
    v_accvgpr_read_b32 v112, a112
    v_accvgpr_read_b32 v113, a113
    v_accvgpr_read_b32 v114, a114
    v_accvgpr_read_b32 v115, a115
    v_accvgpr_read_b32 v116, a116
    v_accvgpr_read_b32 v117, a117
    v_accvgpr_read_b32 v118, a118
    v_accvgpr_read_b32 v119, a119
    v_pk_mul_f32 v[112:113], v[112:113], v[204:205]
    v_pk_mul_f32 v[114:115], v[114:115], v[204:205]
    v_pk_mul_f32 v[116:117], v[116:117], v[204:205]
    v_pk_mul_f32 v[118:119], v[118:119], v[204:205]
    v_cvt_pk_bf16_f32 v56, v112, v113
    v_cvt_pk_bf16_f32 v57, v114, v115
    v_cvt_pk_bf16_f32 v58, v116, v117
    v_cvt_pk_bf16_f32 v59, v118, v119
    v_accvgpr_read_b32 v120, a120
    v_accvgpr_read_b32 v121, a121
    v_accvgpr_read_b32 v122, a122
    v_accvgpr_read_b32 v123, a123
    v_accvgpr_read_b32 v124, a124
    v_accvgpr_read_b32 v125, a125
    v_accvgpr_read_b32 v126, a126
    v_accvgpr_read_b32 v127, a127
    v_pk_mul_f32 v[120:121], v[120:121], v[204:205]
    v_pk_mul_f32 v[122:123], v[122:123], v[204:205]
    v_pk_mul_f32 v[124:125], v[124:125], v[204:205]
    v_pk_mul_f32 v[126:127], v[126:127], v[204:205]
    v_cvt_pk_bf16_f32 v60, v120, v121
    v_cvt_pk_bf16_f32 v61, v122, v123
    v_cvt_pk_bf16_f32 v62, v124, v125
    v_cvt_pk_bf16_f32 v63, v126, v127
    v_accvgpr_read_b32 v96, a128
    v_accvgpr_read_b32 v97, a129
    v_accvgpr_read_b32 v98, a130
    v_accvgpr_read_b32 v99, a131
    v_accvgpr_read_b32 v100, a132
    v_accvgpr_read_b32 v101, a133
    v_accvgpr_read_b32 v102, a134
    v_accvgpr_read_b32 v103, a135
    v_pk_mul_f32 v[96:97], v[96:97], v[208:209]
    v_pk_mul_f32 v[98:99], v[98:99], v[208:209]
    v_pk_mul_f32 v[100:101], v[100:101], v[208:209]
    v_pk_mul_f32 v[102:103], v[102:103], v[208:209]
    v_cvt_pk_bf16_f32 v64, v96, v97
    v_cvt_pk_bf16_f32 v65, v98, v99
    v_cvt_pk_bf16_f32 v66, v100, v101
    v_cvt_pk_bf16_f32 v67, v102, v103
    v_accvgpr_read_b32 v104, a136
    v_accvgpr_read_b32 v105, a137
    v_accvgpr_read_b32 v106, a138
    v_accvgpr_read_b32 v107, a139
    v_accvgpr_read_b32 v108, a140
    v_accvgpr_read_b32 v109, a141
    v_accvgpr_read_b32 v110, a142
    v_accvgpr_read_b32 v111, a143
    v_pk_mul_f32 v[104:105], v[104:105], v[208:209]
    v_pk_mul_f32 v[106:107], v[106:107], v[208:209]
    v_pk_mul_f32 v[108:109], v[108:109], v[208:209]
    v_pk_mul_f32 v[110:111], v[110:111], v[208:209]
    v_cvt_pk_bf16_f32 v68, v104, v105
    v_cvt_pk_bf16_f32 v69, v106, v107
    v_cvt_pk_bf16_f32 v70, v108, v109
    v_cvt_pk_bf16_f32 v71, v110, v111
    v_accvgpr_read_b32 v112, a144
    v_accvgpr_read_b32 v113, a145
    v_accvgpr_read_b32 v114, a146
    v_accvgpr_read_b32 v115, a147
    v_accvgpr_read_b32 v116, a148
    v_accvgpr_read_b32 v117, a149
    v_accvgpr_read_b32 v118, a150
    v_accvgpr_read_b32 v119, a151
    v_pk_mul_f32 v[112:113], v[112:113], v[208:209]
    v_pk_mul_f32 v[114:115], v[114:115], v[208:209]
    v_pk_mul_f32 v[116:117], v[116:117], v[208:209]
    v_pk_mul_f32 v[118:119], v[118:119], v[208:209]
    v_cvt_pk_bf16_f32 v72, v112, v113
    v_cvt_pk_bf16_f32 v73, v114, v115
    v_cvt_pk_bf16_f32 v74, v116, v117
    v_cvt_pk_bf16_f32 v75, v118, v119
    v_accvgpr_read_b32 v120, a152
    v_accvgpr_read_b32 v121, a153
    v_accvgpr_read_b32 v122, a154
    v_accvgpr_read_b32 v123, a155
    v_accvgpr_read_b32 v124, a156
    v_accvgpr_read_b32 v125, a157
    v_accvgpr_read_b32 v126, a158
    v_accvgpr_read_b32 v127, a159
    v_pk_mul_f32 v[120:121], v[120:121], v[208:209]
    v_pk_mul_f32 v[122:123], v[122:123], v[208:209]
    v_pk_mul_f32 v[124:125], v[124:125], v[208:209]
    v_pk_mul_f32 v[126:127], v[126:127], v[208:209]
    v_cvt_pk_bf16_f32 v76, v120, v121
    v_cvt_pk_bf16_f32 v77, v122, v123
    v_cvt_pk_bf16_f32 v78, v124, v125
    v_cvt_pk_bf16_f32 v79, v126, v127
    v_accvgpr_read_b32 v96, a160
    v_accvgpr_read_b32 v97, a161
    v_accvgpr_read_b32 v98, a162
    v_accvgpr_read_b32 v99, a163
    v_accvgpr_read_b32 v100, a164
    v_accvgpr_read_b32 v101, a165
    v_accvgpr_read_b32 v102, a166
    v_accvgpr_read_b32 v103, a167
    v_pk_mul_f32 v[96:97], v[96:97], v[212:213]
    v_pk_mul_f32 v[98:99], v[98:99], v[212:213]
    v_pk_mul_f32 v[100:101], v[100:101], v[212:213]
    v_pk_mul_f32 v[102:103], v[102:103], v[212:213]
    v_cvt_pk_bf16_f32 v80, v96, v97
    v_cvt_pk_bf16_f32 v81, v98, v99
    v_cvt_pk_bf16_f32 v82, v100, v101
    v_cvt_pk_bf16_f32 v83, v102, v103
    v_accvgpr_read_b32 v104, a168
    v_accvgpr_read_b32 v105, a169
    v_accvgpr_read_b32 v106, a170
    v_accvgpr_read_b32 v107, a171
    v_accvgpr_read_b32 v108, a172
    v_accvgpr_read_b32 v109, a173
    v_accvgpr_read_b32 v110, a174
    v_accvgpr_read_b32 v111, a175
    v_pk_mul_f32 v[104:105], v[104:105], v[212:213]
    v_pk_mul_f32 v[106:107], v[106:107], v[212:213]
    v_pk_mul_f32 v[108:109], v[108:109], v[212:213]
    v_pk_mul_f32 v[110:111], v[110:111], v[212:213]
    v_cvt_pk_bf16_f32 v84, v104, v105
    v_cvt_pk_bf16_f32 v85, v106, v107
    v_cvt_pk_bf16_f32 v86, v108, v109
    v_cvt_pk_bf16_f32 v87, v110, v111
    v_accvgpr_read_b32 v112, a176
    v_accvgpr_read_b32 v113, a177
    v_accvgpr_read_b32 v114, a178
    v_accvgpr_read_b32 v115, a179
    v_accvgpr_read_b32 v116, a180
    v_accvgpr_read_b32 v117, a181
    v_accvgpr_read_b32 v118, a182
    v_accvgpr_read_b32 v119, a183
    v_pk_mul_f32 v[112:113], v[112:113], v[212:213]
    v_pk_mul_f32 v[114:115], v[114:115], v[212:213]
    v_pk_mul_f32 v[116:117], v[116:117], v[212:213]
    v_pk_mul_f32 v[118:119], v[118:119], v[212:213]
    v_cvt_pk_bf16_f32 v88, v112, v113
    v_cvt_pk_bf16_f32 v89, v114, v115
    v_cvt_pk_bf16_f32 v90, v116, v117
    v_cvt_pk_bf16_f32 v91, v118, v119
    v_accvgpr_read_b32 v120, a184
    v_accvgpr_read_b32 v121, a185
    v_accvgpr_read_b32 v122, a186
    v_accvgpr_read_b32 v123, a187
    v_accvgpr_read_b32 v124, a188
    v_accvgpr_read_b32 v125, a189
    v_accvgpr_read_b32 v126, a190
    v_accvgpr_read_b32 v127, a191
    v_pk_mul_f32 v[120:121], v[120:121], v[212:213]
    v_pk_mul_f32 v[122:123], v[122:123], v[212:213]
    v_pk_mul_f32 v[124:125], v[124:125], v[212:213]
    v_pk_mul_f32 v[126:127], v[126:127], v[212:213]
    v_cvt_pk_bf16_f32 v92, v120, v121
    v_cvt_pk_bf16_f32 v93, v122, v123
    v_cvt_pk_bf16_f32 v94, v124, v125
    v_cvt_pk_bf16_f32 v95, v126, v127
    v_mov_b32 v192, v237
    v_add_u32 v193, 7168, v237
    v_add_u32 v194, 14336, v237
    v_add_u32 v195, 21504, v237
    s_mul_i32 s23, s22, 24576
    s_mul_i32 s31, s21, 98304
    s_add_u32 s31, s31, s23
    v_add_u32 v196, s31, v236
    v_add_u32 v197, s23, v236
    v_add_u32 v198, 98304, v197
    s_waitcnt vmcnt(0)
    s_barrier
    ds_write_b128 v196, v[0:3] offset:0
    ds_write_b128 v196, v[4:7] offset:1024
    ds_write_b128 v196, v[8:11] offset:2048
    ds_write_b128 v196, v[12:15] offset:3072
    ds_write_b128 v196, v[16:19] offset:4096
    ds_write_b128 v196, v[20:23] offset:5120
    ds_write_b128 v196, v[24:27] offset:6144
    ds_write_b128 v196, v[28:31] offset:7168
    ds_write_b128 v196, v[32:35] offset:8192
    ds_write_b128 v196, v[36:39] offset:9216
    ds_write_b128 v196, v[40:43] offset:10240
    ds_write_b128 v196, v[44:47] offset:11264
    ds_write_b128 v196, v[48:51] offset:12288
    ds_write_b128 v196, v[52:55] offset:13312
    ds_write_b128 v196, v[56:59] offset:14336
    ds_write_b128 v196, v[60:63] offset:15360
    ds_write_b128 v196, v[64:67] offset:16384
    ds_write_b128 v196, v[68:71] offset:17408
    ds_write_b128 v196, v[72:75] offset:18432
    ds_write_b128 v196, v[76:79] offset:19456
    ds_write_b128 v196, v[80:83] offset:20480
    ds_write_b128 v196, v[84:87] offset:21504
    ds_write_b128 v196, v[88:91] offset:22528
    ds_write_b128 v196, v[92:95] offset:23552
    s_waitcnt lgkmcnt(0)
    s_barrier
    ds_read_b128 a[0:3], v197 offset:0
    ds_read_b128 a[4:7], v197 offset:1024
    ds_read_b128 a[8:11], v197 offset:2048
    ds_read_b128 a[12:15], v197 offset:3072
    ds_read_b128 a[16:19], v197 offset:4096
    ds_read_b128 a[20:23], v197 offset:5120
    ds_read_b128 a[24:27], v197 offset:6144
    ds_read_b128 a[28:31], v197 offset:7168
    ds_read_b128 a[32:35], v197 offset:8192
    ds_read_b128 a[36:39], v197 offset:9216
    ds_read_b128 a[40:43], v197 offset:10240
    ds_read_b128 a[44:47], v197 offset:11264
    ds_read_b128 a[48:51], v197 offset:12288
    ds_read_b128 a[52:55], v197 offset:13312
    ds_read_b128 a[56:59], v197 offset:14336
    ds_read_b128 a[60:63], v197 offset:15360
    ds_read_b128 a[64:67], v197 offset:16384
    ds_read_b128 a[68:71], v197 offset:17408
    ds_read_b128 a[72:75], v197 offset:18432
    ds_read_b128 a[76:79], v197 offset:19456
    ds_read_b128 a[80:83], v197 offset:20480
    ds_read_b128 a[84:87], v197 offset:21504
    ds_read_b128 a[88:91], v197 offset:22528
    ds_read_b128 a[92:95], v197 offset:23552
    ds_read_b128 a[96:99], v198 offset:0
    ds_read_b128 a[100:103], v198 offset:1024
    ds_read_b128 a[104:107], v198 offset:2048
    ds_read_b128 a[108:111], v198 offset:3072
    ds_read_b128 a[112:115], v198 offset:4096
    ds_read_b128 a[116:119], v198 offset:5120
    ds_read_b128 a[120:123], v198 offset:6144
    ds_read_b128 a[124:127], v198 offset:7168
    ds_read_b128 a[128:131], v198 offset:8192
    ds_read_b128 a[132:135], v198 offset:9216
    ds_read_b128 a[136:139], v198 offset:10240
    ds_read_b128 a[140:143], v198 offset:11264
    ds_read_b128 a[144:147], v198 offset:12288
    ds_read_b128 a[148:151], v198 offset:13312
    ds_read_b128 a[152:155], v198 offset:14336
    ds_read_b128 a[156:159], v198 offset:15360
    ds_read_b128 a[160:163], v198 offset:16384
    ds_read_b128 a[164:167], v198 offset:17408
    ds_read_b128 a[168:171], v198 offset:18432
    ds_read_b128 a[172:175], v198 offset:19456
    ds_read_b128 a[176:179], v198 offset:20480
    ds_read_b128 a[180:183], v198 offset:21504
    ds_read_b128 a[184:187], v198 offset:22528
    ds_read_b128 a[188:191], v198 offset:23552
    v_xor_b32 v200, 0, v251
    v_lshl_add_u32 v200, v200, 5, v250
    v_add_u32 v200, 65536, v200
    v_xor_b32 v201, 1, v251
    v_lshl_add_u32 v201, v201, 5, v250
    v_add_u32 v201, 65536, v201
    v_xor_b32 v202, 2, v251
    v_lshl_add_u32 v202, v202, 5, v250
    v_add_u32 v202, 65536, v202
    v_xor_b32 v203, 3, v251
    v_lshl_add_u32 v203, v203, 5, v250
    v_add_u32 v203, 65536, v203
    ds_read_b64_tr_b16 a[192:193], v200 offset:0
    ds_read_b64_tr_b16 a[194:195], v200 offset:2048
    ds_read_b64_tr_b16 a[196:197], v201 offset:0
    ds_read_b64_tr_b16 a[198:199], v201 offset:2048
    ds_read_b64_tr_b16 a[200:201], v202 offset:0
    ds_read_b64_tr_b16 a[202:203], v202 offset:2048
    ds_read_b64_tr_b16 a[204:205], v203 offset:0
    ds_read_b64_tr_b16 a[206:207], v203 offset:2048
    s_waitcnt lgkmcnt(0)
    s_barrier
    v_mfma_f32_16x16x32_bf16 v[0:3], a[192:195], a[0:3], 0
    v_mfma_f32_16x16x32_bf16 v[4:7], a[192:195], a[16:19], 0
    ds_read_b64_tr_b16 a[208:209], v200 offset:4096
    v_mfma_f32_16x16x32_bf16 v[8:11], a[192:195], a[32:35], 0
    v_mfma_f32_16x16x32_bf16 v[12:15], a[192:195], a[48:51], 0
    ds_read_b64_tr_b16 a[210:211], v200 offset:6144
    v_mfma_f32_16x16x32_bf16 v[16:19], a[192:195], a[64:67], 0
    s_add_u32 m0, s39, 0
    s_mov_b32 s36, 131072
    buffer_load_dwordx4 v192, s[72:75], s36 offen offset:0 lds
    v_mfma_f32_16x16x32_bf16 v[20:23], a[192:195], a[80:83], 0
    ds_read_b64_tr_b16 a[212:213], v201 offset:4096
    v_mfma_f32_16x16x32_bf16 v[24:27], a[196:199], a[0:3], 0
    buffer_load_dwordx4 v193, s[72:75], s36 offen offset:1024 lds
    v_mfma_f32_16x16x32_bf16 v[28:31], a[196:199], a[16:19], 0
    ds_read_b64_tr_b16 a[214:215], v201 offset:6144
    v_mfma_f32_16x16x32_bf16 v[32:35], a[196:199], a[32:35], 0
    buffer_load_dwordx4 v194, s[72:75], s36 offen offset:2048 lds
    v_mfma_f32_16x16x32_bf16 v[36:39], a[196:199], a[48:51], 0
    ds_read_b64_tr_b16 a[216:217], v202 offset:4096
    v_mfma_f32_16x16x32_bf16 v[40:43], a[196:199], a[64:67], 0
    buffer_load_dwordx4 v195, s[72:75], s36 offen offset:3072 lds
    v_mfma_f32_16x16x32_bf16 v[44:47], a[196:199], a[80:83], 0
    ds_read_b64_tr_b16 a[218:219], v202 offset:6144
    v_mfma_f32_16x16x32_bf16 v[48:51], a[200:203], a[0:3], 0
    s_add_u32 m0, s39, 4096
    s_mov_b32 s36, 163840
    buffer_load_dwordx4 v192, s[72:75], s36 offen offset:0 lds
    v_mfma_f32_16x16x32_bf16 v[52:55], a[200:203], a[16:19], 0
    ds_read_b64_tr_b16 a[220:221], v203 offset:4096
    v_mfma_f32_16x16x32_bf16 v[56:59], a[200:203], a[32:35], 0
    buffer_load_dwordx4 v193, s[72:75], s36 offen offset:1024 lds
    v_mfma_f32_16x16x32_bf16 v[60:63], a[200:203], a[48:51], 0
    ds_read_b64_tr_b16 a[222:223], v203 offset:6144
    v_mfma_f32_16x16x32_bf16 v[64:67], a[200:203], a[64:67], 0
    buffer_load_dwordx4 v194, s[72:75], s36 offen offset:2048 lds
    v_mfma_f32_16x16x32_bf16 v[68:71], a[200:203], a[80:83], 0
    buffer_load_dwordx4 v195, s[72:75], s36 offen offset:3072 lds
    v_mfma_f32_16x16x32_bf16 v[72:75], a[204:207], a[0:3], 0
    s_add_u32 m0, s39, 32768
    s_mov_b32 s36, 128
    buffer_load_dwordx4 v192, s[72:75], s36 offen offset:0 lds
    v_mfma_f32_16x16x32_bf16 v[76:79], a[204:207], a[16:19], 0
    buffer_load_dwordx4 v193, s[72:75], s36 offen offset:1024 lds
    v_mfma_f32_16x16x32_bf16 v[80:83], a[204:207], a[32:35], 0
    buffer_load_dwordx4 v194, s[72:75], s36 offen offset:2048 lds
    v_mfma_f32_16x16x32_bf16 v[84:87], a[204:207], a[48:51], 0
    buffer_load_dwordx4 v195, s[72:75], s36 offen offset:3072 lds
    v_mfma_f32_16x16x32_bf16 v[88:91], a[204:207], a[64:67], 0
    s_add_u32 m0, s39, 36864
    s_mov_b32 s36, 32896
    buffer_load_dwordx4 v192, s[72:75], s36 offen offset:0 lds
    v_mfma_f32_16x16x32_bf16 v[92:95], a[204:207], a[80:83], 0
    buffer_load_dwordx4 v193, s[72:75], s36 offen offset:1024 lds
    s_waitcnt lgkmcnt(0)
    v_mfma_f32_16x16x32_bf16 v[0:3], a[208:211], a[4:7], v[0:3]
    buffer_load_dwordx4 v194, s[72:75], s36 offen offset:2048 lds
    v_mfma_f32_16x16x32_bf16 v[4:7], a[208:211], a[20:23], v[4:7]
    ds_read_b64_tr_b16 a[192:193], v200 offset:8192
    v_mfma_f32_16x16x32_bf16 v[8:11], a[208:211], a[36:39], v[8:11]
    buffer_load_dwordx4 v195, s[72:75], s36 offen offset:3072 lds
    v_mfma_f32_16x16x32_bf16 v[12:15], a[208:211], a[52:55], v[12:15]
    ds_read_b64_tr_b16 a[194:195], v200 offset:10240
    v_mfma_f32_16x16x32_bf16 v[16:19], a[208:211], a[68:71], v[16:19]
    s_add_u32 m0, s39, 98304
    s_mov_b32 s36, 131200
    buffer_load_dwordx4 v192, s[72:75], s36 offen offset:0 lds
    v_mfma_f32_16x16x32_bf16 v[20:23], a[208:211], a[84:87], v[20:23]
    ds_read_b64_tr_b16 a[196:197], v201 offset:8192
    v_mfma_f32_16x16x32_bf16 v[24:27], a[212:215], a[4:7], v[24:27]
    buffer_load_dwordx4 v193, s[72:75], s36 offen offset:1024 lds
    v_mfma_f32_16x16x32_bf16 v[28:31], a[212:215], a[20:23], v[28:31]
    ds_read_b64_tr_b16 a[198:199], v201 offset:10240
    v_mfma_f32_16x16x32_bf16 v[32:35], a[212:215], a[36:39], v[32:35]
    buffer_load_dwordx4 v194, s[72:75], s36 offen offset:2048 lds
    v_mfma_f32_16x16x32_bf16 v[36:39], a[212:215], a[52:55], v[36:39]
    ds_read_b64_tr_b16 a[200:201], v202 offset:8192
    v_mfma_f32_16x16x32_bf16 v[40:43], a[212:215], a[68:71], v[40:43]
    buffer_load_dwordx4 v195, s[72:75], s36 offen offset:3072 lds
    v_mfma_f32_16x16x32_bf16 v[44:47], a[212:215], a[84:87], v[44:47]
    ds_read_b64_tr_b16 a[202:203], v202 offset:10240
    v_mfma_f32_16x16x32_bf16 v[48:51], a[216:219], a[4:7], v[48:51]
    s_add_u32 m0, s39, 102400
    s_mov_b32 s36, 163968
    buffer_load_dwordx4 v192, s[72:75], s36 offen offset:0 lds
    v_mfma_f32_16x16x32_bf16 v[52:55], a[216:219], a[20:23], v[52:55]
    ds_read_b64_tr_b16 a[204:205], v203 offset:8192
    v_mfma_f32_16x16x32_bf16 v[56:59], a[216:219], a[36:39], v[56:59]
    buffer_load_dwordx4 v193, s[72:75], s36 offen offset:1024 lds
    v_mfma_f32_16x16x32_bf16 v[60:63], a[216:219], a[52:55], v[60:63]
    ds_read_b64_tr_b16 a[206:207], v203 offset:10240
    v_mfma_f32_16x16x32_bf16 v[64:67], a[216:219], a[68:71], v[64:67]
    buffer_load_dwordx4 v194, s[72:75], s36 offen offset:2048 lds
    v_mfma_f32_16x16x32_bf16 v[68:71], a[216:219], a[84:87], v[68:71]
    buffer_load_dwordx4 v195, s[72:75], s36 offen offset:3072 lds
    v_mfma_f32_16x16x32_bf16 v[72:75], a[220:223], a[4:7], v[72:75]
    v_mfma_f32_16x16x32_bf16 v[76:79], a[220:223], a[20:23], v[76:79]
    v_mfma_f32_16x16x32_bf16 v[80:83], a[220:223], a[36:39], v[80:83]
    v_mfma_f32_16x16x32_bf16 v[84:87], a[220:223], a[52:55], v[84:87]
    v_mfma_f32_16x16x32_bf16 v[88:91], a[220:223], a[68:71], v[88:91]
    v_mfma_f32_16x16x32_bf16 v[92:95], a[220:223], a[84:87], v[92:95]
    s_waitcnt lgkmcnt(0)
    v_mfma_f32_16x16x32_bf16 v[0:3], a[192:195], a[8:11], v[0:3]
    v_mfma_f32_16x16x32_bf16 v[4:7], a[192:195], a[24:27], v[4:7]
    ds_read_b64_tr_b16 a[208:209], v200 offset:12288
    v_mfma_f32_16x16x32_bf16 v[8:11], a[192:195], a[40:43], v[8:11]
    v_mfma_f32_16x16x32_bf16 v[12:15], a[192:195], a[56:59], v[12:15]
    ds_read_b64_tr_b16 a[210:211], v200 offset:14336
    v_mfma_f32_16x16x32_bf16 v[16:19], a[192:195], a[72:75], v[16:19]
    v_mfma_f32_16x16x32_bf16 v[20:23], a[192:195], a[88:91], v[20:23]
    ds_read_b64_tr_b16 a[212:213], v201 offset:12288
    v_mfma_f32_16x16x32_bf16 v[24:27], a[196:199], a[8:11], v[24:27]
    v_mfma_f32_16x16x32_bf16 v[28:31], a[196:199], a[24:27], v[28:31]
    ds_read_b64_tr_b16 a[214:215], v201 offset:14336
    v_mfma_f32_16x16x32_bf16 v[32:35], a[196:199], a[40:43], v[32:35]
    v_mfma_f32_16x16x32_bf16 v[36:39], a[196:199], a[56:59], v[36:39]
    ds_read_b64_tr_b16 a[216:217], v202 offset:12288
    v_mfma_f32_16x16x32_bf16 v[40:43], a[196:199], a[72:75], v[40:43]
    v_mfma_f32_16x16x32_bf16 v[44:47], a[196:199], a[88:91], v[44:47]
    ds_read_b64_tr_b16 a[218:219], v202 offset:14336
    v_mfma_f32_16x16x32_bf16 v[48:51], a[200:203], a[8:11], v[48:51]
    v_mfma_f32_16x16x32_bf16 v[52:55], a[200:203], a[24:27], v[52:55]
    ds_read_b64_tr_b16 a[220:221], v203 offset:12288
    v_mfma_f32_16x16x32_bf16 v[56:59], a[200:203], a[40:43], v[56:59]
    v_mfma_f32_16x16x32_bf16 v[60:63], a[200:203], a[56:59], v[60:63]
    ds_read_b64_tr_b16 a[222:223], v203 offset:14336
    v_mfma_f32_16x16x32_bf16 v[64:67], a[200:203], a[72:75], v[64:67]
    v_mfma_f32_16x16x32_bf16 v[68:71], a[200:203], a[88:91], v[68:71]
    v_mfma_f32_16x16x32_bf16 v[72:75], a[204:207], a[8:11], v[72:75]
    v_mfma_f32_16x16x32_bf16 v[76:79], a[204:207], a[24:27], v[76:79]
    v_mfma_f32_16x16x32_bf16 v[80:83], a[204:207], a[40:43], v[80:83]
    v_mfma_f32_16x16x32_bf16 v[84:87], a[204:207], a[56:59], v[84:87]
    v_mfma_f32_16x16x32_bf16 v[88:91], a[204:207], a[72:75], v[88:91]
    v_mfma_f32_16x16x32_bf16 v[92:95], a[204:207], a[88:91], v[92:95]
    s_waitcnt lgkmcnt(0)
    s_waitcnt vmcnt(16)
    s_barrier
    v_xor_b32 v200, 0, v251
    v_lshl_add_u32 v200, v200, 5, v250
    v_xor_b32 v201, 1, v251
    v_lshl_add_u32 v201, v201, 5, v250
    v_xor_b32 v202, 2, v251
    v_lshl_add_u32 v202, v202, 5, v250
    v_xor_b32 v203, 3, v251
    v_lshl_add_u32 v203, v203, 5, v250
    v_mfma_f32_16x16x32_bf16 v[0:3], a[208:211], a[12:15], v[0:3]
    s_add_u32 m0, s39, 131072
    s_mov_b32 s36, 256
    buffer_load_dwordx4 v192, s[72:75], s36 offen offset:0 lds
    v_mfma_f32_16x16x32_bf16 v[4:7], a[208:211], a[28:31], v[4:7]
    ds_read_b64_tr_b16 a[192:193], v200 offset:0
    v_mfma_f32_16x16x32_bf16 v[8:11], a[208:211], a[44:47], v[8:11]
    buffer_load_dwordx4 v193, s[72:75], s36 offen offset:1024 lds
    v_mfma_f32_16x16x32_bf16 v[12:15], a[208:211], a[60:63], v[12:15]
    ds_read_b64_tr_b16 a[194:195], v200 offset:2048
    v_mfma_f32_16x16x32_bf16 v[16:19], a[208:211], a[76:79], v[16:19]
    buffer_load_dwordx4 v194, s[72:75], s36 offen offset:2048 lds
    v_mfma_f32_16x16x32_bf16 v[20:23], a[208:211], a[92:95], v[20:23]
    ds_read_b64_tr_b16 a[196:197], v201 offset:0
    v_mfma_f32_16x16x32_bf16 v[24:27], a[212:215], a[12:15], v[24:27]
    buffer_load_dwordx4 v195, s[72:75], s36 offen offset:3072 lds
    v_mfma_f32_16x16x32_bf16 v[28:31], a[212:215], a[28:31], v[28:31]
    ds_read_b64_tr_b16 a[198:199], v201 offset:2048
    v_mfma_f32_16x16x32_bf16 v[32:35], a[212:215], a[44:47], v[32:35]
    s_add_u32 m0, s39, 135168
    s_mov_b32 s36, 33024
    buffer_load_dwordx4 v192, s[72:75], s36 offen offset:0 lds
    v_mfma_f32_16x16x32_bf16 v[36:39], a[212:215], a[60:63], v[36:39]
    ds_read_b64_tr_b16 a[200:201], v202 offset:0
    v_mfma_f32_16x16x32_bf16 v[40:43], a[212:215], a[76:79], v[40:43]
    buffer_load_dwordx4 v193, s[72:75], s36 offen offset:1024 lds
    v_mfma_f32_16x16x32_bf16 v[44:47], a[212:215], a[92:95], v[44:47]
    ds_read_b64_tr_b16 a[202:203], v202 offset:2048
    v_mfma_f32_16x16x32_bf16 v[48:51], a[216:219], a[12:15], v[48:51]
    buffer_load_dwordx4 v194, s[72:75], s36 offen offset:2048 lds
    v_mfma_f32_16x16x32_bf16 v[52:55], a[216:219], a[28:31], v[52:55]
    ds_read_b64_tr_b16 a[204:205], v203 offset:0
    v_mfma_f32_16x16x32_bf16 v[56:59], a[216:219], a[44:47], v[56:59]
    buffer_load_dwordx4 v195, s[72:75], s36 offen offset:3072 lds
    v_mfma_f32_16x16x32_bf16 v[60:63], a[216:219], a[60:63], v[60:63]
    ds_read_b64_tr_b16 a[206:207], v203 offset:2048
    v_mfma_f32_16x16x32_bf16 v[64:67], a[216:219], a[76:79], v[64:67]
    v_mfma_f32_16x16x32_bf16 v[68:71], a[216:219], a[92:95], v[68:71]
    v_mfma_f32_16x16x32_bf16 v[72:75], a[220:223], a[12:15], v[72:75]
    v_mfma_f32_16x16x32_bf16 v[76:79], a[220:223], a[28:31], v[76:79]
    v_mfma_f32_16x16x32_bf16 v[80:83], a[220:223], a[44:47], v[80:83]
    v_mfma_f32_16x16x32_bf16 v[84:87], a[220:223], a[60:63], v[84:87]
    v_mfma_f32_16x16x32_bf16 v[88:91], a[220:223], a[76:79], v[88:91]
    v_mfma_f32_16x16x32_bf16 v[92:95], a[220:223], a[92:95], v[92:95]
    s_waitcnt lgkmcnt(0)
    v_mfma_f32_16x16x32_bf16 v[0:3], a[192:195], a[96:99], v[0:3]
    v_mfma_f32_16x16x32_bf16 v[4:7], a[192:195], a[112:115], v[4:7]
    ds_read_b64_tr_b16 a[208:209], v200 offset:4096
    v_mfma_f32_16x16x32_bf16 v[8:11], a[192:195], a[128:131], v[8:11]
    v_mfma_f32_16x16x32_bf16 v[12:15], a[192:195], a[144:147], v[12:15]
    ds_read_b64_tr_b16 a[210:211], v200 offset:6144
    v_mfma_f32_16x16x32_bf16 v[16:19], a[192:195], a[160:163], v[16:19]
    v_mfma_f32_16x16x32_bf16 v[20:23], a[192:195], a[176:179], v[20:23]
    ds_read_b64_tr_b16 a[212:213], v201 offset:4096
    v_mfma_f32_16x16x32_bf16 v[24:27], a[196:199], a[96:99], v[24:27]
    v_mfma_f32_16x16x32_bf16 v[28:31], a[196:199], a[112:115], v[28:31]
    ds_read_b64_tr_b16 a[214:215], v201 offset:6144
    v_mfma_f32_16x16x32_bf16 v[32:35], a[196:199], a[128:131], v[32:35]
    v_mfma_f32_16x16x32_bf16 v[36:39], a[196:199], a[144:147], v[36:39]
    ds_read_b64_tr_b16 a[216:217], v202 offset:4096
    v_mfma_f32_16x16x32_bf16 v[40:43], a[196:199], a[160:163], v[40:43]
    v_mfma_f32_16x16x32_bf16 v[44:47], a[196:199], a[176:179], v[44:47]
    ds_read_b64_tr_b16 a[218:219], v202 offset:6144
    v_mfma_f32_16x16x32_bf16 v[48:51], a[200:203], a[96:99], v[48:51]
    v_mfma_f32_16x16x32_bf16 v[52:55], a[200:203], a[112:115], v[52:55]
    ds_read_b64_tr_b16 a[220:221], v203 offset:4096
    v_mfma_f32_16x16x32_bf16 v[56:59], a[200:203], a[128:131], v[56:59]
    v_mfma_f32_16x16x32_bf16 v[60:63], a[200:203], a[144:147], v[60:63]
    ds_read_b64_tr_b16 a[222:223], v203 offset:6144
    v_mfma_f32_16x16x32_bf16 v[64:67], a[200:203], a[160:163], v[64:67]
    v_mfma_f32_16x16x32_bf16 v[68:71], a[200:203], a[176:179], v[68:71]
    v_mfma_f32_16x16x32_bf16 v[72:75], a[204:207], a[96:99], v[72:75]
    v_mfma_f32_16x16x32_bf16 v[76:79], a[204:207], a[112:115], v[76:79]
    v_mfma_f32_16x16x32_bf16 v[80:83], a[204:207], a[128:131], v[80:83]
    v_mfma_f32_16x16x32_bf16 v[84:87], a[204:207], a[144:147], v[84:87]
    v_mfma_f32_16x16x32_bf16 v[88:91], a[204:207], a[160:163], v[88:91]
    v_mfma_f32_16x16x32_bf16 v[92:95], a[204:207], a[176:179], v[92:95]
    s_waitcnt lgkmcnt(0)
    v_mfma_f32_16x16x32_bf16 v[0:3], a[208:211], a[100:103], v[0:3]
    v_mfma_f32_16x16x32_bf16 v[4:7], a[208:211], a[116:119], v[4:7]
    ds_read_b64_tr_b16 a[192:193], v200 offset:8192
    v_mfma_f32_16x16x32_bf16 v[8:11], a[208:211], a[132:135], v[8:11]
    v_mfma_f32_16x16x32_bf16 v[12:15], a[208:211], a[148:151], v[12:15]
    ds_read_b64_tr_b16 a[194:195], v200 offset:10240
    v_mfma_f32_16x16x32_bf16 v[16:19], a[208:211], a[164:167], v[16:19]
    v_mfma_f32_16x16x32_bf16 v[20:23], a[208:211], a[180:183], v[20:23]
    ds_read_b64_tr_b16 a[196:197], v201 offset:8192
    v_mfma_f32_16x16x32_bf16 v[24:27], a[212:215], a[100:103], v[24:27]
    v_mfma_f32_16x16x32_bf16 v[28:31], a[212:215], a[116:119], v[28:31]
    ds_read_b64_tr_b16 a[198:199], v201 offset:10240
    v_mfma_f32_16x16x32_bf16 v[32:35], a[212:215], a[132:135], v[32:35]
    v_mfma_f32_16x16x32_bf16 v[36:39], a[212:215], a[148:151], v[36:39]
    ds_read_b64_tr_b16 a[200:201], v202 offset:8192
    v_mfma_f32_16x16x32_bf16 v[40:43], a[212:215], a[164:167], v[40:43]
    v_mfma_f32_16x16x32_bf16 v[44:47], a[212:215], a[180:183], v[44:47]
    ds_read_b64_tr_b16 a[202:203], v202 offset:10240
    v_mfma_f32_16x16x32_bf16 v[48:51], a[216:219], a[100:103], v[48:51]
    v_mfma_f32_16x16x32_bf16 v[52:55], a[216:219], a[116:119], v[52:55]
    ds_read_b64_tr_b16 a[204:205], v203 offset:8192
    v_mfma_f32_16x16x32_bf16 v[56:59], a[216:219], a[132:135], v[56:59]
    v_mfma_f32_16x16x32_bf16 v[60:63], a[216:219], a[148:151], v[60:63]
    ds_read_b64_tr_b16 a[206:207], v203 offset:10240
    v_mfma_f32_16x16x32_bf16 v[64:67], a[216:219], a[164:167], v[64:67]
    v_mfma_f32_16x16x32_bf16 v[68:71], a[216:219], a[180:183], v[68:71]
    v_mfma_f32_16x16x32_bf16 v[72:75], a[220:223], a[100:103], v[72:75]
    v_mfma_f32_16x16x32_bf16 v[76:79], a[220:223], a[116:119], v[76:79]
    v_mfma_f32_16x16x32_bf16 v[80:83], a[220:223], a[132:135], v[80:83]
    v_mfma_f32_16x16x32_bf16 v[84:87], a[220:223], a[148:151], v[84:87]
    v_mfma_f32_16x16x32_bf16 v[88:91], a[220:223], a[164:167], v[88:91]
    v_mfma_f32_16x16x32_bf16 v[92:95], a[220:223], a[180:183], v[92:95]
    s_waitcnt lgkmcnt(0)
    v_mfma_f32_16x16x32_bf16 v[0:3], a[192:195], a[104:107], v[0:3]
    v_mfma_f32_16x16x32_bf16 v[4:7], a[192:195], a[120:123], v[4:7]
    ds_read_b64_tr_b16 a[208:209], v200 offset:12288
    v_mfma_f32_16x16x32_bf16 v[8:11], a[192:195], a[136:139], v[8:11]
    v_mfma_f32_16x16x32_bf16 v[12:15], a[192:195], a[152:155], v[12:15]
    ds_read_b64_tr_b16 a[210:211], v200 offset:14336
    v_mfma_f32_16x16x32_bf16 v[16:19], a[192:195], a[168:171], v[16:19]
    v_mfma_f32_16x16x32_bf16 v[20:23], a[192:195], a[184:187], v[20:23]
    ds_read_b64_tr_b16 a[212:213], v201 offset:12288
    v_mfma_f32_16x16x32_bf16 v[24:27], a[196:199], a[104:107], v[24:27]
    v_mfma_f32_16x16x32_bf16 v[28:31], a[196:199], a[120:123], v[28:31]
    ds_read_b64_tr_b16 a[214:215], v201 offset:14336
    v_mfma_f32_16x16x32_bf16 v[32:35], a[196:199], a[136:139], v[32:35]
    v_mfma_f32_16x16x32_bf16 v[36:39], a[196:199], a[152:155], v[36:39]
    ds_read_b64_tr_b16 a[216:217], v202 offset:12288
    v_mfma_f32_16x16x32_bf16 v[40:43], a[196:199], a[168:171], v[40:43]
    v_mfma_f32_16x16x32_bf16 v[44:47], a[196:199], a[184:187], v[44:47]
    ds_read_b64_tr_b16 a[218:219], v202 offset:14336
    v_mfma_f32_16x16x32_bf16 v[48:51], a[200:203], a[104:107], v[48:51]
    v_mfma_f32_16x16x32_bf16 v[52:55], a[200:203], a[120:123], v[52:55]
    ds_read_b64_tr_b16 a[220:221], v203 offset:12288
    v_mfma_f32_16x16x32_bf16 v[56:59], a[200:203], a[136:139], v[56:59]
    v_mfma_f32_16x16x32_bf16 v[60:63], a[200:203], a[152:155], v[60:63]
    ds_read_b64_tr_b16 a[222:223], v203 offset:14336
    v_mfma_f32_16x16x32_bf16 v[64:67], a[200:203], a[168:171], v[64:67]
    v_mfma_f32_16x16x32_bf16 v[68:71], a[200:203], a[184:187], v[68:71]
    v_mfma_f32_16x16x32_bf16 v[72:75], a[204:207], a[104:107], v[72:75]
    v_mfma_f32_16x16x32_bf16 v[76:79], a[204:207], a[120:123], v[76:79]
    v_mfma_f32_16x16x32_bf16 v[80:83], a[204:207], a[136:139], v[80:83]
    v_mfma_f32_16x16x32_bf16 v[84:87], a[204:207], a[152:155], v[84:87]
    v_mfma_f32_16x16x32_bf16 v[88:91], a[204:207], a[168:171], v[88:91]
    v_mfma_f32_16x16x32_bf16 v[92:95], a[204:207], a[184:187], v[92:95]
    s_waitcnt lgkmcnt(0)
    s_waitcnt vmcnt(16)
    s_barrier
    v_xor_b32 v200, 0, v251
    v_lshl_add_u32 v200, v200, 5, v250
    v_add_u32 v200, 32768, v200
    v_xor_b32 v201, 1, v251
    v_lshl_add_u32 v201, v201, 5, v250
    v_add_u32 v201, 32768, v201
    v_xor_b32 v202, 2, v251
    v_lshl_add_u32 v202, v202, 5, v250
    v_add_u32 v202, 32768, v202
    v_xor_b32 v203, 3, v251
    v_lshl_add_u32 v203, v203, 5, v250
    v_add_u32 v203, 32768, v203
    v_mfma_f32_16x16x32_bf16 v[0:3], a[208:211], a[108:111], v[0:3]
    s_add_u32 m0, s39, 65536
    s_mov_b32 s36, 131328
    buffer_load_dwordx4 v192, s[72:75], s36 offen offset:0 lds
    v_mfma_f32_16x16x32_bf16 v[4:7], a[208:211], a[124:127], v[4:7]
    ds_read_b64_tr_b16 a[192:193], v200 offset:0
    v_mfma_f32_16x16x32_bf16 v[8:11], a[208:211], a[140:143], v[8:11]
    buffer_load_dwordx4 v193, s[72:75], s36 offen offset:1024 lds
    v_mfma_f32_16x16x32_bf16 v[12:15], a[208:211], a[156:159], v[12:15]
    ds_read_b64_tr_b16 a[194:195], v200 offset:2048
    v_mfma_f32_16x16x32_bf16 v[16:19], a[208:211], a[172:175], v[16:19]
    buffer_load_dwordx4 v194, s[72:75], s36 offen offset:2048 lds
    v_mfma_f32_16x16x32_bf16 v[20:23], a[208:211], a[188:191], v[20:23]
    ds_read_b64_tr_b16 a[196:197], v201 offset:0
    v_mfma_f32_16x16x32_bf16 v[24:27], a[212:215], a[108:111], v[24:27]
    buffer_load_dwordx4 v195, s[72:75], s36 offen offset:3072 lds
    v_mfma_f32_16x16x32_bf16 v[28:31], a[212:215], a[124:127], v[28:31]
    ds_read_b64_tr_b16 a[198:199], v201 offset:2048
    v_mfma_f32_16x16x32_bf16 v[32:35], a[212:215], a[140:143], v[32:35]
    s_add_u32 m0, s39, 69632
    s_mov_b32 s36, 164096
    buffer_load_dwordx4 v192, s[72:75], s36 offen offset:0 lds
    v_mfma_f32_16x16x32_bf16 v[36:39], a[212:215], a[156:159], v[36:39]
    ds_read_b64_tr_b16 a[200:201], v202 offset:0
    v_mfma_f32_16x16x32_bf16 v[40:43], a[212:215], a[172:175], v[40:43]
    buffer_load_dwordx4 v193, s[72:75], s36 offen offset:1024 lds
    v_mfma_f32_16x16x32_bf16 v[44:47], a[212:215], a[188:191], v[44:47]
    ds_read_b64_tr_b16 a[202:203], v202 offset:2048
    v_mfma_f32_16x16x32_bf16 v[48:51], a[216:219], a[108:111], v[48:51]
    buffer_load_dwordx4 v194, s[72:75], s36 offen offset:2048 lds
    v_mfma_f32_16x16x32_bf16 v[52:55], a[216:219], a[124:127], v[52:55]
    ds_read_b64_tr_b16 a[204:205], v203 offset:0
    v_mfma_f32_16x16x32_bf16 v[56:59], a[216:219], a[140:143], v[56:59]
    buffer_load_dwordx4 v195, s[72:75], s36 offen offset:3072 lds
    v_mfma_f32_16x16x32_bf16 v[60:63], a[216:219], a[156:159], v[60:63]
    ds_read_b64_tr_b16 a[206:207], v203 offset:2048
    v_mfma_f32_16x16x32_bf16 v[64:67], a[216:219], a[172:175], v[64:67]
    v_mfma_f32_16x16x32_bf16 v[68:71], a[216:219], a[188:191], v[68:71]
    v_mfma_f32_16x16x32_bf16 v[72:75], a[220:223], a[108:111], v[72:75]
    v_mfma_f32_16x16x32_bf16 v[76:79], a[220:223], a[124:127], v[76:79]
    v_mfma_f32_16x16x32_bf16 v[80:83], a[220:223], a[140:143], v[80:83]
    v_mfma_f32_16x16x32_bf16 v[84:87], a[220:223], a[156:159], v[84:87]
    v_mfma_f32_16x16x32_bf16 v[88:91], a[220:223], a[172:175], v[88:91]
    v_mfma_f32_16x16x32_bf16 v[92:95], a[220:223], a[188:191], v[92:95]
    s_waitcnt lgkmcnt(0)
    v_mfma_f32_16x16x32_bf16 v[96:99], a[192:195], a[0:3], 0
    v_mfma_f32_16x16x32_bf16 v[100:103], a[192:195], a[16:19], 0
    ds_read_b64_tr_b16 a[208:209], v200 offset:4096
    v_mfma_f32_16x16x32_bf16 v[104:107], a[192:195], a[32:35], 0
    v_mfma_f32_16x16x32_bf16 v[108:111], a[192:195], a[48:51], 0
    ds_read_b64_tr_b16 a[210:211], v200 offset:6144
    v_mfma_f32_16x16x32_bf16 v[112:115], a[192:195], a[64:67], 0
    v_cvt_pk_bf16_f32 v204, v0, v1
    v_cvt_pk_bf16_f32 v205, v2, v3
    v_mfma_f32_16x16x32_bf16 v[116:119], a[192:195], a[80:83], 0
    ds_read_b64_tr_b16 a[212:213], v201 offset:4096
    v_mfma_f32_16x16x32_bf16 v[120:123], a[196:199], a[0:3], 0
    v_cvt_pk_bf16_f32 v206, v24, v25
    v_cvt_pk_bf16_f32 v207, v26, v27
    v_mfma_f32_16x16x32_bf16 v[124:127], a[196:199], a[16:19], 0
    ds_read_b64_tr_b16 a[214:215], v201 offset:6144
    v_mfma_f32_16x16x32_bf16 v[128:131], a[196:199], a[32:35], 0
    s_mov_b32 s23, 0
    buffer_store_dwordx4 v[204:207], v236, s[16:19], s23 offen offset:0 sc1
    v_mfma_f32_16x16x32_bf16 v[132:135], a[196:199], a[48:51], 0
    ds_read_b64_tr_b16 a[216:217], v202 offset:4096
    v_mfma_f32_16x16x32_bf16 v[136:139], a[196:199], a[64:67], 0
    v_cvt_pk_bf16_f32 v208, v4, v5
    v_cvt_pk_bf16_f32 v209, v6, v7
    v_mfma_f32_16x16x32_bf16 v[140:143], a[196:199], a[80:83], 0
    ds_read_b64_tr_b16 a[218:219], v202 offset:6144
    v_mfma_f32_16x16x32_bf16 v[144:147], a[200:203], a[0:3], 0
    v_cvt_pk_bf16_f32 v210, v28, v29
    v_cvt_pk_bf16_f32 v211, v30, v31
    v_mfma_f32_16x16x32_bf16 v[148:151], a[200:203], a[16:19], 0
    ds_read_b64_tr_b16 a[220:221], v203 offset:4096
    v_mfma_f32_16x16x32_bf16 v[152:155], a[200:203], a[32:35], 0
    buffer_store_dwordx4 v[208:211], v236, s[16:19], s23 offen offset:1024 sc1
    v_mfma_f32_16x16x32_bf16 v[156:159], a[200:203], a[48:51], 0
    ds_read_b64_tr_b16 a[222:223], v203 offset:6144
    v_mfma_f32_16x16x32_bf16 v[160:163], a[200:203], a[64:67], 0
    v_cvt_pk_bf16_f32 v212, v8, v9
    v_cvt_pk_bf16_f32 v213, v10, v11
    v_mfma_f32_16x16x32_bf16 v[164:167], a[200:203], a[80:83], 0
    v_cvt_pk_bf16_f32 v214, v32, v33
    v_cvt_pk_bf16_f32 v215, v34, v35
    v_mfma_f32_16x16x32_bf16 v[168:171], a[204:207], a[0:3], 0
    buffer_store_dwordx4 v[212:215], v236, s[16:19], s23 offen offset:2048 sc1
    v_mfma_f32_16x16x32_bf16 v[172:175], a[204:207], a[16:19], 0
    v_cvt_pk_bf16_f32 v216, v12, v13
    v_cvt_pk_bf16_f32 v217, v14, v15
    v_mfma_f32_16x16x32_bf16 v[176:179], a[204:207], a[32:35], 0
    v_cvt_pk_bf16_f32 v218, v36, v37
    v_cvt_pk_bf16_f32 v219, v38, v39
    v_mfma_f32_16x16x32_bf16 v[180:183], a[204:207], a[48:51], 0
    buffer_store_dwordx4 v[216:219], v236, s[16:19], s23 offen offset:3072 sc1
    v_mfma_f32_16x16x32_bf16 v[184:187], a[204:207], a[64:67], 0
    v_cvt_pk_bf16_f32 v204, v16, v17
    v_cvt_pk_bf16_f32 v205, v18, v19
    v_mfma_f32_16x16x32_bf16 v[188:191], a[204:207], a[80:83], 0
    v_cvt_pk_bf16_f32 v206, v40, v41
    v_cvt_pk_bf16_f32 v207, v42, v43
    s_waitcnt lgkmcnt(0)
    v_mfma_f32_16x16x32_bf16 v[96:99], a[208:211], a[4:7], v[96:99]
    s_mov_b32 s23, 4096
    buffer_store_dwordx4 v[204:207], v236, s[16:19], s23 offen offset:0 sc1
    v_mfma_f32_16x16x32_bf16 v[100:103], a[208:211], a[20:23], v[100:103]
    ds_read_b64_tr_b16 a[192:193], v200 offset:8192
    v_mfma_f32_16x16x32_bf16 v[104:107], a[208:211], a[36:39], v[104:107]
    v_cvt_pk_bf16_f32 v208, v20, v21
    v_cvt_pk_bf16_f32 v209, v22, v23
    v_mfma_f32_16x16x32_bf16 v[108:111], a[208:211], a[52:55], v[108:111]
    ds_read_b64_tr_b16 a[194:195], v200 offset:10240
    v_mfma_f32_16x16x32_bf16 v[112:115], a[208:211], a[68:71], v[112:115]
    v_cvt_pk_bf16_f32 v210, v44, v45
    v_cvt_pk_bf16_f32 v211, v46, v47
    v_mfma_f32_16x16x32_bf16 v[116:119], a[208:211], a[84:87], v[116:119]
    ds_read_b64_tr_b16 a[196:197], v201 offset:8192
    v_mfma_f32_16x16x32_bf16 v[120:123], a[212:215], a[4:7], v[120:123]
    buffer_store_dwordx4 v[208:211], v236, s[16:19], s23 offen offset:1024 sc1
    v_mfma_f32_16x16x32_bf16 v[124:127], a[212:215], a[20:23], v[124:127]
    ds_read_b64_tr_b16 a[198:199], v201 offset:10240
    v_mfma_f32_16x16x32_bf16 v[128:131], a[212:215], a[36:39], v[128:131]
    v_cvt_pk_bf16_f32 v212, v48, v49
    v_cvt_pk_bf16_f32 v213, v50, v51
    v_mfma_f32_16x16x32_bf16 v[132:135], a[212:215], a[52:55], v[132:135]
    ds_read_b64_tr_b16 a[200:201], v202 offset:8192
    v_mfma_f32_16x16x32_bf16 v[136:139], a[212:215], a[68:71], v[136:139]
    v_cvt_pk_bf16_f32 v214, v72, v73
    v_cvt_pk_bf16_f32 v215, v74, v75
    v_mfma_f32_16x16x32_bf16 v[140:143], a[212:215], a[84:87], v[140:143]
    ds_read_b64_tr_b16 a[202:203], v202 offset:10240
    v_mfma_f32_16x16x32_bf16 v[144:147], a[216:219], a[4:7], v[144:147]
    buffer_store_dwordx4 v[212:215], v236, s[16:19], s23 offen offset:2048 sc1
    v_mfma_f32_16x16x32_bf16 v[148:151], a[216:219], a[20:23], v[148:151]
    ds_read_b64_tr_b16 a[204:205], v203 offset:8192
    v_mfma_f32_16x16x32_bf16 v[152:155], a[216:219], a[36:39], v[152:155]
    v_cvt_pk_bf16_f32 v216, v52, v53
    v_cvt_pk_bf16_f32 v217, v54, v55
    v_mfma_f32_16x16x32_bf16 v[156:159], a[216:219], a[52:55], v[156:159]
    ds_read_b64_tr_b16 a[206:207], v203 offset:10240
    v_mfma_f32_16x16x32_bf16 v[160:163], a[216:219], a[68:71], v[160:163]
    v_cvt_pk_bf16_f32 v218, v76, v77
    v_cvt_pk_bf16_f32 v219, v78, v79
    v_mfma_f32_16x16x32_bf16 v[164:167], a[216:219], a[84:87], v[164:167]
    buffer_store_dwordx4 v[216:219], v236, s[16:19], s23 offen offset:3072 sc1
    v_mfma_f32_16x16x32_bf16 v[168:171], a[220:223], a[4:7], v[168:171]
    v_cvt_pk_bf16_f32 v204, v56, v57
    v_cvt_pk_bf16_f32 v205, v58, v59
    v_mfma_f32_16x16x32_bf16 v[172:175], a[220:223], a[20:23], v[172:175]
    v_cvt_pk_bf16_f32 v206, v80, v81
    v_cvt_pk_bf16_f32 v207, v82, v83
    v_mfma_f32_16x16x32_bf16 v[176:179], a[220:223], a[36:39], v[176:179]
    s_mov_b32 s23, 8192
    buffer_store_dwordx4 v[204:207], v236, s[16:19], s23 offen offset:0 sc1
    v_mfma_f32_16x16x32_bf16 v[180:183], a[220:223], a[52:55], v[180:183]
    v_cvt_pk_bf16_f32 v208, v60, v61
    v_cvt_pk_bf16_f32 v209, v62, v63
    v_mfma_f32_16x16x32_bf16 v[184:187], a[220:223], a[68:71], v[184:187]
    v_cvt_pk_bf16_f32 v210, v84, v85
    v_cvt_pk_bf16_f32 v211, v86, v87
    v_mfma_f32_16x16x32_bf16 v[188:191], a[220:223], a[84:87], v[188:191]
    buffer_store_dwordx4 v[208:211], v236, s[16:19], s23 offen offset:1024 sc1
    s_waitcnt lgkmcnt(0)
    v_mfma_f32_16x16x32_bf16 v[96:99], a[192:195], a[8:11], v[96:99]
    v_cvt_pk_bf16_f32 v212, v64, v65
    v_cvt_pk_bf16_f32 v213, v66, v67
    v_mfma_f32_16x16x32_bf16 v[100:103], a[192:195], a[24:27], v[100:103]
    ds_read_b64_tr_b16 a[208:209], v200 offset:12288
    v_mfma_f32_16x16x32_bf16 v[104:107], a[192:195], a[40:43], v[104:107]
    v_cvt_pk_bf16_f32 v214, v88, v89
    v_cvt_pk_bf16_f32 v215, v90, v91
    v_mfma_f32_16x16x32_bf16 v[108:111], a[192:195], a[56:59], v[108:111]
    ds_read_b64_tr_b16 a[210:211], v200 offset:14336
    v_mfma_f32_16x16x32_bf16 v[112:115], a[192:195], a[72:75], v[112:115]
    buffer_store_dwordx4 v[212:215], v236, s[16:19], s23 offen offset:2048 sc1
    v_mfma_f32_16x16x32_bf16 v[116:119], a[192:195], a[88:91], v[116:119]
    ds_read_b64_tr_b16 a[212:213], v201 offset:12288
    v_mfma_f32_16x16x32_bf16 v[120:123], a[196:199], a[8:11], v[120:123]
    v_cvt_pk_bf16_f32 v216, v68, v69
    v_cvt_pk_bf16_f32 v217, v70, v71
    v_mfma_f32_16x16x32_bf16 v[124:127], a[196:199], a[24:27], v[124:127]
    ds_read_b64_tr_b16 a[214:215], v201 offset:14336
    v_mfma_f32_16x16x32_bf16 v[128:131], a[196:199], a[40:43], v[128:131]
    v_cvt_pk_bf16_f32 v218, v92, v93
    v_cvt_pk_bf16_f32 v219, v94, v95
    v_mfma_f32_16x16x32_bf16 v[132:135], a[196:199], a[56:59], v[132:135]
    ds_read_b64_tr_b16 a[216:217], v202 offset:12288
    v_mfma_f32_16x16x32_bf16 v[136:139], a[196:199], a[72:75], v[136:139]
    buffer_store_dwordx4 v[216:219], v236, s[16:19], s23 offen offset:3072 sc1
    v_mfma_f32_16x16x32_bf16 v[140:143], a[196:199], a[88:91], v[140:143]
    ds_read_b64_tr_b16 a[218:219], v202 offset:14336
    v_mfma_f32_16x16x32_bf16 v[144:147], a[200:203], a[8:11], v[144:147]
    v_mfma_f32_16x16x32_bf16 v[148:151], a[200:203], a[24:27], v[148:151]
    ds_read_b64_tr_b16 a[220:221], v203 offset:12288
    v_mfma_f32_16x16x32_bf16 v[152:155], a[200:203], a[40:43], v[152:155]
    v_mfma_f32_16x16x32_bf16 v[156:159], a[200:203], a[56:59], v[156:159]
    ds_read_b64_tr_b16 a[222:223], v203 offset:14336
    v_mfma_f32_16x16x32_bf16 v[160:163], a[200:203], a[72:75], v[160:163]
    v_mfma_f32_16x16x32_bf16 v[164:167], a[200:203], a[88:91], v[164:167]
    v_mfma_f32_16x16x32_bf16 v[168:171], a[204:207], a[8:11], v[168:171]
    v_mfma_f32_16x16x32_bf16 v[172:175], a[204:207], a[24:27], v[172:175]
    v_mfma_f32_16x16x32_bf16 v[176:179], a[204:207], a[40:43], v[176:179]
    v_mfma_f32_16x16x32_bf16 v[180:183], a[204:207], a[56:59], v[180:183]
    v_mfma_f32_16x16x32_bf16 v[184:187], a[204:207], a[72:75], v[184:187]
    v_mfma_f32_16x16x32_bf16 v[188:191], a[204:207], a[88:91], v[188:191]
    s_waitcnt lgkmcnt(0)
    s_waitcnt vmcnt(28)
    s_barrier
    v_xor_b32 v200, 0, v251
    v_lshl_add_u32 v200, v200, 5, v250
    v_add_u32 v200, 98304, v200
    v_xor_b32 v201, 1, v251
    v_lshl_add_u32 v201, v201, 5, v250
    v_add_u32 v201, 98304, v201
    v_xor_b32 v202, 2, v251
    v_lshl_add_u32 v202, v202, 5, v250
    v_add_u32 v202, 98304, v202
    v_xor_b32 v203, 3, v251
    v_lshl_add_u32 v203, v203, 5, v250
    v_add_u32 v203, 98304, v203
    v_mfma_f32_16x16x32_bf16 v[96:99], a[208:211], a[12:15], v[96:99]
    s_add_u32 m0, s39, 0
    s_mov_b32 s36, 384
    buffer_load_dwordx4 v192, s[72:75], s36 offen offset:0 lds
    v_mfma_f32_16x16x32_bf16 v[100:103], a[208:211], a[28:31], v[100:103]
    ds_read_b64_tr_b16 a[192:193], v200 offset:0
    v_mfma_f32_16x16x32_bf16 v[104:107], a[208:211], a[44:47], v[104:107]
    buffer_load_dwordx4 v193, s[72:75], s36 offen offset:1024 lds
    v_mfma_f32_16x16x32_bf16 v[108:111], a[208:211], a[60:63], v[108:111]
    ds_read_b64_tr_b16 a[194:195], v200 offset:2048
    v_mfma_f32_16x16x32_bf16 v[112:115], a[208:211], a[76:79], v[112:115]
    buffer_load_dwordx4 v194, s[72:75], s36 offen offset:2048 lds
    v_mfma_f32_16x16x32_bf16 v[116:119], a[208:211], a[92:95], v[116:119]
    ds_read_b64_tr_b16 a[196:197], v201 offset:0
    v_mfma_f32_16x16x32_bf16 v[120:123], a[212:215], a[12:15], v[120:123]
    buffer_load_dwordx4 v195, s[72:75], s36 offen offset:3072 lds
    v_mfma_f32_16x16x32_bf16 v[124:127], a[212:215], a[28:31], v[124:127]
    ds_read_b64_tr_b16 a[198:199], v201 offset:2048
    v_mfma_f32_16x16x32_bf16 v[128:131], a[212:215], a[44:47], v[128:131]
    s_add_u32 m0, s39, 4096
    s_mov_b32 s36, 33152
    buffer_load_dwordx4 v192, s[72:75], s36 offen offset:0 lds
    v_mfma_f32_16x16x32_bf16 v[132:135], a[212:215], a[60:63], v[132:135]
    ds_read_b64_tr_b16 a[200:201], v202 offset:0
    v_mfma_f32_16x16x32_bf16 v[136:139], a[212:215], a[76:79], v[136:139]
    buffer_load_dwordx4 v193, s[72:75], s36 offen offset:1024 lds
    v_mfma_f32_16x16x32_bf16 v[140:143], a[212:215], a[92:95], v[140:143]
    ds_read_b64_tr_b16 a[202:203], v202 offset:2048
    v_mfma_f32_16x16x32_bf16 v[144:147], a[216:219], a[12:15], v[144:147]
    buffer_load_dwordx4 v194, s[72:75], s36 offen offset:2048 lds
    v_mfma_f32_16x16x32_bf16 v[148:151], a[216:219], a[28:31], v[148:151]
    ds_read_b64_tr_b16 a[204:205], v203 offset:0
    v_mfma_f32_16x16x32_bf16 v[152:155], a[216:219], a[44:47], v[152:155]
    buffer_load_dwordx4 v195, s[72:75], s36 offen offset:3072 lds
    v_mfma_f32_16x16x32_bf16 v[156:159], a[216:219], a[60:63], v[156:159]
    ds_read_b64_tr_b16 a[206:207], v203 offset:2048
    v_mfma_f32_16x16x32_bf16 v[160:163], a[216:219], a[76:79], v[160:163]
    v_mfma_f32_16x16x32_bf16 v[164:167], a[216:219], a[92:95], v[164:167]
    v_mfma_f32_16x16x32_bf16 v[168:171], a[220:223], a[12:15], v[168:171]
    v_mfma_f32_16x16x32_bf16 v[172:175], a[220:223], a[28:31], v[172:175]
    v_mfma_f32_16x16x32_bf16 v[176:179], a[220:223], a[44:47], v[176:179]
    v_mfma_f32_16x16x32_bf16 v[180:183], a[220:223], a[60:63], v[180:183]
    v_mfma_f32_16x16x32_bf16 v[184:187], a[220:223], a[76:79], v[184:187]
    v_mfma_f32_16x16x32_bf16 v[188:191], a[220:223], a[92:95], v[188:191]
    s_waitcnt lgkmcnt(0)
    v_mfma_f32_16x16x32_bf16 v[96:99], a[192:195], a[96:99], v[96:99]
    v_mfma_f32_16x16x32_bf16 v[100:103], a[192:195], a[112:115], v[100:103]
    ds_read_b64_tr_b16 a[208:209], v200 offset:4096
    v_mfma_f32_16x16x32_bf16 v[104:107], a[192:195], a[128:131], v[104:107]
    v_mfma_f32_16x16x32_bf16 v[108:111], a[192:195], a[144:147], v[108:111]
    ds_read_b64_tr_b16 a[210:211], v200 offset:6144
    v_mfma_f32_16x16x32_bf16 v[112:115], a[192:195], a[160:163], v[112:115]
    v_mfma_f32_16x16x32_bf16 v[116:119], a[192:195], a[176:179], v[116:119]
    ds_read_b64_tr_b16 a[212:213], v201 offset:4096
    v_mfma_f32_16x16x32_bf16 v[120:123], a[196:199], a[96:99], v[120:123]
    v_mfma_f32_16x16x32_bf16 v[124:127], a[196:199], a[112:115], v[124:127]
    ds_read_b64_tr_b16 a[214:215], v201 offset:6144
    v_mfma_f32_16x16x32_bf16 v[128:131], a[196:199], a[128:131], v[128:131]
    v_mfma_f32_16x16x32_bf16 v[132:135], a[196:199], a[144:147], v[132:135]
    ds_read_b64_tr_b16 a[216:217], v202 offset:4096
    v_mfma_f32_16x16x32_bf16 v[136:139], a[196:199], a[160:163], v[136:139]
    v_mfma_f32_16x16x32_bf16 v[140:143], a[196:199], a[176:179], v[140:143]
    ds_read_b64_tr_b16 a[218:219], v202 offset:6144
    v_mfma_f32_16x16x32_bf16 v[144:147], a[200:203], a[96:99], v[144:147]
    v_mfma_f32_16x16x32_bf16 v[148:151], a[200:203], a[112:115], v[148:151]
    ds_read_b64_tr_b16 a[220:221], v203 offset:4096
    v_mfma_f32_16x16x32_bf16 v[152:155], a[200:203], a[128:131], v[152:155]
    v_mfma_f32_16x16x32_bf16 v[156:159], a[200:203], a[144:147], v[156:159]
    ds_read_b64_tr_b16 a[222:223], v203 offset:6144
    v_mfma_f32_16x16x32_bf16 v[160:163], a[200:203], a[160:163], v[160:163]
    v_mfma_f32_16x16x32_bf16 v[164:167], a[200:203], a[176:179], v[164:167]
    v_mfma_f32_16x16x32_bf16 v[168:171], a[204:207], a[96:99], v[168:171]
    v_mfma_f32_16x16x32_bf16 v[172:175], a[204:207], a[112:115], v[172:175]
    v_mfma_f32_16x16x32_bf16 v[176:179], a[204:207], a[128:131], v[176:179]
    v_mfma_f32_16x16x32_bf16 v[180:183], a[204:207], a[144:147], v[180:183]
    v_mfma_f32_16x16x32_bf16 v[184:187], a[204:207], a[160:163], v[184:187]
    v_mfma_f32_16x16x32_bf16 v[188:191], a[204:207], a[176:179], v[188:191]
    s_waitcnt lgkmcnt(0)
    v_mfma_f32_16x16x32_bf16 v[96:99], a[208:211], a[100:103], v[96:99]
    v_mfma_f32_16x16x32_bf16 v[100:103], a[208:211], a[116:119], v[100:103]
    ds_read_b64_tr_b16 a[192:193], v200 offset:8192
    v_mfma_f32_16x16x32_bf16 v[104:107], a[208:211], a[132:135], v[104:107]
    v_mfma_f32_16x16x32_bf16 v[108:111], a[208:211], a[148:151], v[108:111]
    ds_read_b64_tr_b16 a[194:195], v200 offset:10240
    v_mfma_f32_16x16x32_bf16 v[112:115], a[208:211], a[164:167], v[112:115]
    v_mfma_f32_16x16x32_bf16 v[116:119], a[208:211], a[180:183], v[116:119]
    ds_read_b64_tr_b16 a[196:197], v201 offset:8192
    v_mfma_f32_16x16x32_bf16 v[120:123], a[212:215], a[100:103], v[120:123]
    v_mfma_f32_16x16x32_bf16 v[124:127], a[212:215], a[116:119], v[124:127]
    ds_read_b64_tr_b16 a[198:199], v201 offset:10240
    v_mfma_f32_16x16x32_bf16 v[128:131], a[212:215], a[132:135], v[128:131]
    v_mfma_f32_16x16x32_bf16 v[132:135], a[212:215], a[148:151], v[132:135]
    ds_read_b64_tr_b16 a[200:201], v202 offset:8192
    v_mfma_f32_16x16x32_bf16 v[136:139], a[212:215], a[164:167], v[136:139]
    v_mfma_f32_16x16x32_bf16 v[140:143], a[212:215], a[180:183], v[140:143]
    ds_read_b64_tr_b16 a[202:203], v202 offset:10240
    v_mfma_f32_16x16x32_bf16 v[144:147], a[216:219], a[100:103], v[144:147]
    v_mfma_f32_16x16x32_bf16 v[148:151], a[216:219], a[116:119], v[148:151]
    ds_read_b64_tr_b16 a[204:205], v203 offset:8192
    v_mfma_f32_16x16x32_bf16 v[152:155], a[216:219], a[132:135], v[152:155]
    v_mfma_f32_16x16x32_bf16 v[156:159], a[216:219], a[148:151], v[156:159]
    ds_read_b64_tr_b16 a[206:207], v203 offset:10240
    v_mfma_f32_16x16x32_bf16 v[160:163], a[216:219], a[164:167], v[160:163]
    v_mfma_f32_16x16x32_bf16 v[164:167], a[216:219], a[180:183], v[164:167]
    v_mfma_f32_16x16x32_bf16 v[168:171], a[220:223], a[100:103], v[168:171]
    v_mfma_f32_16x16x32_bf16 v[172:175], a[220:223], a[116:119], v[172:175]
    v_mfma_f32_16x16x32_bf16 v[176:179], a[220:223], a[132:135], v[176:179]
    v_mfma_f32_16x16x32_bf16 v[180:183], a[220:223], a[148:151], v[180:183]
    v_mfma_f32_16x16x32_bf16 v[184:187], a[220:223], a[164:167], v[184:187]
    v_mfma_f32_16x16x32_bf16 v[188:191], a[220:223], a[180:183], v[188:191]
    s_waitcnt lgkmcnt(0)
    v_mfma_f32_16x16x32_bf16 v[96:99], a[192:195], a[104:107], v[96:99]
    v_mfma_f32_16x16x32_bf16 v[100:103], a[192:195], a[120:123], v[100:103]
    ds_read_b64_tr_b16 a[208:209], v200 offset:12288
    v_mfma_f32_16x16x32_bf16 v[104:107], a[192:195], a[136:139], v[104:107]
    v_mfma_f32_16x16x32_bf16 v[108:111], a[192:195], a[152:155], v[108:111]
    ds_read_b64_tr_b16 a[210:211], v200 offset:14336
    v_mfma_f32_16x16x32_bf16 v[112:115], a[192:195], a[168:171], v[112:115]
    v_mfma_f32_16x16x32_bf16 v[116:119], a[192:195], a[184:187], v[116:119]
    ds_read_b64_tr_b16 a[212:213], v201 offset:12288
    v_mfma_f32_16x16x32_bf16 v[120:123], a[196:199], a[104:107], v[120:123]
    v_mfma_f32_16x16x32_bf16 v[124:127], a[196:199], a[120:123], v[124:127]
    ds_read_b64_tr_b16 a[214:215], v201 offset:14336
    v_mfma_f32_16x16x32_bf16 v[128:131], a[196:199], a[136:139], v[128:131]
    v_mfma_f32_16x16x32_bf16 v[132:135], a[196:199], a[152:155], v[132:135]
    ds_read_b64_tr_b16 a[216:217], v202 offset:12288
    v_mfma_f32_16x16x32_bf16 v[136:139], a[196:199], a[168:171], v[136:139]
    v_mfma_f32_16x16x32_bf16 v[140:143], a[196:199], a[184:187], v[140:143]
    ds_read_b64_tr_b16 a[218:219], v202 offset:14336
    v_mfma_f32_16x16x32_bf16 v[144:147], a[200:203], a[104:107], v[144:147]
    v_mfma_f32_16x16x32_bf16 v[148:151], a[200:203], a[120:123], v[148:151]
    ds_read_b64_tr_b16 a[220:221], v203 offset:12288
    v_mfma_f32_16x16x32_bf16 v[152:155], a[200:203], a[136:139], v[152:155]
    v_mfma_f32_16x16x32_bf16 v[156:159], a[200:203], a[152:155], v[156:159]
    ds_read_b64_tr_b16 a[222:223], v203 offset:14336
    v_mfma_f32_16x16x32_bf16 v[160:163], a[200:203], a[168:171], v[160:163]
    v_mfma_f32_16x16x32_bf16 v[164:167], a[200:203], a[184:187], v[164:167]
    v_mfma_f32_16x16x32_bf16 v[168:171], a[204:207], a[104:107], v[168:171]
    v_mfma_f32_16x16x32_bf16 v[172:175], a[204:207], a[120:123], v[172:175]
    v_mfma_f32_16x16x32_bf16 v[176:179], a[204:207], a[136:139], v[176:179]
    v_mfma_f32_16x16x32_bf16 v[180:183], a[204:207], a[152:155], v[180:183]
    v_mfma_f32_16x16x32_bf16 v[184:187], a[204:207], a[168:171], v[184:187]
    v_mfma_f32_16x16x32_bf16 v[188:191], a[204:207], a[184:187], v[188:191]
    s_waitcnt lgkmcnt(0)
    s_waitcnt vmcnt(28)
    s_barrier
    v_xor_b32 v200, 0, v251
    v_lshl_add_u32 v200, v200, 5, v250
    v_add_u32 v200, 131072, v200
    v_xor_b32 v201, 1, v251
    v_lshl_add_u32 v201, v201, 5, v250
    v_add_u32 v201, 131072, v201
    v_xor_b32 v202, 2, v251
    v_lshl_add_u32 v202, v202, 5, v250
    v_add_u32 v202, 131072, v202
    v_xor_b32 v203, 3, v251
    v_lshl_add_u32 v203, v203, 5, v250
    v_add_u32 v203, 131072, v203
    v_mfma_f32_16x16x32_bf16 v[96:99], a[208:211], a[108:111], v[96:99]
    s_add_u32 m0, s39, 32768
    s_mov_b32 s36, 131456
    buffer_load_dwordx4 v192, s[72:75], s36 offen offset:0 lds
    v_mfma_f32_16x16x32_bf16 v[100:103], a[208:211], a[124:127], v[100:103]
    ds_read_b64_tr_b16 a[192:193], v200 offset:0
    v_mfma_f32_16x16x32_bf16 v[104:107], a[208:211], a[140:143], v[104:107]
    buffer_load_dwordx4 v193, s[72:75], s36 offen offset:1024 lds
    v_mfma_f32_16x16x32_bf16 v[108:111], a[208:211], a[156:159], v[108:111]
    ds_read_b64_tr_b16 a[194:195], v200 offset:2048
    v_mfma_f32_16x16x32_bf16 v[112:115], a[208:211], a[172:175], v[112:115]
    buffer_load_dwordx4 v194, s[72:75], s36 offen offset:2048 lds
    v_mfma_f32_16x16x32_bf16 v[116:119], a[208:211], a[188:191], v[116:119]
    ds_read_b64_tr_b16 a[196:197], v201 offset:0
    v_mfma_f32_16x16x32_bf16 v[120:123], a[212:215], a[108:111], v[120:123]
    buffer_load_dwordx4 v195, s[72:75], s36 offen offset:3072 lds
    v_mfma_f32_16x16x32_bf16 v[124:127], a[212:215], a[124:127], v[124:127]
    ds_read_b64_tr_b16 a[198:199], v201 offset:2048
    v_mfma_f32_16x16x32_bf16 v[128:131], a[212:215], a[140:143], v[128:131]
    s_add_u32 m0, s39, 36864
    s_mov_b32 s36, 164224
    buffer_load_dwordx4 v192, s[72:75], s36 offen offset:0 lds
    v_mfma_f32_16x16x32_bf16 v[132:135], a[212:215], a[156:159], v[132:135]
    ds_read_b64_tr_b16 a[200:201], v202 offset:0
    v_mfma_f32_16x16x32_bf16 v[136:139], a[212:215], a[172:175], v[136:139]
    buffer_load_dwordx4 v193, s[72:75], s36 offen offset:1024 lds
    v_mfma_f32_16x16x32_bf16 v[140:143], a[212:215], a[188:191], v[140:143]
    ds_read_b64_tr_b16 a[202:203], v202 offset:2048
    v_mfma_f32_16x16x32_bf16 v[144:147], a[216:219], a[108:111], v[144:147]
    buffer_load_dwordx4 v194, s[72:75], s36 offen offset:2048 lds
    v_mfma_f32_16x16x32_bf16 v[148:151], a[216:219], a[124:127], v[148:151]
    ds_read_b64_tr_b16 a[204:205], v203 offset:0
    v_mfma_f32_16x16x32_bf16 v[152:155], a[216:219], a[140:143], v[152:155]
    buffer_load_dwordx4 v195, s[72:75], s36 offen offset:3072 lds
    v_mfma_f32_16x16x32_bf16 v[156:159], a[216:219], a[156:159], v[156:159]
    ds_read_b64_tr_b16 a[206:207], v203 offset:2048
    v_mfma_f32_16x16x32_bf16 v[160:163], a[216:219], a[172:175], v[160:163]
    v_mfma_f32_16x16x32_bf16 v[164:167], a[216:219], a[188:191], v[164:167]
    v_mfma_f32_16x16x32_bf16 v[168:171], a[220:223], a[108:111], v[168:171]
    v_mfma_f32_16x16x32_bf16 v[172:175], a[220:223], a[124:127], v[172:175]
    v_mfma_f32_16x16x32_bf16 v[176:179], a[220:223], a[140:143], v[176:179]
    v_mfma_f32_16x16x32_bf16 v[180:183], a[220:223], a[156:159], v[180:183]
    v_mfma_f32_16x16x32_bf16 v[184:187], a[220:223], a[172:175], v[184:187]
    v_mfma_f32_16x16x32_bf16 v[188:191], a[220:223], a[188:191], v[188:191]
    s_waitcnt lgkmcnt(0)
    v_mfma_f32_16x16x32_bf16 v[0:3], a[192:195], a[0:3], 0
    v_mfma_f32_16x16x32_bf16 v[4:7], a[192:195], a[16:19], 0
    ds_read_b64_tr_b16 a[208:209], v200 offset:4096
    v_mfma_f32_16x16x32_bf16 v[8:11], a[192:195], a[32:35], 0
    v_mfma_f32_16x16x32_bf16 v[12:15], a[192:195], a[48:51], 0
    ds_read_b64_tr_b16 a[210:211], v200 offset:6144
    v_mfma_f32_16x16x32_bf16 v[16:19], a[192:195], a[64:67], 0
    v_cvt_pk_bf16_f32 v204, v96, v97
    v_cvt_pk_bf16_f32 v205, v98, v99
    v_mfma_f32_16x16x32_bf16 v[20:23], a[192:195], a[80:83], 0
    ds_read_b64_tr_b16 a[212:213], v201 offset:4096
    v_mfma_f32_16x16x32_bf16 v[24:27], a[196:199], a[0:3], 0
    v_cvt_pk_bf16_f32 v206, v120, v121
    v_cvt_pk_bf16_f32 v207, v122, v123
    v_mfma_f32_16x16x32_bf16 v[28:31], a[196:199], a[16:19], 0
    ds_read_b64_tr_b16 a[214:215], v201 offset:6144
    v_mfma_f32_16x16x32_bf16 v[32:35], a[196:199], a[32:35], 0
    s_mov_b32 s23, 12288
    buffer_store_dwordx4 v[204:207], v236, s[16:19], s23 offen offset:0 sc1
    v_mfma_f32_16x16x32_bf16 v[36:39], a[196:199], a[48:51], 0
    ds_read_b64_tr_b16 a[216:217], v202 offset:4096
    v_mfma_f32_16x16x32_bf16 v[40:43], a[196:199], a[64:67], 0
    v_cvt_pk_bf16_f32 v208, v100, v101
    v_cvt_pk_bf16_f32 v209, v102, v103
    v_mfma_f32_16x16x32_bf16 v[44:47], a[196:199], a[80:83], 0
    ds_read_b64_tr_b16 a[218:219], v202 offset:6144
    v_mfma_f32_16x16x32_bf16 v[48:51], a[200:203], a[0:3], 0
    v_cvt_pk_bf16_f32 v210, v124, v125
    v_cvt_pk_bf16_f32 v211, v126, v127
    v_mfma_f32_16x16x32_bf16 v[52:55], a[200:203], a[16:19], 0
    ds_read_b64_tr_b16 a[220:221], v203 offset:4096
    v_mfma_f32_16x16x32_bf16 v[56:59], a[200:203], a[32:35], 0
    buffer_store_dwordx4 v[208:211], v236, s[16:19], s23 offen offset:1024 sc1
    v_mfma_f32_16x16x32_bf16 v[60:63], a[200:203], a[48:51], 0
    ds_read_b64_tr_b16 a[222:223], v203 offset:6144
    v_mfma_f32_16x16x32_bf16 v[64:67], a[200:203], a[64:67], 0
    v_cvt_pk_bf16_f32 v212, v104, v105
    v_cvt_pk_bf16_f32 v213, v106, v107
    v_mfma_f32_16x16x32_bf16 v[68:71], a[200:203], a[80:83], 0
    v_cvt_pk_bf16_f32 v214, v128, v129
    v_cvt_pk_bf16_f32 v215, v130, v131
    v_mfma_f32_16x16x32_bf16 v[72:75], a[204:207], a[0:3], 0
    buffer_store_dwordx4 v[212:215], v236, s[16:19], s23 offen offset:2048 sc1
    v_mfma_f32_16x16x32_bf16 v[76:79], a[204:207], a[16:19], 0
    v_cvt_pk_bf16_f32 v216, v108, v109
    v_cvt_pk_bf16_f32 v217, v110, v111
    v_mfma_f32_16x16x32_bf16 v[80:83], a[204:207], a[32:35], 0
    v_cvt_pk_bf16_f32 v218, v132, v133
    v_cvt_pk_bf16_f32 v219, v134, v135
    v_mfma_f32_16x16x32_bf16 v[84:87], a[204:207], a[48:51], 0
    buffer_store_dwordx4 v[216:219], v236, s[16:19], s23 offen offset:3072 sc1
    v_mfma_f32_16x16x32_bf16 v[88:91], a[204:207], a[64:67], 0
    v_cvt_pk_bf16_f32 v204, v112, v113
    v_cvt_pk_bf16_f32 v205, v114, v115
    v_mfma_f32_16x16x32_bf16 v[92:95], a[204:207], a[80:83], 0
    v_cvt_pk_bf16_f32 v206, v136, v137
    v_cvt_pk_bf16_f32 v207, v138, v139
    s_waitcnt lgkmcnt(0)
    v_mfma_f32_16x16x32_bf16 v[0:3], a[208:211], a[4:7], v[0:3]
    s_mov_b32 s23, 16384
    buffer_store_dwordx4 v[204:207], v236, s[16:19], s23 offen offset:0 sc1
    v_mfma_f32_16x16x32_bf16 v[4:7], a[208:211], a[20:23], v[4:7]
    ds_read_b64_tr_b16 a[192:193], v200 offset:8192
    v_mfma_f32_16x16x32_bf16 v[8:11], a[208:211], a[36:39], v[8:11]
    v_cvt_pk_bf16_f32 v208, v116, v117
    v_cvt_pk_bf16_f32 v209, v118, v119
    v_mfma_f32_16x16x32_bf16 v[12:15], a[208:211], a[52:55], v[12:15]
    ds_read_b64_tr_b16 a[194:195], v200 offset:10240
    v_mfma_f32_16x16x32_bf16 v[16:19], a[208:211], a[68:71], v[16:19]
    v_cvt_pk_bf16_f32 v210, v140, v141
    v_cvt_pk_bf16_f32 v211, v142, v143
    v_mfma_f32_16x16x32_bf16 v[20:23], a[208:211], a[84:87], v[20:23]
    ds_read_b64_tr_b16 a[196:197], v201 offset:8192
    v_mfma_f32_16x16x32_bf16 v[24:27], a[212:215], a[4:7], v[24:27]
    buffer_store_dwordx4 v[208:211], v236, s[16:19], s23 offen offset:1024 sc1
    v_mfma_f32_16x16x32_bf16 v[28:31], a[212:215], a[20:23], v[28:31]
    ds_read_b64_tr_b16 a[198:199], v201 offset:10240
    v_mfma_f32_16x16x32_bf16 v[32:35], a[212:215], a[36:39], v[32:35]
    v_cvt_pk_bf16_f32 v212, v144, v145
    v_cvt_pk_bf16_f32 v213, v146, v147
    v_mfma_f32_16x16x32_bf16 v[36:39], a[212:215], a[52:55], v[36:39]
    ds_read_b64_tr_b16 a[200:201], v202 offset:8192
    v_mfma_f32_16x16x32_bf16 v[40:43], a[212:215], a[68:71], v[40:43]
    v_cvt_pk_bf16_f32 v214, v168, v169
    v_cvt_pk_bf16_f32 v215, v170, v171
    v_mfma_f32_16x16x32_bf16 v[44:47], a[212:215], a[84:87], v[44:47]
    ds_read_b64_tr_b16 a[202:203], v202 offset:10240
    v_mfma_f32_16x16x32_bf16 v[48:51], a[216:219], a[4:7], v[48:51]
    buffer_store_dwordx4 v[212:215], v236, s[16:19], s23 offen offset:2048 sc1
    v_mfma_f32_16x16x32_bf16 v[52:55], a[216:219], a[20:23], v[52:55]
    ds_read_b64_tr_b16 a[204:205], v203 offset:8192
    v_mfma_f32_16x16x32_bf16 v[56:59], a[216:219], a[36:39], v[56:59]
    v_cvt_pk_bf16_f32 v216, v148, v149
    v_cvt_pk_bf16_f32 v217, v150, v151
    v_mfma_f32_16x16x32_bf16 v[60:63], a[216:219], a[52:55], v[60:63]
    ds_read_b64_tr_b16 a[206:207], v203 offset:10240
    v_mfma_f32_16x16x32_bf16 v[64:67], a[216:219], a[68:71], v[64:67]
    v_cvt_pk_bf16_f32 v218, v172, v173
    v_cvt_pk_bf16_f32 v219, v174, v175
    v_mfma_f32_16x16x32_bf16 v[68:71], a[216:219], a[84:87], v[68:71]
    buffer_store_dwordx4 v[216:219], v236, s[16:19], s23 offen offset:3072 sc1
    v_mfma_f32_16x16x32_bf16 v[72:75], a[220:223], a[4:7], v[72:75]
    v_cvt_pk_bf16_f32 v204, v152, v153
    v_cvt_pk_bf16_f32 v205, v154, v155
    v_mfma_f32_16x16x32_bf16 v[76:79], a[220:223], a[20:23], v[76:79]
    v_cvt_pk_bf16_f32 v206, v176, v177
    v_cvt_pk_bf16_f32 v207, v178, v179
    v_mfma_f32_16x16x32_bf16 v[80:83], a[220:223], a[36:39], v[80:83]
    s_mov_b32 s23, 20480
    buffer_store_dwordx4 v[204:207], v236, s[16:19], s23 offen offset:0 sc1
    v_mfma_f32_16x16x32_bf16 v[84:87], a[220:223], a[52:55], v[84:87]
    v_cvt_pk_bf16_f32 v208, v156, v157
    v_cvt_pk_bf16_f32 v209, v158, v159
    v_mfma_f32_16x16x32_bf16 v[88:91], a[220:223], a[68:71], v[88:91]
    v_cvt_pk_bf16_f32 v210, v180, v181
    v_cvt_pk_bf16_f32 v211, v182, v183
    v_mfma_f32_16x16x32_bf16 v[92:95], a[220:223], a[84:87], v[92:95]
    buffer_store_dwordx4 v[208:211], v236, s[16:19], s23 offen offset:1024 sc1
    s_waitcnt lgkmcnt(0)
    v_mfma_f32_16x16x32_bf16 v[0:3], a[192:195], a[8:11], v[0:3]
    v_cvt_pk_bf16_f32 v212, v160, v161
    v_cvt_pk_bf16_f32 v213, v162, v163
    v_mfma_f32_16x16x32_bf16 v[4:7], a[192:195], a[24:27], v[4:7]
    ds_read_b64_tr_b16 a[208:209], v200 offset:12288
    v_mfma_f32_16x16x32_bf16 v[8:11], a[192:195], a[40:43], v[8:11]
    v_cvt_pk_bf16_f32 v214, v184, v185
    v_cvt_pk_bf16_f32 v215, v186, v187
    v_mfma_f32_16x16x32_bf16 v[12:15], a[192:195], a[56:59], v[12:15]
    ds_read_b64_tr_b16 a[210:211], v200 offset:14336
    v_mfma_f32_16x16x32_bf16 v[16:19], a[192:195], a[72:75], v[16:19]
    buffer_store_dwordx4 v[212:215], v236, s[16:19], s23 offen offset:2048 sc1
    v_mfma_f32_16x16x32_bf16 v[20:23], a[192:195], a[88:91], v[20:23]
    ds_read_b64_tr_b16 a[212:213], v201 offset:12288
    v_mfma_f32_16x16x32_bf16 v[24:27], a[196:199], a[8:11], v[24:27]
    v_cvt_pk_bf16_f32 v216, v164, v165
    v_cvt_pk_bf16_f32 v217, v166, v167
    v_mfma_f32_16x16x32_bf16 v[28:31], a[196:199], a[24:27], v[28:31]
    ds_read_b64_tr_b16 a[214:215], v201 offset:14336
    v_mfma_f32_16x16x32_bf16 v[32:35], a[196:199], a[40:43], v[32:35]
    v_cvt_pk_bf16_f32 v218, v188, v189
    v_cvt_pk_bf16_f32 v219, v190, v191
    v_mfma_f32_16x16x32_bf16 v[36:39], a[196:199], a[56:59], v[36:39]
    ds_read_b64_tr_b16 a[216:217], v202 offset:12288
    v_mfma_f32_16x16x32_bf16 v[40:43], a[196:199], a[72:75], v[40:43]
    buffer_store_dwordx4 v[216:219], v236, s[16:19], s23 offen offset:3072 sc1
    v_mfma_f32_16x16x32_bf16 v[44:47], a[196:199], a[88:91], v[44:47]
    ds_read_b64_tr_b16 a[218:219], v202 offset:14336
    v_mfma_f32_16x16x32_bf16 v[48:51], a[200:203], a[8:11], v[48:51]
    v_mfma_f32_16x16x32_bf16 v[52:55], a[200:203], a[24:27], v[52:55]
    ds_read_b64_tr_b16 a[220:221], v203 offset:12288
    v_mfma_f32_16x16x32_bf16 v[56:59], a[200:203], a[40:43], v[56:59]
    v_mfma_f32_16x16x32_bf16 v[60:63], a[200:203], a[56:59], v[60:63]
    ds_read_b64_tr_b16 a[222:223], v203 offset:14336
    v_mfma_f32_16x16x32_bf16 v[64:67], a[200:203], a[72:75], v[64:67]
    v_mfma_f32_16x16x32_bf16 v[68:71], a[200:203], a[88:91], v[68:71]
    v_mfma_f32_16x16x32_bf16 v[72:75], a[204:207], a[8:11], v[72:75]
    v_mfma_f32_16x16x32_bf16 v[76:79], a[204:207], a[24:27], v[76:79]
    v_mfma_f32_16x16x32_bf16 v[80:83], a[204:207], a[40:43], v[80:83]
    v_mfma_f32_16x16x32_bf16 v[84:87], a[204:207], a[56:59], v[84:87]
    v_mfma_f32_16x16x32_bf16 v[88:91], a[204:207], a[72:75], v[88:91]
    v_mfma_f32_16x16x32_bf16 v[92:95], a[204:207], a[88:91], v[92:95]
    s_waitcnt lgkmcnt(0)
    s_waitcnt vmcnt(40)
    s_barrier
    v_xor_b32 v200, 0, v251
    v_lshl_add_u32 v200, v200, 5, v250
    v_add_u32 v200, 65536, v200
    v_xor_b32 v201, 1, v251
    v_lshl_add_u32 v201, v201, 5, v250
    v_add_u32 v201, 65536, v201
    v_xor_b32 v202, 2, v251
    v_lshl_add_u32 v202, v202, 5, v250
    v_add_u32 v202, 65536, v202
    v_xor_b32 v203, 3, v251
    v_lshl_add_u32 v203, v203, 5, v250
    v_add_u32 v203, 65536, v203
    v_mfma_f32_16x16x32_bf16 v[0:3], a[208:211], a[12:15], v[0:3]
    v_mfma_f32_16x16x32_bf16 v[4:7], a[208:211], a[28:31], v[4:7]
    ds_read_b64_tr_b16 a[192:193], v200 offset:0
    v_mfma_f32_16x16x32_bf16 v[8:11], a[208:211], a[44:47], v[8:11]
    v_mfma_f32_16x16x32_bf16 v[12:15], a[208:211], a[60:63], v[12:15]
    ds_read_b64_tr_b16 a[194:195], v200 offset:2048
    v_mfma_f32_16x16x32_bf16 v[16:19], a[208:211], a[76:79], v[16:19]
    v_mfma_f32_16x16x32_bf16 v[20:23], a[208:211], a[92:95], v[20:23]
    ds_read_b64_tr_b16 a[196:197], v201 offset:0
    v_mfma_f32_16x16x32_bf16 v[24:27], a[212:215], a[12:15], v[24:27]
    v_mfma_f32_16x16x32_bf16 v[28:31], a[212:215], a[28:31], v[28:31]
    ds_read_b64_tr_b16 a[198:199], v201 offset:2048
    v_mfma_f32_16x16x32_bf16 v[32:35], a[212:215], a[44:47], v[32:35]
    v_mfma_f32_16x16x32_bf16 v[36:39], a[212:215], a[60:63], v[36:39]
    ds_read_b64_tr_b16 a[200:201], v202 offset:0
    v_mfma_f32_16x16x32_bf16 v[40:43], a[212:215], a[76:79], v[40:43]
    v_mfma_f32_16x16x32_bf16 v[44:47], a[212:215], a[92:95], v[44:47]
    ds_read_b64_tr_b16 a[202:203], v202 offset:2048
    v_mfma_f32_16x16x32_bf16 v[48:51], a[216:219], a[12:15], v[48:51]
    v_mfma_f32_16x16x32_bf16 v[52:55], a[216:219], a[28:31], v[52:55]
    ds_read_b64_tr_b16 a[204:205], v203 offset:0
    v_mfma_f32_16x16x32_bf16 v[56:59], a[216:219], a[44:47], v[56:59]
    v_mfma_f32_16x16x32_bf16 v[60:63], a[216:219], a[60:63], v[60:63]
    ds_read_b64_tr_b16 a[206:207], v203 offset:2048
    v_mfma_f32_16x16x32_bf16 v[64:67], a[216:219], a[76:79], v[64:67]
    v_mfma_f32_16x16x32_bf16 v[68:71], a[216:219], a[92:95], v[68:71]
    v_mfma_f32_16x16x32_bf16 v[72:75], a[220:223], a[12:15], v[72:75]
    v_mfma_f32_16x16x32_bf16 v[76:79], a[220:223], a[28:31], v[76:79]
    v_mfma_f32_16x16x32_bf16 v[80:83], a[220:223], a[44:47], v[80:83]
    v_mfma_f32_16x16x32_bf16 v[84:87], a[220:223], a[60:63], v[84:87]
    v_mfma_f32_16x16x32_bf16 v[88:91], a[220:223], a[76:79], v[88:91]
    v_mfma_f32_16x16x32_bf16 v[92:95], a[220:223], a[92:95], v[92:95]
    s_waitcnt lgkmcnt(0)
    v_mfma_f32_16x16x32_bf16 v[0:3], a[192:195], a[96:99], v[0:3]
    v_mfma_f32_16x16x32_bf16 v[4:7], a[192:195], a[112:115], v[4:7]
    ds_read_b64_tr_b16 a[208:209], v200 offset:4096
    v_mfma_f32_16x16x32_bf16 v[8:11], a[192:195], a[128:131], v[8:11]
    v_mfma_f32_16x16x32_bf16 v[12:15], a[192:195], a[144:147], v[12:15]
    ds_read_b64_tr_b16 a[210:211], v200 offset:6144
    v_mfma_f32_16x16x32_bf16 v[16:19], a[192:195], a[160:163], v[16:19]
    v_mfma_f32_16x16x32_bf16 v[20:23], a[192:195], a[176:179], v[20:23]
    ds_read_b64_tr_b16 a[212:213], v201 offset:4096
    v_mfma_f32_16x16x32_bf16 v[24:27], a[196:199], a[96:99], v[24:27]
    v_mfma_f32_16x16x32_bf16 v[28:31], a[196:199], a[112:115], v[28:31]
    ds_read_b64_tr_b16 a[214:215], v201 offset:6144
    v_mfma_f32_16x16x32_bf16 v[32:35], a[196:199], a[128:131], v[32:35]
    v_mfma_f32_16x16x32_bf16 v[36:39], a[196:199], a[144:147], v[36:39]
    ds_read_b64_tr_b16 a[216:217], v202 offset:4096
    v_mfma_f32_16x16x32_bf16 v[40:43], a[196:199], a[160:163], v[40:43]
    v_mfma_f32_16x16x32_bf16 v[44:47], a[196:199], a[176:179], v[44:47]
    ds_read_b64_tr_b16 a[218:219], v202 offset:6144
    v_mfma_f32_16x16x32_bf16 v[48:51], a[200:203], a[96:99], v[48:51]
    v_mfma_f32_16x16x32_bf16 v[52:55], a[200:203], a[112:115], v[52:55]
    ds_read_b64_tr_b16 a[220:221], v203 offset:4096
    v_mfma_f32_16x16x32_bf16 v[56:59], a[200:203], a[128:131], v[56:59]
    v_mfma_f32_16x16x32_bf16 v[60:63], a[200:203], a[144:147], v[60:63]
    ds_read_b64_tr_b16 a[222:223], v203 offset:6144
    v_mfma_f32_16x16x32_bf16 v[64:67], a[200:203], a[160:163], v[64:67]
    v_mfma_f32_16x16x32_bf16 v[68:71], a[200:203], a[176:179], v[68:71]
    v_mfma_f32_16x16x32_bf16 v[72:75], a[204:207], a[96:99], v[72:75]
    v_mfma_f32_16x16x32_bf16 v[76:79], a[204:207], a[112:115], v[76:79]
    v_mfma_f32_16x16x32_bf16 v[80:83], a[204:207], a[128:131], v[80:83]
    v_mfma_f32_16x16x32_bf16 v[84:87], a[204:207], a[144:147], v[84:87]
    v_mfma_f32_16x16x32_bf16 v[88:91], a[204:207], a[160:163], v[88:91]
    v_mfma_f32_16x16x32_bf16 v[92:95], a[204:207], a[176:179], v[92:95]
    s_waitcnt lgkmcnt(0)
    v_mfma_f32_16x16x32_bf16 v[0:3], a[208:211], a[100:103], v[0:3]
    v_mfma_f32_16x16x32_bf16 v[4:7], a[208:211], a[116:119], v[4:7]
    ds_read_b64_tr_b16 a[192:193], v200 offset:8192
    v_mfma_f32_16x16x32_bf16 v[8:11], a[208:211], a[132:135], v[8:11]
    v_mfma_f32_16x16x32_bf16 v[12:15], a[208:211], a[148:151], v[12:15]
    ds_read_b64_tr_b16 a[194:195], v200 offset:10240
    v_mfma_f32_16x16x32_bf16 v[16:19], a[208:211], a[164:167], v[16:19]
    v_mfma_f32_16x16x32_bf16 v[20:23], a[208:211], a[180:183], v[20:23]
    ds_read_b64_tr_b16 a[196:197], v201 offset:8192
    v_mfma_f32_16x16x32_bf16 v[24:27], a[212:215], a[100:103], v[24:27]
    v_mfma_f32_16x16x32_bf16 v[28:31], a[212:215], a[116:119], v[28:31]
    ds_read_b64_tr_b16 a[198:199], v201 offset:10240
    v_mfma_f32_16x16x32_bf16 v[32:35], a[212:215], a[132:135], v[32:35]
    v_mfma_f32_16x16x32_bf16 v[36:39], a[212:215], a[148:151], v[36:39]
    ds_read_b64_tr_b16 a[200:201], v202 offset:8192
    v_mfma_f32_16x16x32_bf16 v[40:43], a[212:215], a[164:167], v[40:43]
    v_mfma_f32_16x16x32_bf16 v[44:47], a[212:215], a[180:183], v[44:47]
    ds_read_b64_tr_b16 a[202:203], v202 offset:10240
    v_mfma_f32_16x16x32_bf16 v[48:51], a[216:219], a[100:103], v[48:51]
    v_mfma_f32_16x16x32_bf16 v[52:55], a[216:219], a[116:119], v[52:55]
    ds_read_b64_tr_b16 a[204:205], v203 offset:8192
    v_mfma_f32_16x16x32_bf16 v[56:59], a[216:219], a[132:135], v[56:59]
    v_mfma_f32_16x16x32_bf16 v[60:63], a[216:219], a[148:151], v[60:63]
    ds_read_b64_tr_b16 a[206:207], v203 offset:10240
    v_mfma_f32_16x16x32_bf16 v[64:67], a[216:219], a[164:167], v[64:67]
    v_mfma_f32_16x16x32_bf16 v[68:71], a[216:219], a[180:183], v[68:71]
    v_mfma_f32_16x16x32_bf16 v[72:75], a[220:223], a[100:103], v[72:75]
    v_mfma_f32_16x16x32_bf16 v[76:79], a[220:223], a[116:119], v[76:79]
    v_mfma_f32_16x16x32_bf16 v[80:83], a[220:223], a[132:135], v[80:83]
    v_mfma_f32_16x16x32_bf16 v[84:87], a[220:223], a[148:151], v[84:87]
    v_mfma_f32_16x16x32_bf16 v[88:91], a[220:223], a[164:167], v[88:91]
    v_mfma_f32_16x16x32_bf16 v[92:95], a[220:223], a[180:183], v[92:95]
    s_waitcnt lgkmcnt(0)
    v_mfma_f32_16x16x32_bf16 v[0:3], a[192:195], a[104:107], v[0:3]
    v_mfma_f32_16x16x32_bf16 v[4:7], a[192:195], a[120:123], v[4:7]
    ds_read_b64_tr_b16 a[208:209], v200 offset:12288
    v_mfma_f32_16x16x32_bf16 v[8:11], a[192:195], a[136:139], v[8:11]
    v_mfma_f32_16x16x32_bf16 v[12:15], a[192:195], a[152:155], v[12:15]
    ds_read_b64_tr_b16 a[210:211], v200 offset:14336
    v_mfma_f32_16x16x32_bf16 v[16:19], a[192:195], a[168:171], v[16:19]
    v_mfma_f32_16x16x32_bf16 v[20:23], a[192:195], a[184:187], v[20:23]
    ds_read_b64_tr_b16 a[212:213], v201 offset:12288
    v_mfma_f32_16x16x32_bf16 v[24:27], a[196:199], a[104:107], v[24:27]
    v_mfma_f32_16x16x32_bf16 v[28:31], a[196:199], a[120:123], v[28:31]
    ds_read_b64_tr_b16 a[214:215], v201 offset:14336
    v_mfma_f32_16x16x32_bf16 v[32:35], a[196:199], a[136:139], v[32:35]
    v_mfma_f32_16x16x32_bf16 v[36:39], a[196:199], a[152:155], v[36:39]
    ds_read_b64_tr_b16 a[216:217], v202 offset:12288
    v_mfma_f32_16x16x32_bf16 v[40:43], a[196:199], a[168:171], v[40:43]
    v_mfma_f32_16x16x32_bf16 v[44:47], a[196:199], a[184:187], v[44:47]
    ds_read_b64_tr_b16 a[218:219], v202 offset:14336
    v_mfma_f32_16x16x32_bf16 v[48:51], a[200:203], a[104:107], v[48:51]
    v_mfma_f32_16x16x32_bf16 v[52:55], a[200:203], a[120:123], v[52:55]
    ds_read_b64_tr_b16 a[220:221], v203 offset:12288
    v_mfma_f32_16x16x32_bf16 v[56:59], a[200:203], a[136:139], v[56:59]
    v_mfma_f32_16x16x32_bf16 v[60:63], a[200:203], a[152:155], v[60:63]
    ds_read_b64_tr_b16 a[222:223], v203 offset:14336
    v_mfma_f32_16x16x32_bf16 v[64:67], a[200:203], a[168:171], v[64:67]
    v_mfma_f32_16x16x32_bf16 v[68:71], a[200:203], a[184:187], v[68:71]
    v_mfma_f32_16x16x32_bf16 v[72:75], a[204:207], a[104:107], v[72:75]
    v_mfma_f32_16x16x32_bf16 v[76:79], a[204:207], a[120:123], v[76:79]
    v_mfma_f32_16x16x32_bf16 v[80:83], a[204:207], a[136:139], v[80:83]
    v_mfma_f32_16x16x32_bf16 v[84:87], a[204:207], a[152:155], v[84:87]
    v_mfma_f32_16x16x32_bf16 v[88:91], a[204:207], a[168:171], v[88:91]
    v_mfma_f32_16x16x32_bf16 v[92:95], a[204:207], a[184:187], v[92:95]
    s_waitcnt lgkmcnt(0)
    s_waitcnt vmcnt(20)
    s_barrier
    v_xor_b32 v200, 0, v251
    v_lshl_add_u32 v200, v200, 5, v250
    v_xor_b32 v201, 1, v251
    v_lshl_add_u32 v201, v201, 5, v250
    v_xor_b32 v202, 2, v251
    v_lshl_add_u32 v202, v202, 5, v250
    v_xor_b32 v203, 3, v251
    v_lshl_add_u32 v203, v203, 5, v250
    v_mfma_f32_16x16x32_bf16 v[0:3], a[208:211], a[108:111], v[0:3]
    v_mfma_f32_16x16x32_bf16 v[4:7], a[208:211], a[124:127], v[4:7]
    ds_read_b64_tr_b16 a[192:193], v200 offset:0
    v_mfma_f32_16x16x32_bf16 v[8:11], a[208:211], a[140:143], v[8:11]
    v_mfma_f32_16x16x32_bf16 v[12:15], a[208:211], a[156:159], v[12:15]
    ds_read_b64_tr_b16 a[194:195], v200 offset:2048
    v_mfma_f32_16x16x32_bf16 v[16:19], a[208:211], a[172:175], v[16:19]
    v_mfma_f32_16x16x32_bf16 v[20:23], a[208:211], a[188:191], v[20:23]
    ds_read_b64_tr_b16 a[196:197], v201 offset:0
    v_mfma_f32_16x16x32_bf16 v[24:27], a[212:215], a[108:111], v[24:27]
    v_mfma_f32_16x16x32_bf16 v[28:31], a[212:215], a[124:127], v[28:31]
    ds_read_b64_tr_b16 a[198:199], v201 offset:2048
    v_mfma_f32_16x16x32_bf16 v[32:35], a[212:215], a[140:143], v[32:35]
    v_mfma_f32_16x16x32_bf16 v[36:39], a[212:215], a[156:159], v[36:39]
    ds_read_b64_tr_b16 a[200:201], v202 offset:0
    v_mfma_f32_16x16x32_bf16 v[40:43], a[212:215], a[172:175], v[40:43]
    v_mfma_f32_16x16x32_bf16 v[44:47], a[212:215], a[188:191], v[44:47]
    ds_read_b64_tr_b16 a[202:203], v202 offset:2048
    v_mfma_f32_16x16x32_bf16 v[48:51], a[216:219], a[108:111], v[48:51]
    v_mfma_f32_16x16x32_bf16 v[52:55], a[216:219], a[124:127], v[52:55]
    ds_read_b64_tr_b16 a[204:205], v203 offset:0
    v_mfma_f32_16x16x32_bf16 v[56:59], a[216:219], a[140:143], v[56:59]
    v_mfma_f32_16x16x32_bf16 v[60:63], a[216:219], a[156:159], v[60:63]
    ds_read_b64_tr_b16 a[206:207], v203 offset:2048
    v_mfma_f32_16x16x32_bf16 v[64:67], a[216:219], a[172:175], v[64:67]
    v_mfma_f32_16x16x32_bf16 v[68:71], a[216:219], a[188:191], v[68:71]
    v_mfma_f32_16x16x32_bf16 v[72:75], a[220:223], a[108:111], v[72:75]
    v_mfma_f32_16x16x32_bf16 v[76:79], a[220:223], a[124:127], v[76:79]
    v_mfma_f32_16x16x32_bf16 v[80:83], a[220:223], a[140:143], v[80:83]
    v_mfma_f32_16x16x32_bf16 v[84:87], a[220:223], a[156:159], v[84:87]
    v_mfma_f32_16x16x32_bf16 v[88:91], a[220:223], a[172:175], v[88:91]
    v_mfma_f32_16x16x32_bf16 v[92:95], a[220:223], a[188:191], v[92:95]
    s_waitcnt lgkmcnt(0)
    v_mfma_f32_16x16x32_bf16 v[96:99], a[192:195], a[0:3], 0
    v_mfma_f32_16x16x32_bf16 v[100:103], a[192:195], a[16:19], 0
    ds_read_b64_tr_b16 a[208:209], v200 offset:4096
    v_mfma_f32_16x16x32_bf16 v[104:107], a[192:195], a[32:35], 0
    v_mfma_f32_16x16x32_bf16 v[108:111], a[192:195], a[48:51], 0
    ds_read_b64_tr_b16 a[210:211], v200 offset:6144
    v_mfma_f32_16x16x32_bf16 v[112:115], a[192:195], a[64:67], 0
    v_cvt_pk_bf16_f32 v204, v0, v1
    v_cvt_pk_bf16_f32 v205, v2, v3
    v_mfma_f32_16x16x32_bf16 v[116:119], a[192:195], a[80:83], 0
    ds_read_b64_tr_b16 a[212:213], v201 offset:4096
    v_mfma_f32_16x16x32_bf16 v[120:123], a[196:199], a[0:3], 0
    v_cvt_pk_bf16_f32 v206, v24, v25
    v_cvt_pk_bf16_f32 v207, v26, v27
    v_mfma_f32_16x16x32_bf16 v[124:127], a[196:199], a[16:19], 0
    ds_read_b64_tr_b16 a[214:215], v201 offset:6144
    v_mfma_f32_16x16x32_bf16 v[128:131], a[196:199], a[32:35], 0
    s_mov_b32 s23, 24576
    buffer_store_dwordx4 v[204:207], v236, s[16:19], s23 offen offset:0 sc1
    v_mfma_f32_16x16x32_bf16 v[132:135], a[196:199], a[48:51], 0
    ds_read_b64_tr_b16 a[216:217], v202 offset:4096
    v_mfma_f32_16x16x32_bf16 v[136:139], a[196:199], a[64:67], 0
    v_cvt_pk_bf16_f32 v208, v4, v5
    v_cvt_pk_bf16_f32 v209, v6, v7
    v_mfma_f32_16x16x32_bf16 v[140:143], a[196:199], a[80:83], 0
    ds_read_b64_tr_b16 a[218:219], v202 offset:6144
    v_mfma_f32_16x16x32_bf16 v[144:147], a[200:203], a[0:3], 0
    v_cvt_pk_bf16_f32 v210, v28, v29
    v_cvt_pk_bf16_f32 v211, v30, v31
    v_mfma_f32_16x16x32_bf16 v[148:151], a[200:203], a[16:19], 0
    ds_read_b64_tr_b16 a[220:221], v203 offset:4096
    v_mfma_f32_16x16x32_bf16 v[152:155], a[200:203], a[32:35], 0
    buffer_store_dwordx4 v[208:211], v236, s[16:19], s23 offen offset:1024 sc1
    v_mfma_f32_16x16x32_bf16 v[156:159], a[200:203], a[48:51], 0
    ds_read_b64_tr_b16 a[222:223], v203 offset:6144
    v_mfma_f32_16x16x32_bf16 v[160:163], a[200:203], a[64:67], 0
    v_cvt_pk_bf16_f32 v212, v8, v9
    v_cvt_pk_bf16_f32 v213, v10, v11
    v_mfma_f32_16x16x32_bf16 v[164:167], a[200:203], a[80:83], 0
    v_cvt_pk_bf16_f32 v214, v32, v33
    v_cvt_pk_bf16_f32 v215, v34, v35
    v_mfma_f32_16x16x32_bf16 v[168:171], a[204:207], a[0:3], 0
    buffer_store_dwordx4 v[212:215], v236, s[16:19], s23 offen offset:2048 sc1
    v_mfma_f32_16x16x32_bf16 v[172:175], a[204:207], a[16:19], 0
    v_cvt_pk_bf16_f32 v216, v12, v13
    v_cvt_pk_bf16_f32 v217, v14, v15
    v_mfma_f32_16x16x32_bf16 v[176:179], a[204:207], a[32:35], 0
    v_cvt_pk_bf16_f32 v218, v36, v37
    v_cvt_pk_bf16_f32 v219, v38, v39
    v_mfma_f32_16x16x32_bf16 v[180:183], a[204:207], a[48:51], 0
    buffer_store_dwordx4 v[216:219], v236, s[16:19], s23 offen offset:3072 sc1
    v_mfma_f32_16x16x32_bf16 v[184:187], a[204:207], a[64:67], 0
    v_cvt_pk_bf16_f32 v204, v16, v17
    v_cvt_pk_bf16_f32 v205, v18, v19
    v_mfma_f32_16x16x32_bf16 v[188:191], a[204:207], a[80:83], 0
    v_cvt_pk_bf16_f32 v206, v40, v41
    v_cvt_pk_bf16_f32 v207, v42, v43
    s_waitcnt lgkmcnt(0)
    v_mfma_f32_16x16x32_bf16 v[96:99], a[208:211], a[4:7], v[96:99]
    s_mov_b32 s23, 28672
    buffer_store_dwordx4 v[204:207], v236, s[16:19], s23 offen offset:0 sc1
    v_mfma_f32_16x16x32_bf16 v[100:103], a[208:211], a[20:23], v[100:103]
    ds_read_b64_tr_b16 a[192:193], v200 offset:8192
    v_mfma_f32_16x16x32_bf16 v[104:107], a[208:211], a[36:39], v[104:107]
    v_cvt_pk_bf16_f32 v208, v20, v21
    v_cvt_pk_bf16_f32 v209, v22, v23
    v_mfma_f32_16x16x32_bf16 v[108:111], a[208:211], a[52:55], v[108:111]
    ds_read_b64_tr_b16 a[194:195], v200 offset:10240
    v_mfma_f32_16x16x32_bf16 v[112:115], a[208:211], a[68:71], v[112:115]
    v_cvt_pk_bf16_f32 v210, v44, v45
    v_cvt_pk_bf16_f32 v211, v46, v47
    v_mfma_f32_16x16x32_bf16 v[116:119], a[208:211], a[84:87], v[116:119]
    ds_read_b64_tr_b16 a[196:197], v201 offset:8192
    v_mfma_f32_16x16x32_bf16 v[120:123], a[212:215], a[4:7], v[120:123]
    buffer_store_dwordx4 v[208:211], v236, s[16:19], s23 offen offset:1024 sc1
    v_mfma_f32_16x16x32_bf16 v[124:127], a[212:215], a[20:23], v[124:127]
    ds_read_b64_tr_b16 a[198:199], v201 offset:10240
    v_mfma_f32_16x16x32_bf16 v[128:131], a[212:215], a[36:39], v[128:131]
    v_cvt_pk_bf16_f32 v212, v48, v49
    v_cvt_pk_bf16_f32 v213, v50, v51
    v_mfma_f32_16x16x32_bf16 v[132:135], a[212:215], a[52:55], v[132:135]
    ds_read_b64_tr_b16 a[200:201], v202 offset:8192
    v_mfma_f32_16x16x32_bf16 v[136:139], a[212:215], a[68:71], v[136:139]
    v_cvt_pk_bf16_f32 v214, v72, v73
    v_cvt_pk_bf16_f32 v215, v74, v75
    v_mfma_f32_16x16x32_bf16 v[140:143], a[212:215], a[84:87], v[140:143]
    ds_read_b64_tr_b16 a[202:203], v202 offset:10240
    v_mfma_f32_16x16x32_bf16 v[144:147], a[216:219], a[4:7], v[144:147]
    buffer_store_dwordx4 v[212:215], v236, s[16:19], s23 offen offset:2048 sc1
    v_mfma_f32_16x16x32_bf16 v[148:151], a[216:219], a[20:23], v[148:151]
    ds_read_b64_tr_b16 a[204:205], v203 offset:8192
    v_mfma_f32_16x16x32_bf16 v[152:155], a[216:219], a[36:39], v[152:155]
    v_cvt_pk_bf16_f32 v216, v52, v53
    v_cvt_pk_bf16_f32 v217, v54, v55
    v_mfma_f32_16x16x32_bf16 v[156:159], a[216:219], a[52:55], v[156:159]
    ds_read_b64_tr_b16 a[206:207], v203 offset:10240
    v_mfma_f32_16x16x32_bf16 v[160:163], a[216:219], a[68:71], v[160:163]
    v_cvt_pk_bf16_f32 v218, v76, v77
    v_cvt_pk_bf16_f32 v219, v78, v79
    v_mfma_f32_16x16x32_bf16 v[164:167], a[216:219], a[84:87], v[164:167]
    buffer_store_dwordx4 v[216:219], v236, s[16:19], s23 offen offset:3072 sc1
    v_mfma_f32_16x16x32_bf16 v[168:171], a[220:223], a[4:7], v[168:171]
    v_cvt_pk_bf16_f32 v204, v56, v57
    v_cvt_pk_bf16_f32 v205, v58, v59
    v_mfma_f32_16x16x32_bf16 v[172:175], a[220:223], a[20:23], v[172:175]
    v_cvt_pk_bf16_f32 v206, v80, v81
    v_cvt_pk_bf16_f32 v207, v82, v83
    v_mfma_f32_16x16x32_bf16 v[176:179], a[220:223], a[36:39], v[176:179]
    s_mov_b32 s23, 32768
    buffer_store_dwordx4 v[204:207], v236, s[16:19], s23 offen offset:0 sc1
    v_mfma_f32_16x16x32_bf16 v[180:183], a[220:223], a[52:55], v[180:183]
    v_cvt_pk_bf16_f32 v208, v60, v61
    v_cvt_pk_bf16_f32 v209, v62, v63
    v_mfma_f32_16x16x32_bf16 v[184:187], a[220:223], a[68:71], v[184:187]
    v_cvt_pk_bf16_f32 v210, v84, v85
    v_cvt_pk_bf16_f32 v211, v86, v87
    v_mfma_f32_16x16x32_bf16 v[188:191], a[220:223], a[84:87], v[188:191]
    buffer_store_dwordx4 v[208:211], v236, s[16:19], s23 offen offset:1024 sc1
    s_waitcnt lgkmcnt(0)
    v_mfma_f32_16x16x32_bf16 v[96:99], a[192:195], a[8:11], v[96:99]
    v_cvt_pk_bf16_f32 v212, v64, v65
    v_cvt_pk_bf16_f32 v213, v66, v67
    v_mfma_f32_16x16x32_bf16 v[100:103], a[192:195], a[24:27], v[100:103]
    ds_read_b64_tr_b16 a[208:209], v200 offset:12288
    v_mfma_f32_16x16x32_bf16 v[104:107], a[192:195], a[40:43], v[104:107]
    v_cvt_pk_bf16_f32 v214, v88, v89
    v_cvt_pk_bf16_f32 v215, v90, v91
    v_mfma_f32_16x16x32_bf16 v[108:111], a[192:195], a[56:59], v[108:111]
    ds_read_b64_tr_b16 a[210:211], v200 offset:14336
    v_mfma_f32_16x16x32_bf16 v[112:115], a[192:195], a[72:75], v[112:115]
    buffer_store_dwordx4 v[212:215], v236, s[16:19], s23 offen offset:2048 sc1
    v_mfma_f32_16x16x32_bf16 v[116:119], a[192:195], a[88:91], v[116:119]
    ds_read_b64_tr_b16 a[212:213], v201 offset:12288
    v_mfma_f32_16x16x32_bf16 v[120:123], a[196:199], a[8:11], v[120:123]
    v_cvt_pk_bf16_f32 v216, v68, v69
    v_cvt_pk_bf16_f32 v217, v70, v71
    v_mfma_f32_16x16x32_bf16 v[124:127], a[196:199], a[24:27], v[124:127]
    ds_read_b64_tr_b16 a[214:215], v201 offset:14336
    v_mfma_f32_16x16x32_bf16 v[128:131], a[196:199], a[40:43], v[128:131]
    v_cvt_pk_bf16_f32 v218, v92, v93
    v_cvt_pk_bf16_f32 v219, v94, v95
    v_mfma_f32_16x16x32_bf16 v[132:135], a[196:199], a[56:59], v[132:135]
    ds_read_b64_tr_b16 a[216:217], v202 offset:12288
    v_mfma_f32_16x16x32_bf16 v[136:139], a[196:199], a[72:75], v[136:139]
    buffer_store_dwordx4 v[216:219], v236, s[16:19], s23 offen offset:3072 sc1
    v_mfma_f32_16x16x32_bf16 v[140:143], a[196:199], a[88:91], v[140:143]
    ds_read_b64_tr_b16 a[218:219], v202 offset:14336
    v_mfma_f32_16x16x32_bf16 v[144:147], a[200:203], a[8:11], v[144:147]
    v_mfma_f32_16x16x32_bf16 v[148:151], a[200:203], a[24:27], v[148:151]
    ds_read_b64_tr_b16 a[220:221], v203 offset:12288
    v_mfma_f32_16x16x32_bf16 v[152:155], a[200:203], a[40:43], v[152:155]
    v_mfma_f32_16x16x32_bf16 v[156:159], a[200:203], a[56:59], v[156:159]
    ds_read_b64_tr_b16 a[222:223], v203 offset:14336
    v_mfma_f32_16x16x32_bf16 v[160:163], a[200:203], a[72:75], v[160:163]
    v_mfma_f32_16x16x32_bf16 v[164:167], a[200:203], a[88:91], v[164:167]
    v_mfma_f32_16x16x32_bf16 v[168:171], a[204:207], a[8:11], v[168:171]
    v_mfma_f32_16x16x32_bf16 v[172:175], a[204:207], a[24:27], v[172:175]
    v_mfma_f32_16x16x32_bf16 v[176:179], a[204:207], a[40:43], v[176:179]
    v_mfma_f32_16x16x32_bf16 v[180:183], a[204:207], a[56:59], v[180:183]
    v_mfma_f32_16x16x32_bf16 v[184:187], a[204:207], a[72:75], v[184:187]
    v_mfma_f32_16x16x32_bf16 v[188:191], a[204:207], a[88:91], v[188:191]
    s_waitcnt lgkmcnt(0)
    s_waitcnt vmcnt(24)
    s_barrier
    v_xor_b32 v200, 0, v251
    v_lshl_add_u32 v200, v200, 5, v250
    v_add_u32 v200, 32768, v200
    v_xor_b32 v201, 1, v251
    v_lshl_add_u32 v201, v201, 5, v250
    v_add_u32 v201, 32768, v201
    v_xor_b32 v202, 2, v251
    v_lshl_add_u32 v202, v202, 5, v250
    v_add_u32 v202, 32768, v202
    v_xor_b32 v203, 3, v251
    v_lshl_add_u32 v203, v203, 5, v250
    v_add_u32 v203, 32768, v203
    v_mfma_f32_16x16x32_bf16 v[96:99], a[208:211], a[12:15], v[96:99]
    v_mfma_f32_16x16x32_bf16 v[100:103], a[208:211], a[28:31], v[100:103]
    ds_read_b64_tr_b16 a[192:193], v200 offset:0
    v_mfma_f32_16x16x32_bf16 v[104:107], a[208:211], a[44:47], v[104:107]
    v_mfma_f32_16x16x32_bf16 v[108:111], a[208:211], a[60:63], v[108:111]
    ds_read_b64_tr_b16 a[194:195], v200 offset:2048
    v_mfma_f32_16x16x32_bf16 v[112:115], a[208:211], a[76:79], v[112:115]
    v_mfma_f32_16x16x32_bf16 v[116:119], a[208:211], a[92:95], v[116:119]
    ds_read_b64_tr_b16 a[196:197], v201 offset:0
    v_mfma_f32_16x16x32_bf16 v[120:123], a[212:215], a[12:15], v[120:123]
    v_mfma_f32_16x16x32_bf16 v[124:127], a[212:215], a[28:31], v[124:127]
    ds_read_b64_tr_b16 a[198:199], v201 offset:2048
    v_mfma_f32_16x16x32_bf16 v[128:131], a[212:215], a[44:47], v[128:131]
    v_mfma_f32_16x16x32_bf16 v[132:135], a[212:215], a[60:63], v[132:135]
    ds_read_b64_tr_b16 a[200:201], v202 offset:0
    v_mfma_f32_16x16x32_bf16 v[136:139], a[212:215], a[76:79], v[136:139]
    v_mfma_f32_16x16x32_bf16 v[140:143], a[212:215], a[92:95], v[140:143]
    ds_read_b64_tr_b16 a[202:203], v202 offset:2048
    v_mfma_f32_16x16x32_bf16 v[144:147], a[216:219], a[12:15], v[144:147]
    v_mfma_f32_16x16x32_bf16 v[148:151], a[216:219], a[28:31], v[148:151]
    ds_read_b64_tr_b16 a[204:205], v203 offset:0
    v_mfma_f32_16x16x32_bf16 v[152:155], a[216:219], a[44:47], v[152:155]
    v_mfma_f32_16x16x32_bf16 v[156:159], a[216:219], a[60:63], v[156:159]
    ds_read_b64_tr_b16 a[206:207], v203 offset:2048
    v_mfma_f32_16x16x32_bf16 v[160:163], a[216:219], a[76:79], v[160:163]
    v_mfma_f32_16x16x32_bf16 v[164:167], a[216:219], a[92:95], v[164:167]
    v_mfma_f32_16x16x32_bf16 v[168:171], a[220:223], a[12:15], v[168:171]
    v_mfma_f32_16x16x32_bf16 v[172:175], a[220:223], a[28:31], v[172:175]
    v_mfma_f32_16x16x32_bf16 v[176:179], a[220:223], a[44:47], v[176:179]
    v_mfma_f32_16x16x32_bf16 v[180:183], a[220:223], a[60:63], v[180:183]
    v_mfma_f32_16x16x32_bf16 v[184:187], a[220:223], a[76:79], v[184:187]
    v_mfma_f32_16x16x32_bf16 v[188:191], a[220:223], a[92:95], v[188:191]
    s_waitcnt lgkmcnt(0)
    v_mfma_f32_16x16x32_bf16 v[96:99], a[192:195], a[96:99], v[96:99]
    v_mfma_f32_16x16x32_bf16 v[100:103], a[192:195], a[112:115], v[100:103]
    ds_read_b64_tr_b16 a[208:209], v200 offset:4096
    v_mfma_f32_16x16x32_bf16 v[104:107], a[192:195], a[128:131], v[104:107]
    v_mfma_f32_16x16x32_bf16 v[108:111], a[192:195], a[144:147], v[108:111]
    ds_read_b64_tr_b16 a[210:211], v200 offset:6144
    v_mfma_f32_16x16x32_bf16 v[112:115], a[192:195], a[160:163], v[112:115]
    v_mfma_f32_16x16x32_bf16 v[116:119], a[192:195], a[176:179], v[116:119]
    ds_read_b64_tr_b16 a[212:213], v201 offset:4096
    v_mfma_f32_16x16x32_bf16 v[120:123], a[196:199], a[96:99], v[120:123]
    v_mfma_f32_16x16x32_bf16 v[124:127], a[196:199], a[112:115], v[124:127]
    ds_read_b64_tr_b16 a[214:215], v201 offset:6144
    v_mfma_f32_16x16x32_bf16 v[128:131], a[196:199], a[128:131], v[128:131]
    v_mfma_f32_16x16x32_bf16 v[132:135], a[196:199], a[144:147], v[132:135]
    ds_read_b64_tr_b16 a[216:217], v202 offset:4096
    v_mfma_f32_16x16x32_bf16 v[136:139], a[196:199], a[160:163], v[136:139]
    v_mfma_f32_16x16x32_bf16 v[140:143], a[196:199], a[176:179], v[140:143]
    ds_read_b64_tr_b16 a[218:219], v202 offset:6144
    v_mfma_f32_16x16x32_bf16 v[144:147], a[200:203], a[96:99], v[144:147]
    v_mfma_f32_16x16x32_bf16 v[148:151], a[200:203], a[112:115], v[148:151]
    ds_read_b64_tr_b16 a[220:221], v203 offset:4096
    v_mfma_f32_16x16x32_bf16 v[152:155], a[200:203], a[128:131], v[152:155]
    v_mfma_f32_16x16x32_bf16 v[156:159], a[200:203], a[144:147], v[156:159]
    ds_read_b64_tr_b16 a[222:223], v203 offset:6144
    v_mfma_f32_16x16x32_bf16 v[160:163], a[200:203], a[160:163], v[160:163]
    v_mfma_f32_16x16x32_bf16 v[164:167], a[200:203], a[176:179], v[164:167]
    v_mfma_f32_16x16x32_bf16 v[168:171], a[204:207], a[96:99], v[168:171]
    v_mfma_f32_16x16x32_bf16 v[172:175], a[204:207], a[112:115], v[172:175]
    v_mfma_f32_16x16x32_bf16 v[176:179], a[204:207], a[128:131], v[176:179]
    v_mfma_f32_16x16x32_bf16 v[180:183], a[204:207], a[144:147], v[180:183]
    v_mfma_f32_16x16x32_bf16 v[184:187], a[204:207], a[160:163], v[184:187]
    v_mfma_f32_16x16x32_bf16 v[188:191], a[204:207], a[176:179], v[188:191]
    s_waitcnt lgkmcnt(0)
    v_mfma_f32_16x16x32_bf16 v[96:99], a[208:211], a[100:103], v[96:99]
    v_mfma_f32_16x16x32_bf16 v[100:103], a[208:211], a[116:119], v[100:103]
    ds_read_b64_tr_b16 a[192:193], v200 offset:8192
    v_mfma_f32_16x16x32_bf16 v[104:107], a[208:211], a[132:135], v[104:107]
    v_mfma_f32_16x16x32_bf16 v[108:111], a[208:211], a[148:151], v[108:111]
    ds_read_b64_tr_b16 a[194:195], v200 offset:10240
    v_mfma_f32_16x16x32_bf16 v[112:115], a[208:211], a[164:167], v[112:115]
    v_mfma_f32_16x16x32_bf16 v[116:119], a[208:211], a[180:183], v[116:119]
    ds_read_b64_tr_b16 a[196:197], v201 offset:8192
    v_mfma_f32_16x16x32_bf16 v[120:123], a[212:215], a[100:103], v[120:123]
    v_mfma_f32_16x16x32_bf16 v[124:127], a[212:215], a[116:119], v[124:127]
    ds_read_b64_tr_b16 a[198:199], v201 offset:10240
    v_mfma_f32_16x16x32_bf16 v[128:131], a[212:215], a[132:135], v[128:131]
    v_mfma_f32_16x16x32_bf16 v[132:135], a[212:215], a[148:151], v[132:135]
    ds_read_b64_tr_b16 a[200:201], v202 offset:8192
    v_mfma_f32_16x16x32_bf16 v[136:139], a[212:215], a[164:167], v[136:139]
    v_mfma_f32_16x16x32_bf16 v[140:143], a[212:215], a[180:183], v[140:143]
    ds_read_b64_tr_b16 a[202:203], v202 offset:10240
    v_mfma_f32_16x16x32_bf16 v[144:147], a[216:219], a[100:103], v[144:147]
    v_mfma_f32_16x16x32_bf16 v[148:151], a[216:219], a[116:119], v[148:151]
    ds_read_b64_tr_b16 a[204:205], v203 offset:8192
    v_mfma_f32_16x16x32_bf16 v[152:155], a[216:219], a[132:135], v[152:155]
    v_mfma_f32_16x16x32_bf16 v[156:159], a[216:219], a[148:151], v[156:159]
    ds_read_b64_tr_b16 a[206:207], v203 offset:10240
    v_mfma_f32_16x16x32_bf16 v[160:163], a[216:219], a[164:167], v[160:163]
    v_mfma_f32_16x16x32_bf16 v[164:167], a[216:219], a[180:183], v[164:167]
    v_mfma_f32_16x16x32_bf16 v[168:171], a[220:223], a[100:103], v[168:171]
    v_mfma_f32_16x16x32_bf16 v[172:175], a[220:223], a[116:119], v[172:175]
    v_mfma_f32_16x16x32_bf16 v[176:179], a[220:223], a[132:135], v[176:179]
    v_mfma_f32_16x16x32_bf16 v[180:183], a[220:223], a[148:151], v[180:183]
    v_mfma_f32_16x16x32_bf16 v[184:187], a[220:223], a[164:167], v[184:187]
    v_mfma_f32_16x16x32_bf16 v[188:191], a[220:223], a[180:183], v[188:191]
    s_waitcnt lgkmcnt(0)
    v_mfma_f32_16x16x32_bf16 v[96:99], a[192:195], a[104:107], v[96:99]
    v_mfma_f32_16x16x32_bf16 v[100:103], a[192:195], a[120:123], v[100:103]
    ds_read_b64_tr_b16 a[208:209], v200 offset:12288
    v_mfma_f32_16x16x32_bf16 v[104:107], a[192:195], a[136:139], v[104:107]
    v_mfma_f32_16x16x32_bf16 v[108:111], a[192:195], a[152:155], v[108:111]
    ds_read_b64_tr_b16 a[210:211], v200 offset:14336
    v_mfma_f32_16x16x32_bf16 v[112:115], a[192:195], a[168:171], v[112:115]
    v_mfma_f32_16x16x32_bf16 v[116:119], a[192:195], a[184:187], v[116:119]
    ds_read_b64_tr_b16 a[212:213], v201 offset:12288
    v_mfma_f32_16x16x32_bf16 v[120:123], a[196:199], a[104:107], v[120:123]
    v_mfma_f32_16x16x32_bf16 v[124:127], a[196:199], a[120:123], v[124:127]
    ds_read_b64_tr_b16 a[214:215], v201 offset:14336
    v_mfma_f32_16x16x32_bf16 v[128:131], a[196:199], a[136:139], v[128:131]
    v_mfma_f32_16x16x32_bf16 v[132:135], a[196:199], a[152:155], v[132:135]
    ds_read_b64_tr_b16 a[216:217], v202 offset:12288
    v_mfma_f32_16x16x32_bf16 v[136:139], a[196:199], a[168:171], v[136:139]
    v_mfma_f32_16x16x32_bf16 v[140:143], a[196:199], a[184:187], v[140:143]
    ds_read_b64_tr_b16 a[218:219], v202 offset:14336
    v_mfma_f32_16x16x32_bf16 v[144:147], a[200:203], a[104:107], v[144:147]
    v_mfma_f32_16x16x32_bf16 v[148:151], a[200:203], a[120:123], v[148:151]
    ds_read_b64_tr_b16 a[220:221], v203 offset:12288
    v_mfma_f32_16x16x32_bf16 v[152:155], a[200:203], a[136:139], v[152:155]
    v_mfma_f32_16x16x32_bf16 v[156:159], a[200:203], a[152:155], v[156:159]
    ds_read_b64_tr_b16 a[222:223], v203 offset:14336
    v_mfma_f32_16x16x32_bf16 v[160:163], a[200:203], a[168:171], v[160:163]
    v_mfma_f32_16x16x32_bf16 v[164:167], a[200:203], a[184:187], v[164:167]
    v_mfma_f32_16x16x32_bf16 v[168:171], a[204:207], a[104:107], v[168:171]
    v_mfma_f32_16x16x32_bf16 v[172:175], a[204:207], a[120:123], v[172:175]
    v_mfma_f32_16x16x32_bf16 v[176:179], a[204:207], a[136:139], v[176:179]
    v_mfma_f32_16x16x32_bf16 v[180:183], a[204:207], a[152:155], v[180:183]
    v_mfma_f32_16x16x32_bf16 v[184:187], a[204:207], a[168:171], v[184:187]
    v_mfma_f32_16x16x32_bf16 v[188:191], a[204:207], a[184:187], v[188:191]
    s_waitcnt lgkmcnt(0)
    v_mfma_f32_16x16x32_bf16 v[96:99], a[208:211], a[108:111], v[96:99]
    v_mfma_f32_16x16x32_bf16 v[100:103], a[208:211], a[124:127], v[100:103]
    v_mfma_f32_16x16x32_bf16 v[104:107], a[208:211], a[140:143], v[104:107]
    v_mfma_f32_16x16x32_bf16 v[108:111], a[208:211], a[156:159], v[108:111]
    v_mfma_f32_16x16x32_bf16 v[112:115], a[208:211], a[172:175], v[112:115]
    v_mfma_f32_16x16x32_bf16 v[116:119], a[208:211], a[188:191], v[116:119]
    v_mfma_f32_16x16x32_bf16 v[120:123], a[212:215], a[108:111], v[120:123]
    v_mfma_f32_16x16x32_bf16 v[124:127], a[212:215], a[124:127], v[124:127]
    v_mfma_f32_16x16x32_bf16 v[128:131], a[212:215], a[140:143], v[128:131]
    v_mfma_f32_16x16x32_bf16 v[132:135], a[212:215], a[156:159], v[132:135]
    v_mfma_f32_16x16x32_bf16 v[136:139], a[212:215], a[172:175], v[136:139]
    v_mfma_f32_16x16x32_bf16 v[140:143], a[212:215], a[188:191], v[140:143]
    v_mfma_f32_16x16x32_bf16 v[144:147], a[216:219], a[108:111], v[144:147]
    v_mfma_f32_16x16x32_bf16 v[148:151], a[216:219], a[124:127], v[148:151]
    v_mfma_f32_16x16x32_bf16 v[152:155], a[216:219], a[140:143], v[152:155]
    v_mfma_f32_16x16x32_bf16 v[156:159], a[216:219], a[156:159], v[156:159]
    v_mfma_f32_16x16x32_bf16 v[160:163], a[216:219], a[172:175], v[160:163]
    v_mfma_f32_16x16x32_bf16 v[164:167], a[216:219], a[188:191], v[164:167]
    v_mfma_f32_16x16x32_bf16 v[168:171], a[220:223], a[108:111], v[168:171]
    v_mfma_f32_16x16x32_bf16 v[172:175], a[220:223], a[124:127], v[172:175]
    v_mfma_f32_16x16x32_bf16 v[176:179], a[220:223], a[140:143], v[176:179]
    v_mfma_f32_16x16x32_bf16 v[180:183], a[220:223], a[156:159], v[180:183]
    v_mfma_f32_16x16x32_bf16 v[184:187], a[220:223], a[172:175], v[184:187]
    v_mfma_f32_16x16x32_bf16 v[188:191], a[220:223], a[188:191], v[188:191]
    s_waitcnt lgkmcnt(0)
    s_nop 7
    v_cvt_pk_bf16_f32 v204, v96, v97
    v_cvt_pk_bf16_f32 v205, v98, v99
    v_cvt_pk_bf16_f32 v206, v120, v121
    v_cvt_pk_bf16_f32 v207, v122, v123
    s_mov_b32 s23, 36864
    buffer_store_dwordx4 v[204:207], v236, s[16:19], s23 offen offset:0 sc1
    v_cvt_pk_bf16_f32 v208, v100, v101
    v_cvt_pk_bf16_f32 v209, v102, v103
    v_cvt_pk_bf16_f32 v210, v124, v125
    v_cvt_pk_bf16_f32 v211, v126, v127
    buffer_store_dwordx4 v[208:211], v236, s[16:19], s23 offen offset:1024 sc1
    v_cvt_pk_bf16_f32 v212, v104, v105
    v_cvt_pk_bf16_f32 v213, v106, v107
    v_cvt_pk_bf16_f32 v214, v128, v129
    v_cvt_pk_bf16_f32 v215, v130, v131
    buffer_store_dwordx4 v[212:215], v236, s[16:19], s23 offen offset:2048 sc1
    v_cvt_pk_bf16_f32 v216, v108, v109
    v_cvt_pk_bf16_f32 v217, v110, v111
    v_cvt_pk_bf16_f32 v218, v132, v133
    v_cvt_pk_bf16_f32 v219, v134, v135
    buffer_store_dwordx4 v[216:219], v236, s[16:19], s23 offen offset:3072 sc1
    v_cvt_pk_bf16_f32 v204, v112, v113
    v_cvt_pk_bf16_f32 v205, v114, v115
    v_cvt_pk_bf16_f32 v206, v136, v137
    v_cvt_pk_bf16_f32 v207, v138, v139
    s_mov_b32 s23, 40960
    buffer_store_dwordx4 v[204:207], v236, s[16:19], s23 offen offset:0 sc1
    v_cvt_pk_bf16_f32 v208, v116, v117
    v_cvt_pk_bf16_f32 v209, v118, v119
    v_cvt_pk_bf16_f32 v210, v140, v141
    v_cvt_pk_bf16_f32 v211, v142, v143
    buffer_store_dwordx4 v[208:211], v236, s[16:19], s23 offen offset:1024 sc1
    v_cvt_pk_bf16_f32 v212, v144, v145
    v_cvt_pk_bf16_f32 v213, v146, v147
    v_cvt_pk_bf16_f32 v214, v168, v169
    v_cvt_pk_bf16_f32 v215, v170, v171
    buffer_store_dwordx4 v[212:215], v236, s[16:19], s23 offen offset:2048 sc1
    v_cvt_pk_bf16_f32 v216, v148, v149
    v_cvt_pk_bf16_f32 v217, v150, v151
    v_cvt_pk_bf16_f32 v218, v172, v173
    v_cvt_pk_bf16_f32 v219, v174, v175
    buffer_store_dwordx4 v[216:219], v236, s[16:19], s23 offen offset:3072 sc1
    v_cvt_pk_bf16_f32 v204, v152, v153
    v_cvt_pk_bf16_f32 v205, v154, v155
    v_cvt_pk_bf16_f32 v206, v176, v177
    v_cvt_pk_bf16_f32 v207, v178, v179
    s_mov_b32 s23, 45056
    buffer_store_dwordx4 v[204:207], v236, s[16:19], s23 offen offset:0 sc1
    v_cvt_pk_bf16_f32 v208, v156, v157
    v_cvt_pk_bf16_f32 v209, v158, v159
    v_cvt_pk_bf16_f32 v210, v180, v181
    v_cvt_pk_bf16_f32 v211, v182, v183
    buffer_store_dwordx4 v[208:211], v236, s[16:19], s23 offen offset:1024 sc1
    v_cvt_pk_bf16_f32 v212, v160, v161
    v_cvt_pk_bf16_f32 v213, v162, v163
    v_cvt_pk_bf16_f32 v214, v184, v185
    v_cvt_pk_bf16_f32 v215, v186, v187
    buffer_store_dwordx4 v[212:215], v236, s[16:19], s23 offen offset:2048 sc1
    v_cvt_pk_bf16_f32 v216, v164, v165
    v_cvt_pk_bf16_f32 v217, v166, v167
    v_cvt_pk_bf16_f32 v218, v188, v189
    v_cvt_pk_bf16_f32 v219, v190, v191
    buffer_store_dwordx4 v[216:219], v236, s[16:19], s23 offen offset:3072 sc1
Lk1_end:
    s_endpgm
Ltr0:
    s_call_b64 s[44:45], Lslow0
    s_branch Lret0
Ltr1:
    s_call_b64 s[44:45], Lslow1
    s_branch Lret1
Ltr2:
    s_call_b64 s[44:45], Lslow2
    s_branch Lret2
Ltr3:
    s_call_b64 s[44:45], Lslow0
    s_branch Lret3
Ltr4:
    s_call_b64 s[44:45], Lslow1
    s_branch Lret4
Ltr5:
    s_call_b64 s[44:45], Lslow2
    s_branch Lret5
Ltr6:
    s_call_b64 s[44:45], Lslow0
    s_branch Lret6
Ltr7:
    s_call_b64 s[44:45], Lslow1
    s_branch Lret7
Ltr8:
    s_call_b64 s[44:45], Lslow2
    s_branch Lret8
Ltr9:
    s_call_b64 s[44:45], Lslow0
    s_branch Lret9
Ltr10:
    s_call_b64 s[44:45], Lslow1
    s_branch Lret10
Ltr11:
    s_call_b64 s[44:45], Lslow2
    s_branch Lret11
Ltr12:
    s_call_b64 s[44:45], Lslow0
    s_branch Lret12
Ltr13:
    s_call_b64 s[44:45], Lslow1
    s_branch Lret13
Ltr14:
    s_call_b64 s[44:45], Lslow2
    s_branch Lret14
Ltr15:
    s_call_b64 s[44:45], Lslow0
    s_branch Lret15
Ltr16:
    s_call_b64 s[44:45], Lslow1
    s_branch Lret16
Ltr17:
    s_call_b64 s[44:45], Lslow2
    s_branch Lret17
Ltr18:
    s_call_b64 s[44:45], Lslow0
    s_branch Lret18
Ltr19:
    s_call_b64 s[44:45], Lslow1
    s_branch Lret19
Ltr20:
    s_call_b64 s[44:45], Lslow2
    s_branch Lret20
Lslow0:
    s_nop 15
    v_max3_f32 v244, v96, v97, v98
    v_max3_f32 v244, v244, v99, v100
    v_max3_f32 v244, v244, v101, v102
    v_max_f32 v244, v244, v103
    v_mov_b32 v245, v244
    s_nop 1
    v_permlane16_swap_b32 v244, v245
    s_nop 1
    v_max_f32 v244, v244, v245
    v_mov_b32 v245, v244
    s_nop 1
    v_permlane32_swap_b32 v244, v245
    s_nop 1
    v_max_f32 v244, v244, v245
    v_max_f32 v244, 0, v244
    v_sub_f32 v245, 0, v244
    v_exp_f32 v245, v245
    v_sub_f32 v144, v144, v244
    v_sub_f32 v145, v145, v244
    v_sub_f32 v146, v146, v244
    v_sub_f32 v147, v147, v244
    v_sub_f32 v96, v96, v244
    v_sub_f32 v97, v97, v244
    v_sub_f32 v98, v98, v244
    v_sub_f32 v99, v99, v244
    v_sub_f32 v100, v100, v244
    v_sub_f32 v101, v101, v244
    v_sub_f32 v102, v102, v244
    v_sub_f32 v103, v103, v244
    v_mul_f32 v192, v192, v245
    v_mul_f32 v193, v193, v245
    v_mul_f32 v194, v194, v245
    v_mul_f32 v195, v195, v245
    v_accvgpr_read_b32 v246, a0
    v_accvgpr_read_b32 v247, a1
    v_accvgpr_read_b32 v248, a2
    v_accvgpr_read_b32 v249, a3
    v_mul_f32 v246, v246, v245
    v_mul_f32 v247, v247, v245
    v_mul_f32 v248, v248, v245
    v_mul_f32 v249, v249, v245
    v_accvgpr_write_b32 a0, v246
    v_accvgpr_write_b32 a1, v247
    v_accvgpr_write_b32 a2, v248
    v_accvgpr_write_b32 a3, v249
    v_accvgpr_read_b32 v246, a4
    v_accvgpr_read_b32 v247, a5
    v_accvgpr_read_b32 v248, a6
    v_accvgpr_read_b32 v249, a7
    v_mul_f32 v246, v246, v245
    v_mul_f32 v247, v247, v245
    v_mul_f32 v248, v248, v245
    v_mul_f32 v249, v249, v245
    v_accvgpr_write_b32 a4, v246
    v_accvgpr_write_b32 a5, v247
    v_accvgpr_write_b32 a6, v248
    v_accvgpr_write_b32 a7, v249
    v_accvgpr_read_b32 v246, a8
    v_accvgpr_read_b32 v247, a9
    v_accvgpr_read_b32 v248, a10
    v_accvgpr_read_b32 v249, a11
    v_mul_f32 v246, v246, v245
    v_mul_f32 v247, v247, v245
    v_mul_f32 v248, v248, v245
    v_mul_f32 v249, v249, v245
    v_accvgpr_write_b32 a8, v246
    v_accvgpr_write_b32 a9, v247
    v_accvgpr_write_b32 a10, v248
    v_accvgpr_write_b32 a11, v249
    v_accvgpr_read_b32 v246, a12
    v_accvgpr_read_b32 v247, a13
    v_accvgpr_read_b32 v248, a14
    v_accvgpr_read_b32 v249, a15
    v_mul_f32 v246, v246, v245
    v_mul_f32 v247, v247, v245
    v_mul_f32 v248, v248, v245
    v_mul_f32 v249, v249, v245
    v_accvgpr_write_b32 a12, v246
    v_accvgpr_write_b32 a13, v247
    v_accvgpr_write_b32 a14, v248
    v_accvgpr_write_b32 a15, v249
    v_accvgpr_read_b32 v246, a16
    v_accvgpr_read_b32 v247, a17
    v_accvgpr_read_b32 v248, a18
    v_accvgpr_read_b32 v249, a19
    v_mul_f32 v246, v246, v245
    v_mul_f32 v247, v247, v245
    v_mul_f32 v248, v248, v245
    v_mul_f32 v249, v249, v245
    v_accvgpr_write_b32 a16, v246
    v_accvgpr_write_b32 a17, v247
    v_accvgpr_write_b32 a18, v248
    v_accvgpr_write_b32 a19, v249
    v_accvgpr_read_b32 v246, a20
    v_accvgpr_read_b32 v247, a21
    v_accvgpr_read_b32 v248, a22
    v_accvgpr_read_b32 v249, a23
    v_mul_f32 v246, v246, v245
    v_mul_f32 v247, v247, v245
    v_mul_f32 v248, v248, v245
    v_mul_f32 v249, v249, v245
    v_accvgpr_write_b32 a20, v246
    v_accvgpr_write_b32 a21, v247
    v_accvgpr_write_b32 a22, v248
    v_accvgpr_write_b32 a23, v249
    v_accvgpr_read_b32 v246, a24
    v_accvgpr_read_b32 v247, a25
    v_accvgpr_read_b32 v248, a26
    v_accvgpr_read_b32 v249, a27
    v_mul_f32 v246, v246, v245
    v_mul_f32 v247, v247, v245
    v_mul_f32 v248, v248, v245
    v_mul_f32 v249, v249, v245
    v_accvgpr_write_b32 a24, v246
    v_accvgpr_write_b32 a25, v247
    v_accvgpr_write_b32 a26, v248
    v_accvgpr_write_b32 a27, v249
    v_accvgpr_read_b32 v246, a28
    v_accvgpr_read_b32 v247, a29
    v_accvgpr_read_b32 v248, a30
    v_accvgpr_read_b32 v249, a31
    v_mul_f32 v246, v246, v245
    v_mul_f32 v247, v247, v245
    v_mul_f32 v248, v248, v245
    v_mul_f32 v249, v249, v245
    v_accvgpr_write_b32 a28, v246
    v_accvgpr_write_b32 a29, v247
    v_accvgpr_write_b32 a30, v248
    v_accvgpr_write_b32 a31, v249
    v_max3_f32 v244, v104, v105, v106
    v_max3_f32 v244, v244, v107, v108
    v_max3_f32 v244, v244, v109, v110
    v_max_f32 v244, v244, v111
    v_mov_b32 v245, v244
    s_nop 1
    v_permlane16_swap_b32 v244, v245
    s_nop 1
    v_max_f32 v244, v244, v245
    v_mov_b32 v245, v244
    s_nop 1
    v_permlane32_swap_b32 v244, v245
    s_nop 1
    v_max_f32 v244, v244, v245
    v_max_f32 v244, 0, v244
    v_sub_f32 v245, 0, v244
    v_exp_f32 v245, v245
    v_sub_f32 v148, v148, v244
    v_sub_f32 v149, v149, v244
    v_sub_f32 v150, v150, v244
    v_sub_f32 v151, v151, v244
    v_sub_f32 v104, v104, v244
    v_sub_f32 v105, v105, v244
    v_sub_f32 v106, v106, v244
    v_sub_f32 v107, v107, v244
    v_sub_f32 v108, v108, v244
    v_sub_f32 v109, v109, v244
    v_sub_f32 v110, v110, v244
    v_sub_f32 v111, v111, v244
    v_mul_f32 v196, v196, v245
    v_mul_f32 v197, v197, v245
    v_mul_f32 v198, v198, v245
    v_mul_f32 v199, v199, v245
    v_accvgpr_read_b32 v246, a32
    v_accvgpr_read_b32 v247, a33
    v_accvgpr_read_b32 v248, a34
    v_accvgpr_read_b32 v249, a35
    v_mul_f32 v246, v246, v245
    v_mul_f32 v247, v247, v245
    v_mul_f32 v248, v248, v245
    v_mul_f32 v249, v249, v245
    v_accvgpr_write_b32 a32, v246
    v_accvgpr_write_b32 a33, v247
    v_accvgpr_write_b32 a34, v248
    v_accvgpr_write_b32 a35, v249
    v_accvgpr_read_b32 v246, a36
    v_accvgpr_read_b32 v247, a37
    v_accvgpr_read_b32 v248, a38
    v_accvgpr_read_b32 v249, a39
    v_mul_f32 v246, v246, v245
    v_mul_f32 v247, v247, v245
    v_mul_f32 v248, v248, v245
    v_mul_f32 v249, v249, v245
    v_accvgpr_write_b32 a36, v246
    v_accvgpr_write_b32 a37, v247
    v_accvgpr_write_b32 a38, v248
    v_accvgpr_write_b32 a39, v249
    v_accvgpr_read_b32 v246, a40
    v_accvgpr_read_b32 v247, a41
    v_accvgpr_read_b32 v248, a42
    v_accvgpr_read_b32 v249, a43
    v_mul_f32 v246, v246, v245
    v_mul_f32 v247, v247, v245
    v_mul_f32 v248, v248, v245
    v_mul_f32 v249, v249, v245
    v_accvgpr_write_b32 a40, v246
    v_accvgpr_write_b32 a41, v247
    v_accvgpr_write_b32 a42, v248
    v_accvgpr_write_b32 a43, v249
    v_accvgpr_read_b32 v246, a44
    v_accvgpr_read_b32 v247, a45
    v_accvgpr_read_b32 v248, a46
    v_accvgpr_read_b32 v249, a47
    v_mul_f32 v246, v246, v245
    v_mul_f32 v247, v247, v245
    v_mul_f32 v248, v248, v245
    v_mul_f32 v249, v249, v245
    v_accvgpr_write_b32 a44, v246
    v_accvgpr_write_b32 a45, v247
    v_accvgpr_write_b32 a46, v248
    v_accvgpr_write_b32 a47, v249
    v_accvgpr_read_b32 v246, a48
    v_accvgpr_read_b32 v247, a49
    v_accvgpr_read_b32 v248, a50
    v_accvgpr_read_b32 v249, a51
    v_mul_f32 v246, v246, v245
    v_mul_f32 v247, v247, v245
    v_mul_f32 v248, v248, v245
    v_mul_f32 v249, v249, v245
    v_accvgpr_write_b32 a48, v246
    v_accvgpr_write_b32 a49, v247
    v_accvgpr_write_b32 a50, v248
    v_accvgpr_write_b32 a51, v249
    v_accvgpr_read_b32 v246, a52
    v_accvgpr_read_b32 v247, a53
    v_accvgpr_read_b32 v248, a54
    v_accvgpr_read_b32 v249, a55
    v_mul_f32 v246, v246, v245
    v_mul_f32 v247, v247, v245
    v_mul_f32 v248, v248, v245
    v_mul_f32 v249, v249, v245
    v_accvgpr_write_b32 a52, v246
    v_accvgpr_write_b32 a53, v247
    v_accvgpr_write_b32 a54, v248
    v_accvgpr_write_b32 a55, v249
    v_accvgpr_read_b32 v246, a56
    v_accvgpr_read_b32 v247, a57
    v_accvgpr_read_b32 v248, a58
    v_accvgpr_read_b32 v249, a59
    v_mul_f32 v246, v246, v245
    v_mul_f32 v247, v247, v245
    v_mul_f32 v248, v248, v245
    v_mul_f32 v249, v249, v245
    v_accvgpr_write_b32 a56, v246
    v_accvgpr_write_b32 a57, v247
    v_accvgpr_write_b32 a58, v248
    v_accvgpr_write_b32 a59, v249
    v_accvgpr_read_b32 v246, a60
    v_accvgpr_read_b32 v247, a61
    v_accvgpr_read_b32 v248, a62
    v_accvgpr_read_b32 v249, a63
    v_mul_f32 v246, v246, v245
    v_mul_f32 v247, v247, v245
    v_mul_f32 v248, v248, v245
    v_mul_f32 v249, v249, v245
    v_accvgpr_write_b32 a60, v246
    v_accvgpr_write_b32 a61, v247
    v_accvgpr_write_b32 a62, v248
    v_accvgpr_write_b32 a63, v249
    s_nop 3
    s_setpc_b64 s[44:45]
Lslow1:
    s_nop 15
    v_max3_f32 v244, v112, v113, v114
    v_max3_f32 v244, v244, v115, v116
    v_max3_f32 v244, v244, v117, v118
    v_max_f32 v244, v244, v119
    v_mov_b32 v245, v244
    s_nop 1
    v_permlane16_swap_b32 v244, v245
    s_nop 1
    v_max_f32 v244, v244, v245
    v_mov_b32 v245, v244
    s_nop 1
    v_permlane32_swap_b32 v244, v245
    s_nop 1
    v_max_f32 v244, v244, v245
    v_max_f32 v244, 0, v244
    v_sub_f32 v245, 0, v244
    v_exp_f32 v245, v245
    v_sub_f32 v152, v152, v244
    v_sub_f32 v153, v153, v244
    v_sub_f32 v154, v154, v244
    v_sub_f32 v155, v155, v244
    v_sub_f32 v112, v112, v244
    v_sub_f32 v113, v113, v244
    v_sub_f32 v114, v114, v244
    v_sub_f32 v115, v115, v244
    v_sub_f32 v116, v116, v244
    v_sub_f32 v117, v117, v244
    v_sub_f32 v118, v118, v244
    v_sub_f32 v119, v119, v244
    v_mul_f32 v200, v200, v245
    v_mul_f32 v201, v201, v245
    v_mul_f32 v202, v202, v245
    v_mul_f32 v203, v203, v245
    v_accvgpr_read_b32 v246, a64
    v_accvgpr_read_b32 v247, a65
    v_accvgpr_read_b32 v248, a66
    v_accvgpr_read_b32 v249, a67
    v_mul_f32 v246, v246, v245
    v_mul_f32 v247, v247, v245
    v_mul_f32 v248, v248, v245
    v_mul_f32 v249, v249, v245
    v_accvgpr_write_b32 a64, v246
    v_accvgpr_write_b32 a65, v247
    v_accvgpr_write_b32 a66, v248
    v_accvgpr_write_b32 a67, v249
    v_accvgpr_read_b32 v246, a68
    v_accvgpr_read_b32 v247, a69
    v_accvgpr_read_b32 v248, a70
    v_accvgpr_read_b32 v249, a71
    v_mul_f32 v246, v246, v245
    v_mul_f32 v247, v247, v245
    v_mul_f32 v248, v248, v245
    v_mul_f32 v249, v249, v245
    v_accvgpr_write_b32 a68, v246
    v_accvgpr_write_b32 a69, v247
    v_accvgpr_write_b32 a70, v248
    v_accvgpr_write_b32 a71, v249
    v_accvgpr_read_b32 v246, a72
    v_accvgpr_read_b32 v247, a73
    v_accvgpr_read_b32 v248, a74
    v_accvgpr_read_b32 v249, a75
    v_mul_f32 v246, v246, v245
    v_mul_f32 v247, v247, v245
    v_mul_f32 v248, v248, v245
    v_mul_f32 v249, v249, v245
    v_accvgpr_write_b32 a72, v246
    v_accvgpr_write_b32 a73, v247
    v_accvgpr_write_b32 a74, v248
    v_accvgpr_write_b32 a75, v249
    v_accvgpr_read_b32 v246, a76
    v_accvgpr_read_b32 v247, a77
    v_accvgpr_read_b32 v248, a78
    v_accvgpr_read_b32 v249, a79
    v_mul_f32 v246, v246, v245
    v_mul_f32 v247, v247, v245
    v_mul_f32 v248, v248, v245
    v_mul_f32 v249, v249, v245
    v_accvgpr_write_b32 a76, v246
    v_accvgpr_write_b32 a77, v247
    v_accvgpr_write_b32 a78, v248
    v_accvgpr_write_b32 a79, v249
    v_accvgpr_read_b32 v246, a80
    v_accvgpr_read_b32 v247, a81
    v_accvgpr_read_b32 v248, a82
    v_accvgpr_read_b32 v249, a83
    v_mul_f32 v246, v246, v245
    v_mul_f32 v247, v247, v245
    v_mul_f32 v248, v248, v245
    v_mul_f32 v249, v249, v245
    v_accvgpr_write_b32 a80, v246
    v_accvgpr_write_b32 a81, v247
    v_accvgpr_write_b32 a82, v248
    v_accvgpr_write_b32 a83, v249
    v_accvgpr_read_b32 v246, a84
    v_accvgpr_read_b32 v247, a85
    v_accvgpr_read_b32 v248, a86
    v_accvgpr_read_b32 v249, a87
    v_mul_f32 v246, v246, v245
    v_mul_f32 v247, v247, v245
    v_mul_f32 v248, v248, v245
    v_mul_f32 v249, v249, v245
    v_accvgpr_write_b32 a84, v246
    v_accvgpr_write_b32 a85, v247
    v_accvgpr_write_b32 a86, v248
    v_accvgpr_write_b32 a87, v249
    v_accvgpr_read_b32 v246, a88
    v_accvgpr_read_b32 v247, a89
    v_accvgpr_read_b32 v248, a90
    v_accvgpr_read_b32 v249, a91
    v_mul_f32 v246, v246, v245
    v_mul_f32 v247, v247, v245
    v_mul_f32 v248, v248, v245
    v_mul_f32 v249, v249, v245
    v_accvgpr_write_b32 a88, v246
    v_accvgpr_write_b32 a89, v247
    v_accvgpr_write_b32 a90, v248
    v_accvgpr_write_b32 a91, v249
    v_accvgpr_read_b32 v246, a92
    v_accvgpr_read_b32 v247, a93
    v_accvgpr_read_b32 v248, a94
    v_accvgpr_read_b32 v249, a95
    v_mul_f32 v246, v246, v245
    v_mul_f32 v247, v247, v245
    v_mul_f32 v248, v248, v245
    v_mul_f32 v249, v249, v245
    v_accvgpr_write_b32 a92, v246
    v_accvgpr_write_b32 a93, v247
    v_accvgpr_write_b32 a94, v248
    v_accvgpr_write_b32 a95, v249
    v_max3_f32 v244, v120, v121, v122
    v_max3_f32 v244, v244, v123, v124
    v_max3_f32 v244, v244, v125, v126
    v_max_f32 v244, v244, v127
    v_mov_b32 v245, v244
    s_nop 1
    v_permlane16_swap_b32 v244, v245
    s_nop 1
    v_max_f32 v244, v244, v245
    v_mov_b32 v245, v244
    s_nop 1
    v_permlane32_swap_b32 v244, v245
    s_nop 1
    v_max_f32 v244, v244, v245
    v_max_f32 v244, 0, v244
    v_sub_f32 v245, 0, v244
    v_exp_f32 v245, v245
    v_sub_f32 v156, v156, v244
    v_sub_f32 v157, v157, v244
    v_sub_f32 v158, v158, v244
    v_sub_f32 v159, v159, v244
    v_sub_f32 v120, v120, v244
    v_sub_f32 v121, v121, v244
    v_sub_f32 v122, v122, v244
    v_sub_f32 v123, v123, v244
    v_sub_f32 v124, v124, v244
    v_sub_f32 v125, v125, v244
    v_sub_f32 v126, v126, v244
    v_sub_f32 v127, v127, v244
    v_mul_f32 v204, v204, v245
    v_mul_f32 v205, v205, v245
    v_mul_f32 v206, v206, v245
    v_mul_f32 v207, v207, v245
    v_accvgpr_read_b32 v246, a96
    v_accvgpr_read_b32 v247, a97
    v_accvgpr_read_b32 v248, a98
    v_accvgpr_read_b32 v249, a99
    v_mul_f32 v246, v246, v245
    v_mul_f32 v247, v247, v245
    v_mul_f32 v248, v248, v245
    v_mul_f32 v249, v249, v245
    v_accvgpr_write_b32 a96, v246
    v_accvgpr_write_b32 a97, v247
    v_accvgpr_write_b32 a98, v248
    v_accvgpr_write_b32 a99, v249
    v_accvgpr_read_b32 v246, a100
    v_accvgpr_read_b32 v247, a101
    v_accvgpr_read_b32 v248, a102
    v_accvgpr_read_b32 v249, a103
    v_mul_f32 v246, v246, v245
    v_mul_f32 v247, v247, v245
    v_mul_f32 v248, v248, v245
    v_mul_f32 v249, v249, v245
    v_accvgpr_write_b32 a100, v246
    v_accvgpr_write_b32 a101, v247
    v_accvgpr_write_b32 a102, v248
    v_accvgpr_write_b32 a103, v249
    v_accvgpr_read_b32 v246, a104
    v_accvgpr_read_b32 v247, a105
    v_accvgpr_read_b32 v248, a106
    v_accvgpr_read_b32 v249, a107
    v_mul_f32 v246, v246, v245
    v_mul_f32 v247, v247, v245
    v_mul_f32 v248, v248, v245
    v_mul_f32 v249, v249, v245
    v_accvgpr_write_b32 a104, v246
    v_accvgpr_write_b32 a105, v247
    v_accvgpr_write_b32 a106, v248
    v_accvgpr_write_b32 a107, v249
    v_accvgpr_read_b32 v246, a108
    v_accvgpr_read_b32 v247, a109
    v_accvgpr_read_b32 v248, a110
    v_accvgpr_read_b32 v249, a111
    v_mul_f32 v246, v246, v245
    v_mul_f32 v247, v247, v245
    v_mul_f32 v248, v248, v245
    v_mul_f32 v249, v249, v245
    v_accvgpr_write_b32 a108, v246
    v_accvgpr_write_b32 a109, v247
    v_accvgpr_write_b32 a110, v248
    v_accvgpr_write_b32 a111, v249
    v_accvgpr_read_b32 v246, a112
    v_accvgpr_read_b32 v247, a113
    v_accvgpr_read_b32 v248, a114
    v_accvgpr_read_b32 v249, a115
    v_mul_f32 v246, v246, v245
    v_mul_f32 v247, v247, v245
    v_mul_f32 v248, v248, v245
    v_mul_f32 v249, v249, v245
    v_accvgpr_write_b32 a112, v246
    v_accvgpr_write_b32 a113, v247
    v_accvgpr_write_b32 a114, v248
    v_accvgpr_write_b32 a115, v249
    v_accvgpr_read_b32 v246, a116
    v_accvgpr_read_b32 v247, a117
    v_accvgpr_read_b32 v248, a118
    v_accvgpr_read_b32 v249, a119
    v_mul_f32 v246, v246, v245
    v_mul_f32 v247, v247, v245
    v_mul_f32 v248, v248, v245
    v_mul_f32 v249, v249, v245
    v_accvgpr_write_b32 a116, v246
    v_accvgpr_write_b32 a117, v247
    v_accvgpr_write_b32 a118, v248
    v_accvgpr_write_b32 a119, v249
    v_accvgpr_read_b32 v246, a120
    v_accvgpr_read_b32 v247, a121
    v_accvgpr_read_b32 v248, a122
    v_accvgpr_read_b32 v249, a123
    v_mul_f32 v246, v246, v245
    v_mul_f32 v247, v247, v245
    v_mul_f32 v248, v248, v245
    v_mul_f32 v249, v249, v245
    v_accvgpr_write_b32 a120, v246
    v_accvgpr_write_b32 a121, v247
    v_accvgpr_write_b32 a122, v248
    v_accvgpr_write_b32 a123, v249
    v_accvgpr_read_b32 v246, a124
    v_accvgpr_read_b32 v247, a125
    v_accvgpr_read_b32 v248, a126
    v_accvgpr_read_b32 v249, a127
    v_mul_f32 v246, v246, v245
    v_mul_f32 v247, v247, v245
    v_mul_f32 v248, v248, v245
    v_mul_f32 v249, v249, v245
    v_accvgpr_write_b32 a124, v246
    v_accvgpr_write_b32 a125, v247
    v_accvgpr_write_b32 a126, v248
    v_accvgpr_write_b32 a127, v249
    s_nop 3
    s_setpc_b64 s[44:45]
Lslow2:
    s_nop 15
    v_max3_f32 v244, v128, v129, v130
    v_max3_f32 v244, v244, v131, v132
    v_max3_f32 v244, v244, v133, v134
    v_max_f32 v244, v244, v135
    v_mov_b32 v245, v244
    s_nop 1
    v_permlane16_swap_b32 v244, v245
    s_nop 1
    v_max_f32 v244, v244, v245
    v_mov_b32 v245, v244
    s_nop 1
    v_permlane32_swap_b32 v244, v245
    s_nop 1
    v_max_f32 v244, v244, v245
    v_max_f32 v244, 0, v244
    v_sub_f32 v245, 0, v244
    v_exp_f32 v245, v245
    v_sub_f32 v160, v160, v244
    v_sub_f32 v161, v161, v244
    v_sub_f32 v162, v162, v244
    v_sub_f32 v163, v163, v244
    v_sub_f32 v128, v128, v244
    v_sub_f32 v129, v129, v244
    v_sub_f32 v130, v130, v244
    v_sub_f32 v131, v131, v244
    v_sub_f32 v132, v132, v244
    v_sub_f32 v133, v133, v244
    v_sub_f32 v134, v134, v244
    v_sub_f32 v135, v135, v244
    v_mul_f32 v208, v208, v245
    v_mul_f32 v209, v209, v245
    v_mul_f32 v210, v210, v245
    v_mul_f32 v211, v211, v245
    v_accvgpr_read_b32 v246, a128
    v_accvgpr_read_b32 v247, a129
    v_accvgpr_read_b32 v248, a130
    v_accvgpr_read_b32 v249, a131
    v_mul_f32 v246, v246, v245
    v_mul_f32 v247, v247, v245
    v_mul_f32 v248, v248, v245
    v_mul_f32 v249, v249, v245
    v_accvgpr_write_b32 a128, v246
    v_accvgpr_write_b32 a129, v247
    v_accvgpr_write_b32 a130, v248
    v_accvgpr_write_b32 a131, v249
    v_accvgpr_read_b32 v246, a132
    v_accvgpr_read_b32 v247, a133
    v_accvgpr_read_b32 v248, a134
    v_accvgpr_read_b32 v249, a135
    v_mul_f32 v246, v246, v245
    v_mul_f32 v247, v247, v245
    v_mul_f32 v248, v248, v245
    v_mul_f32 v249, v249, v245
    v_accvgpr_write_b32 a132, v246
    v_accvgpr_write_b32 a133, v247
    v_accvgpr_write_b32 a134, v248
    v_accvgpr_write_b32 a135, v249
    v_accvgpr_read_b32 v246, a136
    v_accvgpr_read_b32 v247, a137
    v_accvgpr_read_b32 v248, a138
    v_accvgpr_read_b32 v249, a139
    v_mul_f32 v246, v246, v245
    v_mul_f32 v247, v247, v245
    v_mul_f32 v248, v248, v245
    v_mul_f32 v249, v249, v245
    v_accvgpr_write_b32 a136, v246
    v_accvgpr_write_b32 a137, v247
    v_accvgpr_write_b32 a138, v248
    v_accvgpr_write_b32 a139, v249
    v_accvgpr_read_b32 v246, a140
    v_accvgpr_read_b32 v247, a141
    v_accvgpr_read_b32 v248, a142
    v_accvgpr_read_b32 v249, a143
    v_mul_f32 v246, v246, v245
    v_mul_f32 v247, v247, v245
    v_mul_f32 v248, v248, v245
    v_mul_f32 v249, v249, v245
    v_accvgpr_write_b32 a140, v246
    v_accvgpr_write_b32 a141, v247
    v_accvgpr_write_b32 a142, v248
    v_accvgpr_write_b32 a143, v249
    v_accvgpr_read_b32 v246, a144
    v_accvgpr_read_b32 v247, a145
    v_accvgpr_read_b32 v248, a146
    v_accvgpr_read_b32 v249, a147
    v_mul_f32 v246, v246, v245
    v_mul_f32 v247, v247, v245
    v_mul_f32 v248, v248, v245
    v_mul_f32 v249, v249, v245
    v_accvgpr_write_b32 a144, v246
    v_accvgpr_write_b32 a145, v247
    v_accvgpr_write_b32 a146, v248
    v_accvgpr_write_b32 a147, v249
    v_accvgpr_read_b32 v246, a148
    v_accvgpr_read_b32 v247, a149
    v_accvgpr_read_b32 v248, a150
    v_accvgpr_read_b32 v249, a151
    v_mul_f32 v246, v246, v245
    v_mul_f32 v247, v247, v245
    v_mul_f32 v248, v248, v245
    v_mul_f32 v249, v249, v245
    v_accvgpr_write_b32 a148, v246
    v_accvgpr_write_b32 a149, v247
    v_accvgpr_write_b32 a150, v248
    v_accvgpr_write_b32 a151, v249
    v_accvgpr_read_b32 v246, a152
    v_accvgpr_read_b32 v247, a153
    v_accvgpr_read_b32 v248, a154
    v_accvgpr_read_b32 v249, a155
    v_mul_f32 v246, v246, v245
    v_mul_f32 v247, v247, v245
    v_mul_f32 v248, v248, v245
    v_mul_f32 v249, v249, v245
    v_accvgpr_write_b32 a152, v246
    v_accvgpr_write_b32 a153, v247
    v_accvgpr_write_b32 a154, v248
    v_accvgpr_write_b32 a155, v249
    v_accvgpr_read_b32 v246, a156
    v_accvgpr_read_b32 v247, a157
    v_accvgpr_read_b32 v248, a158
    v_accvgpr_read_b32 v249, a159
    v_mul_f32 v246, v246, v245
    v_mul_f32 v247, v247, v245
    v_mul_f32 v248, v248, v245
    v_mul_f32 v249, v249, v245
    v_accvgpr_write_b32 a156, v246
    v_accvgpr_write_b32 a157, v247
    v_accvgpr_write_b32 a158, v248
    v_accvgpr_write_b32 a159, v249
    v_max3_f32 v244, v136, v137, v138
    v_max3_f32 v244, v244, v139, v140
    v_max3_f32 v244, v244, v141, v142
    v_max_f32 v244, v244, v143
    v_mov_b32 v245, v244
    s_nop 1
    v_permlane16_swap_b32 v244, v245
    s_nop 1
    v_max_f32 v244, v244, v245
    v_mov_b32 v245, v244
    s_nop 1
    v_permlane32_swap_b32 v244, v245
    s_nop 1
    v_max_f32 v244, v244, v245
    v_max_f32 v244, 0, v244
    v_sub_f32 v245, 0, v244
    v_exp_f32 v245, v245
    v_sub_f32 v164, v164, v244
    v_sub_f32 v165, v165, v244
    v_sub_f32 v166, v166, v244
    v_sub_f32 v167, v167, v244
    v_sub_f32 v136, v136, v244
    v_sub_f32 v137, v137, v244
    v_sub_f32 v138, v138, v244
    v_sub_f32 v139, v139, v244
    v_sub_f32 v140, v140, v244
    v_sub_f32 v141, v141, v244
    v_sub_f32 v142, v142, v244
    v_sub_f32 v143, v143, v244
    v_mul_f32 v212, v212, v245
    v_mul_f32 v213, v213, v245
    v_mul_f32 v214, v214, v245
    v_mul_f32 v215, v215, v245
    v_accvgpr_read_b32 v246, a160
    v_accvgpr_read_b32 v247, a161
    v_accvgpr_read_b32 v248, a162
    v_accvgpr_read_b32 v249, a163
    v_mul_f32 v246, v246, v245
    v_mul_f32 v247, v247, v245
    v_mul_f32 v248, v248, v245
    v_mul_f32 v249, v249, v245
    v_accvgpr_write_b32 a160, v246
    v_accvgpr_write_b32 a161, v247
    v_accvgpr_write_b32 a162, v248
    v_accvgpr_write_b32 a163, v249
    v_accvgpr_read_b32 v246, a164
    v_accvgpr_read_b32 v247, a165
    v_accvgpr_read_b32 v248, a166
    v_accvgpr_read_b32 v249, a167
    v_mul_f32 v246, v246, v245
    v_mul_f32 v247, v247, v245
    v_mul_f32 v248, v248, v245
    v_mul_f32 v249, v249, v245
    v_accvgpr_write_b32 a164, v246
    v_accvgpr_write_b32 a165, v247
    v_accvgpr_write_b32 a166, v248
    v_accvgpr_write_b32 a167, v249
    v_accvgpr_read_b32 v246, a168
    v_accvgpr_read_b32 v247, a169
    v_accvgpr_read_b32 v248, a170
    v_accvgpr_read_b32 v249, a171
    v_mul_f32 v246, v246, v245
    v_mul_f32 v247, v247, v245
    v_mul_f32 v248, v248, v245
    v_mul_f32 v249, v249, v245
    v_accvgpr_write_b32 a168, v246
    v_accvgpr_write_b32 a169, v247
    v_accvgpr_write_b32 a170, v248
    v_accvgpr_write_b32 a171, v249
    v_accvgpr_read_b32 v246, a172
    v_accvgpr_read_b32 v247, a173
    v_accvgpr_read_b32 v248, a174
    v_accvgpr_read_b32 v249, a175
    v_mul_f32 v246, v246, v245
    v_mul_f32 v247, v247, v245
    v_mul_f32 v248, v248, v245
    v_mul_f32 v249, v249, v245
    v_accvgpr_write_b32 a172, v246
    v_accvgpr_write_b32 a173, v247
    v_accvgpr_write_b32 a174, v248
    v_accvgpr_write_b32 a175, v249
    v_accvgpr_read_b32 v246, a176
    v_accvgpr_read_b32 v247, a177
    v_accvgpr_read_b32 v248, a178
    v_accvgpr_read_b32 v249, a179
    v_mul_f32 v246, v246, v245
    v_mul_f32 v247, v247, v245
    v_mul_f32 v248, v248, v245
    v_mul_f32 v249, v249, v245
    v_accvgpr_write_b32 a176, v246
    v_accvgpr_write_b32 a177, v247
    v_accvgpr_write_b32 a178, v248
    v_accvgpr_write_b32 a179, v249
    v_accvgpr_read_b32 v246, a180
    v_accvgpr_read_b32 v247, a181
    v_accvgpr_read_b32 v248, a182
    v_accvgpr_read_b32 v249, a183
    v_mul_f32 v246, v246, v245
    v_mul_f32 v247, v247, v245
    v_mul_f32 v248, v248, v245
    v_mul_f32 v249, v249, v245
    v_accvgpr_write_b32 a180, v246
    v_accvgpr_write_b32 a181, v247
    v_accvgpr_write_b32 a182, v248
    v_accvgpr_write_b32 a183, v249
    v_accvgpr_read_b32 v246, a184
    v_accvgpr_read_b32 v247, a185
    v_accvgpr_read_b32 v248, a186
    v_accvgpr_read_b32 v249, a187
    v_mul_f32 v246, v246, v245
    v_mul_f32 v247, v247, v245
    v_mul_f32 v248, v248, v245
    v_mul_f32 v249, v249, v245
    v_accvgpr_write_b32 a184, v246
    v_accvgpr_write_b32 a185, v247
    v_accvgpr_write_b32 a186, v248
    v_accvgpr_write_b32 a187, v249
    v_accvgpr_read_b32 v246, a188
    v_accvgpr_read_b32 v247, a189
    v_accvgpr_read_b32 v248, a190
    v_accvgpr_read_b32 v249, a191
    v_mul_f32 v246, v246, v245
    v_mul_f32 v247, v247, v245
    v_mul_f32 v248, v248, v245
    v_mul_f32 v249, v249, v245
    v_accvgpr_write_b32 a188, v246
    v_accvgpr_write_b32 a189, v247
    v_accvgpr_write_b32 a190, v248
    v_accvgpr_write_b32 a191, v249
    s_nop 3
    s_setpc_b64 s[44:45]
.globl reduce_kernel
.p2align 8
.type reduce_kernel,@function
reduce_kernel:
    s_cmp_ge_u32 s2, 256
    s_cbranch_scc1 Lk2_end
    s_load_dwordx2 s[4:5], s[0:1], 80
    s_load_dwordx2 s[6:7], s[0:1], 96
    v_lshrrev_b32 v1, 6, v0
    v_and_b32 v2, 63, v0
    v_readfirstlane_b32 s16, v1
    v_lshlrev_b32 v3, 4, v2
    s_lshr_b32 s17, s2, 4
    s_and_b32 s18, s2, 15
    s_lshl_b32 s18, s18, 2
    s_add_u32 s18, s18, s16
    s_mul_i32 s19, s17, 3145728
    s_mul_i32 s20, s18, 3072
    s_add_u32 s19, s19, s20
    s_waitcnt lgkmcnt(0)
    s_add_u32 s8, s6, s19
    s_addc_u32 s9, s7, 0
    s_mov_b32 s10, 2952192
    s_mov_b32 s11, 0x00020000
    s_mov_b32 s21, 0
    buffer_load_dwordx4 v[32:35], v3, s[8:11], s21 offen offset:0
    buffer_load_dwordx4 v[36:39], v3, s[8:11], s21 offen offset:1024
    buffer_load_dwordx4 v[40:43], v3, s[8:11], s21 offen offset:2048
    s_add_u32 s21, s21, 196608
    buffer_load_dwordx4 v[44:47], v3, s[8:11], s21 offen offset:0
    buffer_load_dwordx4 v[48:51], v3, s[8:11], s21 offen offset:1024
    buffer_load_dwordx4 v[52:55], v3, s[8:11], s21 offen offset:2048
    s_add_u32 s21, s21, 196608
    buffer_load_dwordx4 v[56:59], v3, s[8:11], s21 offen offset:0
    buffer_load_dwordx4 v[60:63], v3, s[8:11], s21 offen offset:1024
    buffer_load_dwordx4 v[64:67], v3, s[8:11], s21 offen offset:2048
    s_add_u32 s21, s21, 196608
    buffer_load_dwordx4 v[68:71], v3, s[8:11], s21 offen offset:0
    buffer_load_dwordx4 v[72:75], v3, s[8:11], s21 offen offset:1024
    buffer_load_dwordx4 v[76:79], v3, s[8:11], s21 offen offset:2048
    s_add_u32 s21, s21, 196608
    buffer_load_dwordx4 v[80:83], v3, s[8:11], s21 offen offset:0
    buffer_load_dwordx4 v[84:87], v3, s[8:11], s21 offen offset:1024
    buffer_load_dwordx4 v[88:91], v3, s[8:11], s21 offen offset:2048
    s_add_u32 s21, s21, 196608
    buffer_load_dwordx4 v[92:95], v3, s[8:11], s21 offen offset:0
    buffer_load_dwordx4 v[96:99], v3, s[8:11], s21 offen offset:1024
    buffer_load_dwordx4 v[100:103], v3, s[8:11], s21 offen offset:2048
    s_add_u32 s21, s21, 196608
    buffer_load_dwordx4 v[104:107], v3, s[8:11], s21 offen offset:0
    buffer_load_dwordx4 v[108:111], v3, s[8:11], s21 offen offset:1024
    buffer_load_dwordx4 v[112:115], v3, s[8:11], s21 offen offset:2048
    s_add_u32 s21, s21, 196608
    buffer_load_dwordx4 v[116:119], v3, s[8:11], s21 offen offset:0
    buffer_load_dwordx4 v[120:123], v3, s[8:11], s21 offen offset:1024
    buffer_load_dwordx4 v[124:127], v3, s[8:11], s21 offen offset:2048
    s_add_u32 s21, s21, 196608
    buffer_load_dwordx4 v[128:131], v3, s[8:11], s21 offen offset:0
    buffer_load_dwordx4 v[132:135], v3, s[8:11], s21 offen offset:1024
    buffer_load_dwordx4 v[136:139], v3, s[8:11], s21 offen offset:2048
    s_add_u32 s21, s21, 196608
    buffer_load_dwordx4 v[140:143], v3, s[8:11], s21 offen offset:0
    buffer_load_dwordx4 v[144:147], v3, s[8:11], s21 offen offset:1024
    buffer_load_dwordx4 v[148:151], v3, s[8:11], s21 offen offset:2048
    s_add_u32 s21, s21, 196608
    buffer_load_dwordx4 v[152:155], v3, s[8:11], s21 offen offset:0
    buffer_load_dwordx4 v[156:159], v3, s[8:11], s21 offen offset:1024
    buffer_load_dwordx4 v[160:163], v3, s[8:11], s21 offen offset:2048
    s_add_u32 s21, s21, 196608
    buffer_load_dwordx4 v[164:167], v3, s[8:11], s21 offen offset:0
    buffer_load_dwordx4 v[168:171], v3, s[8:11], s21 offen offset:1024
    buffer_load_dwordx4 v[172:175], v3, s[8:11], s21 offen offset:2048
    s_add_u32 s21, s21, 196608
    buffer_load_dwordx4 v[176:179], v3, s[8:11], s21 offen offset:0
    buffer_load_dwordx4 v[180:183], v3, s[8:11], s21 offen offset:1024
    buffer_load_dwordx4 v[184:187], v3, s[8:11], s21 offen offset:2048
    s_add_u32 s21, s21, 196608
    buffer_load_dwordx4 v[188:191], v3, s[8:11], s21 offen offset:0
    buffer_load_dwordx4 v[192:195], v3, s[8:11], s21 offen offset:1024
    buffer_load_dwordx4 v[196:199], v3, s[8:11], s21 offen offset:2048
    s_add_u32 s21, s21, 196608
    buffer_load_dwordx4 v[200:203], v3, s[8:11], s21 offen offset:0
    buffer_load_dwordx4 v[204:207], v3, s[8:11], s21 offen offset:1024
    buffer_load_dwordx4 v[208:211], v3, s[8:11], s21 offen offset:2048
    s_add_u32 s21, s21, 196608
    buffer_load_dwordx4 v[212:215], v3, s[8:11], s21 offen offset:0
    buffer_load_dwordx4 v[216:219], v3, s[8:11], s21 offen offset:1024
    buffer_load_dwordx4 v[220:223], v3, s[8:11], s21 offen offset:2048
    s_lshr_b32 s22, s18, 1
    s_and_b32 s23, s18, 1
    s_mul_i32 s23, s23, 3
    s_lshr_b32 s24, s22, 3
    s_lshr_b32 s25, s24, 1
    s_mul_i32 s25, s25, 96
    s_and_b32 s26, s17, 7
    s_mul_i32 s26, s26, 192
    s_add_u32 s25, s25, s26
    s_lshl_b32 s23, s23, 4
    s_add_u32 s25, s25, s23
    s_lshl_b32 s25, s25, 11
    s_lshr_b32 s26, s17, 3
    s_lshl_b32 s26, s26, 10
    s_add_u32 s25, s25, s26
    s_and_b32 s26, s24, 1
    s_lshl_b32 s26, s26, 9
    s_add_u32 s25, s25, s26
    s_and_b32 s26, s22, 7
    s_lshl_b32 s26, s26, 6
    s_add_u32 s25, s25, s26
    s_add_u32 s12, s4, s25
    s_addc_u32 s13, s5, 0
    s_mov_b32 s14, 96320
    s_mov_b32 s15, 0x00020000
    v_and_b32 v4, 15, v2
    v_lshrrev_b32 v5, 4, v2
    v_lshlrev_b32 v4, 11, v4
    v_lshl_add_u32 v4, v5, 3, v4
    s_mov_b32 s27, 0xffff0000
    s_waitcnt vmcnt(45)
    v_lshlrev_b32 v8, 16, v32
    v_and_b32 v9, s27, v32
    v_lshlrev_b32 v10, 16, v33
    v_and_b32 v11, s27, v33
    v_lshlrev_b32 v12, 16, v34
    v_and_b32 v13, s27, v34
    v_lshlrev_b32 v14, 16, v35
    v_and_b32 v15, s27, v35
    v_lshlrev_b32 v16, 16, v36
    v_and_b32 v17, s27, v36
    v_lshlrev_b32 v18, 16, v37
    v_and_b32 v19, s27, v37
    v_lshlrev_b32 v20, 16, v38
    v_and_b32 v21, s27, v38
    v_lshlrev_b32 v22, 16, v39
    v_and_b32 v23, s27, v39
    v_lshlrev_b32 v24, 16, v40
    v_and_b32 v25, s27, v40
    v_lshlrev_b32 v26, 16, v41
    v_and_b32 v27, s27, v41
    v_lshlrev_b32 v28, 16, v42
    v_and_b32 v29, s27, v42
    v_lshlrev_b32 v30, 16, v43
    v_and_b32 v31, s27, v43
    s_waitcnt vmcnt(42)
    v_lshlrev_b32 v6, 16, v44
    v_and_b32 v7, s27, v44
    v_pk_add_f32 v[8:9], v[8:9], v[6:7]
    v_lshlrev_b32 v6, 16, v45
    v_and_b32 v7, s27, v45
    v_pk_add_f32 v[10:11], v[10:11], v[6:7]
    v_lshlrev_b32 v6, 16, v46
    v_and_b32 v7, s27, v46
    v_pk_add_f32 v[12:13], v[12:13], v[6:7]
    v_lshlrev_b32 v6, 16, v47
    v_and_b32 v7, s27, v47
    v_pk_add_f32 v[14:15], v[14:15], v[6:7]
    v_lshlrev_b32 v6, 16, v48
    v_and_b32 v7, s27, v48
    v_pk_add_f32 v[16:17], v[16:17], v[6:7]
    v_lshlrev_b32 v6, 16, v49
    v_and_b32 v7, s27, v49
    v_pk_add_f32 v[18:19], v[18:19], v[6:7]
    v_lshlrev_b32 v6, 16, v50
    v_and_b32 v7, s27, v50
    v_pk_add_f32 v[20:21], v[20:21], v[6:7]
    v_lshlrev_b32 v6, 16, v51
    v_and_b32 v7, s27, v51
    v_pk_add_f32 v[22:23], v[22:23], v[6:7]
    v_lshlrev_b32 v6, 16, v52
    v_and_b32 v7, s27, v52
    v_pk_add_f32 v[24:25], v[24:25], v[6:7]
    v_lshlrev_b32 v6, 16, v53
    v_and_b32 v7, s27, v53
    v_pk_add_f32 v[26:27], v[26:27], v[6:7]
    v_lshlrev_b32 v6, 16, v54
    v_and_b32 v7, s27, v54
    v_pk_add_f32 v[28:29], v[28:29], v[6:7]
    v_lshlrev_b32 v6, 16, v55
    v_and_b32 v7, s27, v55
    v_pk_add_f32 v[30:31], v[30:31], v[6:7]
    s_waitcnt vmcnt(39)
    v_lshlrev_b32 v6, 16, v56
    v_and_b32 v7, s27, v56
    v_pk_add_f32 v[8:9], v[8:9], v[6:7]
    v_lshlrev_b32 v6, 16, v57
    v_and_b32 v7, s27, v57
    v_pk_add_f32 v[10:11], v[10:11], v[6:7]
    v_lshlrev_b32 v6, 16, v58
    v_and_b32 v7, s27, v58
    v_pk_add_f32 v[12:13], v[12:13], v[6:7]
    v_lshlrev_b32 v6, 16, v59
    v_and_b32 v7, s27, v59
    v_pk_add_f32 v[14:15], v[14:15], v[6:7]
    v_lshlrev_b32 v6, 16, v60
    v_and_b32 v7, s27, v60
    v_pk_add_f32 v[16:17], v[16:17], v[6:7]
    v_lshlrev_b32 v6, 16, v61
    v_and_b32 v7, s27, v61
    v_pk_add_f32 v[18:19], v[18:19], v[6:7]
    v_lshlrev_b32 v6, 16, v62
    v_and_b32 v7, s27, v62
    v_pk_add_f32 v[20:21], v[20:21], v[6:7]
    v_lshlrev_b32 v6, 16, v63
    v_and_b32 v7, s27, v63
    v_pk_add_f32 v[22:23], v[22:23], v[6:7]
    v_lshlrev_b32 v6, 16, v64
    v_and_b32 v7, s27, v64
    v_pk_add_f32 v[24:25], v[24:25], v[6:7]
    v_lshlrev_b32 v6, 16, v65
    v_and_b32 v7, s27, v65
    v_pk_add_f32 v[26:27], v[26:27], v[6:7]
    v_lshlrev_b32 v6, 16, v66
    v_and_b32 v7, s27, v66
    v_pk_add_f32 v[28:29], v[28:29], v[6:7]
    v_lshlrev_b32 v6, 16, v67
    v_and_b32 v7, s27, v67
    v_pk_add_f32 v[30:31], v[30:31], v[6:7]
    s_waitcnt vmcnt(36)
    v_lshlrev_b32 v6, 16, v68
    v_and_b32 v7, s27, v68
    v_pk_add_f32 v[8:9], v[8:9], v[6:7]
    v_lshlrev_b32 v6, 16, v69
    v_and_b32 v7, s27, v69
    v_pk_add_f32 v[10:11], v[10:11], v[6:7]
    v_lshlrev_b32 v6, 16, v70
    v_and_b32 v7, s27, v70
    v_pk_add_f32 v[12:13], v[12:13], v[6:7]
    v_lshlrev_b32 v6, 16, v71
    v_and_b32 v7, s27, v71
    v_pk_add_f32 v[14:15], v[14:15], v[6:7]
    v_lshlrev_b32 v6, 16, v72
    v_and_b32 v7, s27, v72
    v_pk_add_f32 v[16:17], v[16:17], v[6:7]
    v_lshlrev_b32 v6, 16, v73
    v_and_b32 v7, s27, v73
    v_pk_add_f32 v[18:19], v[18:19], v[6:7]
    v_lshlrev_b32 v6, 16, v74
    v_and_b32 v7, s27, v74
    v_pk_add_f32 v[20:21], v[20:21], v[6:7]
    v_lshlrev_b32 v6, 16, v75
    v_and_b32 v7, s27, v75
    v_pk_add_f32 v[22:23], v[22:23], v[6:7]
    v_lshlrev_b32 v6, 16, v76
    v_and_b32 v7, s27, v76
    v_pk_add_f32 v[24:25], v[24:25], v[6:7]
    v_lshlrev_b32 v6, 16, v77
    v_and_b32 v7, s27, v77
    v_pk_add_f32 v[26:27], v[26:27], v[6:7]
    v_lshlrev_b32 v6, 16, v78
    v_and_b32 v7, s27, v78
    v_pk_add_f32 v[28:29], v[28:29], v[6:7]
    v_lshlrev_b32 v6, 16, v79
    v_and_b32 v7, s27, v79
    v_pk_add_f32 v[30:31], v[30:31], v[6:7]
    s_waitcnt vmcnt(33)
    v_lshlrev_b32 v6, 16, v80
    v_and_b32 v7, s27, v80
    v_pk_add_f32 v[8:9], v[8:9], v[6:7]
    v_lshlrev_b32 v6, 16, v81
    v_and_b32 v7, s27, v81
    v_pk_add_f32 v[10:11], v[10:11], v[6:7]
    v_lshlrev_b32 v6, 16, v82
    v_and_b32 v7, s27, v82
    v_pk_add_f32 v[12:13], v[12:13], v[6:7]
    v_lshlrev_b32 v6, 16, v83
    v_and_b32 v7, s27, v83
    v_pk_add_f32 v[14:15], v[14:15], v[6:7]
    v_lshlrev_b32 v6, 16, v84
    v_and_b32 v7, s27, v84
    v_pk_add_f32 v[16:17], v[16:17], v[6:7]
    v_lshlrev_b32 v6, 16, v85
    v_and_b32 v7, s27, v85
    v_pk_add_f32 v[18:19], v[18:19], v[6:7]
    v_lshlrev_b32 v6, 16, v86
    v_and_b32 v7, s27, v86
    v_pk_add_f32 v[20:21], v[20:21], v[6:7]
    v_lshlrev_b32 v6, 16, v87
    v_and_b32 v7, s27, v87
    v_pk_add_f32 v[22:23], v[22:23], v[6:7]
    v_lshlrev_b32 v6, 16, v88
    v_and_b32 v7, s27, v88
    v_pk_add_f32 v[24:25], v[24:25], v[6:7]
    v_lshlrev_b32 v6, 16, v89
    v_and_b32 v7, s27, v89
    v_pk_add_f32 v[26:27], v[26:27], v[6:7]
    v_lshlrev_b32 v6, 16, v90
    v_and_b32 v7, s27, v90
    v_pk_add_f32 v[28:29], v[28:29], v[6:7]
    v_lshlrev_b32 v6, 16, v91
    v_and_b32 v7, s27, v91
    v_pk_add_f32 v[30:31], v[30:31], v[6:7]
    s_waitcnt vmcnt(30)
    v_lshlrev_b32 v6, 16, v92
    v_and_b32 v7, s27, v92
    v_pk_add_f32 v[8:9], v[8:9], v[6:7]
    v_lshlrev_b32 v6, 16, v93
    v_and_b32 v7, s27, v93
    v_pk_add_f32 v[10:11], v[10:11], v[6:7]
    v_lshlrev_b32 v6, 16, v94
    v_and_b32 v7, s27, v94
    v_pk_add_f32 v[12:13], v[12:13], v[6:7]
    v_lshlrev_b32 v6, 16, v95
    v_and_b32 v7, s27, v95
    v_pk_add_f32 v[14:15], v[14:15], v[6:7]
    v_lshlrev_b32 v6, 16, v96
    v_and_b32 v7, s27, v96
    v_pk_add_f32 v[16:17], v[16:17], v[6:7]
    v_lshlrev_b32 v6, 16, v97
    v_and_b32 v7, s27, v97
    v_pk_add_f32 v[18:19], v[18:19], v[6:7]
    v_lshlrev_b32 v6, 16, v98
    v_and_b32 v7, s27, v98
    v_pk_add_f32 v[20:21], v[20:21], v[6:7]
    v_lshlrev_b32 v6, 16, v99
    v_and_b32 v7, s27, v99
    v_pk_add_f32 v[22:23], v[22:23], v[6:7]
    v_lshlrev_b32 v6, 16, v100
    v_and_b32 v7, s27, v100
    v_pk_add_f32 v[24:25], v[24:25], v[6:7]
    v_lshlrev_b32 v6, 16, v101
    v_and_b32 v7, s27, v101
    v_pk_add_f32 v[26:27], v[26:27], v[6:7]
    v_lshlrev_b32 v6, 16, v102
    v_and_b32 v7, s27, v102
    v_pk_add_f32 v[28:29], v[28:29], v[6:7]
    v_lshlrev_b32 v6, 16, v103
    v_and_b32 v7, s27, v103
    v_pk_add_f32 v[30:31], v[30:31], v[6:7]
    s_waitcnt vmcnt(27)
    v_lshlrev_b32 v6, 16, v104
    v_and_b32 v7, s27, v104
    v_pk_add_f32 v[8:9], v[8:9], v[6:7]
    v_lshlrev_b32 v6, 16, v105
    v_and_b32 v7, s27, v105
    v_pk_add_f32 v[10:11], v[10:11], v[6:7]
    v_lshlrev_b32 v6, 16, v106
    v_and_b32 v7, s27, v106
    v_pk_add_f32 v[12:13], v[12:13], v[6:7]
    v_lshlrev_b32 v6, 16, v107
    v_and_b32 v7, s27, v107
    v_pk_add_f32 v[14:15], v[14:15], v[6:7]
    v_lshlrev_b32 v6, 16, v108
    v_and_b32 v7, s27, v108
    v_pk_add_f32 v[16:17], v[16:17], v[6:7]
    v_lshlrev_b32 v6, 16, v109
    v_and_b32 v7, s27, v109
    v_pk_add_f32 v[18:19], v[18:19], v[6:7]
    v_lshlrev_b32 v6, 16, v110
    v_and_b32 v7, s27, v110
    v_pk_add_f32 v[20:21], v[20:21], v[6:7]
    v_lshlrev_b32 v6, 16, v111
    v_and_b32 v7, s27, v111
    v_pk_add_f32 v[22:23], v[22:23], v[6:7]
    v_lshlrev_b32 v6, 16, v112
    v_and_b32 v7, s27, v112
    v_pk_add_f32 v[24:25], v[24:25], v[6:7]
    v_lshlrev_b32 v6, 16, v113
    v_and_b32 v7, s27, v113
    v_pk_add_f32 v[26:27], v[26:27], v[6:7]
    v_lshlrev_b32 v6, 16, v114
    v_and_b32 v7, s27, v114
    v_pk_add_f32 v[28:29], v[28:29], v[6:7]
    v_lshlrev_b32 v6, 16, v115
    v_and_b32 v7, s27, v115
    v_pk_add_f32 v[30:31], v[30:31], v[6:7]
    s_waitcnt vmcnt(24)
    v_lshlrev_b32 v6, 16, v116
    v_and_b32 v7, s27, v116
    v_pk_add_f32 v[8:9], v[8:9], v[6:7]
    v_lshlrev_b32 v6, 16, v117
    v_and_b32 v7, s27, v117
    v_pk_add_f32 v[10:11], v[10:11], v[6:7]
    v_lshlrev_b32 v6, 16, v118
    v_and_b32 v7, s27, v118
    v_pk_add_f32 v[12:13], v[12:13], v[6:7]
    v_lshlrev_b32 v6, 16, v119
    v_and_b32 v7, s27, v119
    v_pk_add_f32 v[14:15], v[14:15], v[6:7]
    v_lshlrev_b32 v6, 16, v120
    v_and_b32 v7, s27, v120
    v_pk_add_f32 v[16:17], v[16:17], v[6:7]
    v_lshlrev_b32 v6, 16, v121
    v_and_b32 v7, s27, v121
    v_pk_add_f32 v[18:19], v[18:19], v[6:7]
    v_lshlrev_b32 v6, 16, v122
    v_and_b32 v7, s27, v122
    v_pk_add_f32 v[20:21], v[20:21], v[6:7]
    v_lshlrev_b32 v6, 16, v123
    v_and_b32 v7, s27, v123
    v_pk_add_f32 v[22:23], v[22:23], v[6:7]
    v_lshlrev_b32 v6, 16, v124
    v_and_b32 v7, s27, v124
    v_pk_add_f32 v[24:25], v[24:25], v[6:7]
    v_lshlrev_b32 v6, 16, v125
    v_and_b32 v7, s27, v125
    v_pk_add_f32 v[26:27], v[26:27], v[6:7]
    v_lshlrev_b32 v6, 16, v126
    v_and_b32 v7, s27, v126
    v_pk_add_f32 v[28:29], v[28:29], v[6:7]
    v_lshlrev_b32 v6, 16, v127
    v_and_b32 v7, s27, v127
    v_pk_add_f32 v[30:31], v[30:31], v[6:7]
    s_waitcnt vmcnt(21)
    v_lshlrev_b32 v6, 16, v128
    v_and_b32 v7, s27, v128
    v_pk_add_f32 v[8:9], v[8:9], v[6:7]
    v_lshlrev_b32 v6, 16, v129
    v_and_b32 v7, s27, v129
    v_pk_add_f32 v[10:11], v[10:11], v[6:7]
    v_lshlrev_b32 v6, 16, v130
    v_and_b32 v7, s27, v130
    v_pk_add_f32 v[12:13], v[12:13], v[6:7]
    v_lshlrev_b32 v6, 16, v131
    v_and_b32 v7, s27, v131
    v_pk_add_f32 v[14:15], v[14:15], v[6:7]
    v_lshlrev_b32 v6, 16, v132
    v_and_b32 v7, s27, v132
    v_pk_add_f32 v[16:17], v[16:17], v[6:7]
    v_lshlrev_b32 v6, 16, v133
    v_and_b32 v7, s27, v133
    v_pk_add_f32 v[18:19], v[18:19], v[6:7]
    v_lshlrev_b32 v6, 16, v134
    v_and_b32 v7, s27, v134
    v_pk_add_f32 v[20:21], v[20:21], v[6:7]
    v_lshlrev_b32 v6, 16, v135
    v_and_b32 v7, s27, v135
    v_pk_add_f32 v[22:23], v[22:23], v[6:7]
    v_lshlrev_b32 v6, 16, v136
    v_and_b32 v7, s27, v136
    v_pk_add_f32 v[24:25], v[24:25], v[6:7]
    v_lshlrev_b32 v6, 16, v137
    v_and_b32 v7, s27, v137
    v_pk_add_f32 v[26:27], v[26:27], v[6:7]
    v_lshlrev_b32 v6, 16, v138
    v_and_b32 v7, s27, v138
    v_pk_add_f32 v[28:29], v[28:29], v[6:7]
    v_lshlrev_b32 v6, 16, v139
    v_and_b32 v7, s27, v139
    v_pk_add_f32 v[30:31], v[30:31], v[6:7]
    s_waitcnt vmcnt(18)
    v_lshlrev_b32 v6, 16, v140
    v_and_b32 v7, s27, v140
    v_pk_add_f32 v[8:9], v[8:9], v[6:7]
    v_lshlrev_b32 v6, 16, v141
    v_and_b32 v7, s27, v141
    v_pk_add_f32 v[10:11], v[10:11], v[6:7]
    v_lshlrev_b32 v6, 16, v142
    v_and_b32 v7, s27, v142
    v_pk_add_f32 v[12:13], v[12:13], v[6:7]
    v_lshlrev_b32 v6, 16, v143
    v_and_b32 v7, s27, v143
    v_pk_add_f32 v[14:15], v[14:15], v[6:7]
    v_lshlrev_b32 v6, 16, v144
    v_and_b32 v7, s27, v144
    v_pk_add_f32 v[16:17], v[16:17], v[6:7]
    v_lshlrev_b32 v6, 16, v145
    v_and_b32 v7, s27, v145
    v_pk_add_f32 v[18:19], v[18:19], v[6:7]
    v_lshlrev_b32 v6, 16, v146
    v_and_b32 v7, s27, v146
    v_pk_add_f32 v[20:21], v[20:21], v[6:7]
    v_lshlrev_b32 v6, 16, v147
    v_and_b32 v7, s27, v147
    v_pk_add_f32 v[22:23], v[22:23], v[6:7]
    v_lshlrev_b32 v6, 16, v148
    v_and_b32 v7, s27, v148
    v_pk_add_f32 v[24:25], v[24:25], v[6:7]
    v_lshlrev_b32 v6, 16, v149
    v_and_b32 v7, s27, v149
    v_pk_add_f32 v[26:27], v[26:27], v[6:7]
    v_lshlrev_b32 v6, 16, v150
    v_and_b32 v7, s27, v150
    v_pk_add_f32 v[28:29], v[28:29], v[6:7]
    v_lshlrev_b32 v6, 16, v151
    v_and_b32 v7, s27, v151
    v_pk_add_f32 v[30:31], v[30:31], v[6:7]
    s_waitcnt vmcnt(15)
    v_lshlrev_b32 v6, 16, v152
    v_and_b32 v7, s27, v152
    v_pk_add_f32 v[8:9], v[8:9], v[6:7]
    v_lshlrev_b32 v6, 16, v153
    v_and_b32 v7, s27, v153
    v_pk_add_f32 v[10:11], v[10:11], v[6:7]
    v_lshlrev_b32 v6, 16, v154
    v_and_b32 v7, s27, v154
    v_pk_add_f32 v[12:13], v[12:13], v[6:7]
    v_lshlrev_b32 v6, 16, v155
    v_and_b32 v7, s27, v155
    v_pk_add_f32 v[14:15], v[14:15], v[6:7]
    v_lshlrev_b32 v6, 16, v156
    v_and_b32 v7, s27, v156
    v_pk_add_f32 v[16:17], v[16:17], v[6:7]
    v_lshlrev_b32 v6, 16, v157
    v_and_b32 v7, s27, v157
    v_pk_add_f32 v[18:19], v[18:19], v[6:7]
    v_lshlrev_b32 v6, 16, v158
    v_and_b32 v7, s27, v158
    v_pk_add_f32 v[20:21], v[20:21], v[6:7]
    v_lshlrev_b32 v6, 16, v159
    v_and_b32 v7, s27, v159
    v_pk_add_f32 v[22:23], v[22:23], v[6:7]
    v_lshlrev_b32 v6, 16, v160
    v_and_b32 v7, s27, v160
    v_pk_add_f32 v[24:25], v[24:25], v[6:7]
    v_lshlrev_b32 v6, 16, v161
    v_and_b32 v7, s27, v161
    v_pk_add_f32 v[26:27], v[26:27], v[6:7]
    v_lshlrev_b32 v6, 16, v162
    v_and_b32 v7, s27, v162
    v_pk_add_f32 v[28:29], v[28:29], v[6:7]
    v_lshlrev_b32 v6, 16, v163
    v_and_b32 v7, s27, v163
    v_pk_add_f32 v[30:31], v[30:31], v[6:7]
    s_waitcnt vmcnt(12)
    v_lshlrev_b32 v6, 16, v164
    v_and_b32 v7, s27, v164
    v_pk_add_f32 v[8:9], v[8:9], v[6:7]
    v_lshlrev_b32 v6, 16, v165
    v_and_b32 v7, s27, v165
    v_pk_add_f32 v[10:11], v[10:11], v[6:7]
    v_lshlrev_b32 v6, 16, v166
    v_and_b32 v7, s27, v166
    v_pk_add_f32 v[12:13], v[12:13], v[6:7]
    v_lshlrev_b32 v6, 16, v167
    v_and_b32 v7, s27, v167
    v_pk_add_f32 v[14:15], v[14:15], v[6:7]
    v_lshlrev_b32 v6, 16, v168
    v_and_b32 v7, s27, v168
    v_pk_add_f32 v[16:17], v[16:17], v[6:7]
    v_lshlrev_b32 v6, 16, v169
    v_and_b32 v7, s27, v169
    v_pk_add_f32 v[18:19], v[18:19], v[6:7]
    v_lshlrev_b32 v6, 16, v170
    v_and_b32 v7, s27, v170
    v_pk_add_f32 v[20:21], v[20:21], v[6:7]
    v_lshlrev_b32 v6, 16, v171
    v_and_b32 v7, s27, v171
    v_pk_add_f32 v[22:23], v[22:23], v[6:7]
    v_lshlrev_b32 v6, 16, v172
    v_and_b32 v7, s27, v172
    v_pk_add_f32 v[24:25], v[24:25], v[6:7]
    v_lshlrev_b32 v6, 16, v173
    v_and_b32 v7, s27, v173
    v_pk_add_f32 v[26:27], v[26:27], v[6:7]
    v_lshlrev_b32 v6, 16, v174
    v_and_b32 v7, s27, v174
    v_pk_add_f32 v[28:29], v[28:29], v[6:7]
    v_lshlrev_b32 v6, 16, v175
    v_and_b32 v7, s27, v175
    v_pk_add_f32 v[30:31], v[30:31], v[6:7]
    s_waitcnt vmcnt(9)
    v_lshlrev_b32 v6, 16, v176
    v_and_b32 v7, s27, v176
    v_pk_add_f32 v[8:9], v[8:9], v[6:7]
    v_lshlrev_b32 v6, 16, v177
    v_and_b32 v7, s27, v177
    v_pk_add_f32 v[10:11], v[10:11], v[6:7]
    v_lshlrev_b32 v6, 16, v178
    v_and_b32 v7, s27, v178
    v_pk_add_f32 v[12:13], v[12:13], v[6:7]
    v_lshlrev_b32 v6, 16, v179
    v_and_b32 v7, s27, v179
    v_pk_add_f32 v[14:15], v[14:15], v[6:7]
    v_lshlrev_b32 v6, 16, v180
    v_and_b32 v7, s27, v180
    v_pk_add_f32 v[16:17], v[16:17], v[6:7]
    v_lshlrev_b32 v6, 16, v181
    v_and_b32 v7, s27, v181
    v_pk_add_f32 v[18:19], v[18:19], v[6:7]
    v_lshlrev_b32 v6, 16, v182
    v_and_b32 v7, s27, v182
    v_pk_add_f32 v[20:21], v[20:21], v[6:7]
    v_lshlrev_b32 v6, 16, v183
    v_and_b32 v7, s27, v183
    v_pk_add_f32 v[22:23], v[22:23], v[6:7]
    v_lshlrev_b32 v6, 16, v184
    v_and_b32 v7, s27, v184
    v_pk_add_f32 v[24:25], v[24:25], v[6:7]
    v_lshlrev_b32 v6, 16, v185
    v_and_b32 v7, s27, v185
    v_pk_add_f32 v[26:27], v[26:27], v[6:7]
    v_lshlrev_b32 v6, 16, v186
    v_and_b32 v7, s27, v186
    v_pk_add_f32 v[28:29], v[28:29], v[6:7]
    v_lshlrev_b32 v6, 16, v187
    v_and_b32 v7, s27, v187
    v_pk_add_f32 v[30:31], v[30:31], v[6:7]
    s_waitcnt vmcnt(6)
    v_lshlrev_b32 v6, 16, v188
    v_and_b32 v7, s27, v188
    v_pk_add_f32 v[8:9], v[8:9], v[6:7]
    v_lshlrev_b32 v6, 16, v189
    v_and_b32 v7, s27, v189
    v_pk_add_f32 v[10:11], v[10:11], v[6:7]
    v_lshlrev_b32 v6, 16, v190
    v_and_b32 v7, s27, v190
    v_pk_add_f32 v[12:13], v[12:13], v[6:7]
    v_lshlrev_b32 v6, 16, v191
    v_and_b32 v7, s27, v191
    v_pk_add_f32 v[14:15], v[14:15], v[6:7]
    v_lshlrev_b32 v6, 16, v192
    v_and_b32 v7, s27, v192
    v_pk_add_f32 v[16:17], v[16:17], v[6:7]
    v_lshlrev_b32 v6, 16, v193
    v_and_b32 v7, s27, v193
    v_pk_add_f32 v[18:19], v[18:19], v[6:7]
    v_lshlrev_b32 v6, 16, v194
    v_and_b32 v7, s27, v194
    v_pk_add_f32 v[20:21], v[20:21], v[6:7]
    v_lshlrev_b32 v6, 16, v195
    v_and_b32 v7, s27, v195
    v_pk_add_f32 v[22:23], v[22:23], v[6:7]
    v_lshlrev_b32 v6, 16, v196
    v_and_b32 v7, s27, v196
    v_pk_add_f32 v[24:25], v[24:25], v[6:7]
    v_lshlrev_b32 v6, 16, v197
    v_and_b32 v7, s27, v197
    v_pk_add_f32 v[26:27], v[26:27], v[6:7]
    v_lshlrev_b32 v6, 16, v198
    v_and_b32 v7, s27, v198
    v_pk_add_f32 v[28:29], v[28:29], v[6:7]
    v_lshlrev_b32 v6, 16, v199
    v_and_b32 v7, s27, v199
    v_pk_add_f32 v[30:31], v[30:31], v[6:7]
    s_waitcnt vmcnt(3)
    v_lshlrev_b32 v6, 16, v200
    v_and_b32 v7, s27, v200
    v_pk_add_f32 v[8:9], v[8:9], v[6:7]
    v_lshlrev_b32 v6, 16, v201
    v_and_b32 v7, s27, v201
    v_pk_add_f32 v[10:11], v[10:11], v[6:7]
    v_lshlrev_b32 v6, 16, v202
    v_and_b32 v7, s27, v202
    v_pk_add_f32 v[12:13], v[12:13], v[6:7]
    v_lshlrev_b32 v6, 16, v203
    v_and_b32 v7, s27, v203
    v_pk_add_f32 v[14:15], v[14:15], v[6:7]
    v_lshlrev_b32 v6, 16, v204
    v_and_b32 v7, s27, v204
    v_pk_add_f32 v[16:17], v[16:17], v[6:7]
    v_lshlrev_b32 v6, 16, v205
    v_and_b32 v7, s27, v205
    v_pk_add_f32 v[18:19], v[18:19], v[6:7]
    v_lshlrev_b32 v6, 16, v206
    v_and_b32 v7, s27, v206
    v_pk_add_f32 v[20:21], v[20:21], v[6:7]
    v_lshlrev_b32 v6, 16, v207
    v_and_b32 v7, s27, v207
    v_pk_add_f32 v[22:23], v[22:23], v[6:7]
    v_lshlrev_b32 v6, 16, v208
    v_and_b32 v7, s27, v208
    v_pk_add_f32 v[24:25], v[24:25], v[6:7]
    v_lshlrev_b32 v6, 16, v209
    v_and_b32 v7, s27, v209
    v_pk_add_f32 v[26:27], v[26:27], v[6:7]
    v_lshlrev_b32 v6, 16, v210
    v_and_b32 v7, s27, v210
    v_pk_add_f32 v[28:29], v[28:29], v[6:7]
    v_lshlrev_b32 v6, 16, v211
    v_and_b32 v7, s27, v211
    v_pk_add_f32 v[30:31], v[30:31], v[6:7]
    s_waitcnt vmcnt(0)
    v_lshlrev_b32 v6, 16, v212
    v_and_b32 v7, s27, v212
    v_pk_add_f32 v[8:9], v[8:9], v[6:7]
    v_lshlrev_b32 v6, 16, v213
    v_and_b32 v7, s27, v213
    v_pk_add_f32 v[10:11], v[10:11], v[6:7]
    v_lshlrev_b32 v6, 16, v214
    v_and_b32 v7, s27, v214
    v_pk_add_f32 v[12:13], v[12:13], v[6:7]
    v_lshlrev_b32 v6, 16, v215
    v_and_b32 v7, s27, v215
    v_pk_add_f32 v[14:15], v[14:15], v[6:7]
    v_lshlrev_b32 v6, 16, v216
    v_and_b32 v7, s27, v216
    v_pk_add_f32 v[16:17], v[16:17], v[6:7]
    v_lshlrev_b32 v6, 16, v217
    v_and_b32 v7, s27, v217
    v_pk_add_f32 v[18:19], v[18:19], v[6:7]
    v_lshlrev_b32 v6, 16, v218
    v_and_b32 v7, s27, v218
    v_pk_add_f32 v[20:21], v[20:21], v[6:7]
    v_lshlrev_b32 v6, 16, v219
    v_and_b32 v7, s27, v219
    v_pk_add_f32 v[22:23], v[22:23], v[6:7]
    v_lshlrev_b32 v6, 16, v220
    v_and_b32 v7, s27, v220
    v_pk_add_f32 v[24:25], v[24:25], v[6:7]
    v_lshlrev_b32 v6, 16, v221
    v_and_b32 v7, s27, v221
    v_pk_add_f32 v[26:27], v[26:27], v[6:7]
    v_lshlrev_b32 v6, 16, v222
    v_and_b32 v7, s27, v222
    v_pk_add_f32 v[28:29], v[28:29], v[6:7]
    v_lshlrev_b32 v6, 16, v223
    v_and_b32 v7, s27, v223
    v_pk_add_f32 v[30:31], v[30:31], v[6:7]
    v_cvt_pk_bf16_f32 v32, v8, v9
    v_cvt_pk_bf16_f32 v33, v10, v11
    v_cvt_pk_bf16_f32 v34, v12, v13
    v_cvt_pk_bf16_f32 v35, v14, v15
    s_mov_b32 s21, 0
    buffer_store_dwordx2 v[32:33], v4, s[12:15], s21 offen
    buffer_store_dwordx2 v[34:35], v4, s[12:15], s21 offen offset:32
    v_cvt_pk_bf16_f32 v36, v16, v17
    v_cvt_pk_bf16_f32 v37, v18, v19
    v_cvt_pk_bf16_f32 v38, v20, v21
    v_cvt_pk_bf16_f32 v39, v22, v23
    s_mov_b32 s21, 32768
    buffer_store_dwordx2 v[36:37], v4, s[12:15], s21 offen
    buffer_store_dwordx2 v[38:39], v4, s[12:15], s21 offen offset:32
    v_cvt_pk_bf16_f32 v40, v24, v25
    v_cvt_pk_bf16_f32 v41, v26, v27
    v_cvt_pk_bf16_f32 v42, v28, v29
    v_cvt_pk_bf16_f32 v43, v30, v31
    s_mov_b32 s21, 65536
    buffer_store_dwordx2 v[40:41], v4, s[12:15], s21 offen
    buffer_store_dwordx2 v[42:43], v4, s[12:15], s21 offen offset:32
Lk2_end:
    s_endpgm
Ltext_end:
.section .rodata,"a"
.p2align 6
.amdhsa_kernel attn_kernel
  .amdhsa_next_free_vgpr 512
  .amdhsa_next_free_sgpr 102
  .amdhsa_accum_offset 256
  .amdhsa_group_segment_fixed_size 0
  .amdhsa_kernarg_size 104
  .amdhsa_user_sgpr_count 2
  .amdhsa_user_sgpr_kernarg_segment_ptr 1
  .amdhsa_system_sgpr_workgroup_id_x 1
.end_amdhsa_kernel
.p2align 6
.amdhsa_kernel reduce_kernel
  .amdhsa_next_free_vgpr 224
  .amdhsa_next_free_sgpr 80
  .amdhsa_accum_offset 224
  .amdhsa_group_segment_fixed_size 0
  .amdhsa_kernarg_size 104
  .amdhsa_user_sgpr_count 2
  .amdhsa_user_sgpr_kernarg_segment_ptr 1
  .amdhsa_system_sgpr_workgroup_id_x 1
.end_amdhsa_kernel
```
